```python
import torch

def _softmax(x, axis=-1):
    return torch.softmax(x, dim=axis)

def _gelu(x):
    return torch.nn.functional.gelu(x, approximate='tanh')

def _silu(x):
    return torch.nn.functional.silu(x)

def _sigmoid(x):
    return torch.sigmoid(x)

def _layernorm(x, axis=-1, eps=1e-05):
    m = x.mean(dim=axis, keepdim=True)
    v = x.var(dim=axis, keepdim=True, unbiased=False)
    return (x - m) / torch.sqrt(v + eps)

def _scatter_add(tgt, idx, src, axis=0):
    return tgt.clone().index_add_(axis, idx, src)

def _segment_sum(src, seg, n):
    out = torch.zeros((n,) + src.shape[1:], dtype=src.dtype)
    return out.index_add_(0, seg, src)

def _pad(x, pw):
    flat = tuple((v for pair in reversed(pw) for v in pair))
    return torch.nn.functional.pad(x, flat)
kernel_name = 'parallel_sum__memory_aug_recurrent_mem_tr__swiglu_ffn__prompt'

def setup_inputs():

    _w = lambda a: (lambda t: t.to(torch.bfloat16) if t.is_floating_point() else t)(torch.as_tensor(a))

    def _A_setup():
        B, S, Dm = (1, 2048, 640)
        H, Dh = (32, 128)
        M, seg = (8, 32)
        seg = min(seg, S)
        S = S // seg * seg
        return {'x': _w((lambda *s: torch.randn(*s, dtype=torch.bfloat16) * 0.05)(B, S, Dm)), 'mem0': _w((lambda *s: torch.randn(*s, dtype=torch.bfloat16) * 1.6)(B, M, Dm)), 'Wq': _w((lambda *s: torch.randn(*s, dtype=torch.bfloat16) * 0.8)(Dm, H, Dh) * Dm ** (-0.5)), 'Wk': _w((lambda *s: torch.randn(*s, dtype=torch.bfloat16) * 0.8)(Dm, H, Dh) * Dm ** (-0.5)), 'Wv': _w((lambda *s: torch.randn(*s, dtype=torch.bfloat16) * 1.6)(Dm, H, Dh) * Dm ** (-0.5)), 'Wo': _w((lambda *s: torch.randn(*s, dtype=torch.bfloat16) * 1.6)(H, Dh, Dm) * (H * Dh) ** (-0.5)), 'seg_len': seg}
    _A_in = _A_setup()

    def _B_setup():
        B, S, D, F = (1, 2048, 640, 1728)
        return {'x': _w((lambda *s: torch.randn(*s, dtype=torch.bfloat16) * 0.05)(B, S, D)), 'w_gate': _w((lambda *s: torch.randn(*s, dtype=torch.bfloat16) * 0.05)(D, F)), 'w_up': _w((lambda *s: torch.randn(*s, dtype=torch.bfloat16) * 0.05)(D, F)), 'w_down': _w((lambda *s: torch.randn(*s, dtype=torch.bfloat16) * 0.05)(F, D))}
    _B_in = _B_setup()
    return {'A_x': _A_in['x'], 'A_mem0': _A_in['mem0'], 'A_Wq': _A_in['Wq'], 'A_Wk': _A_in['Wk'], 'A_Wv': _A_in['Wv'], 'A_Wo': _A_in['Wo'], 'A_seg_len': _A_in['seg_len'], 'B_x': _B_in['x'], 'B_w_gate': _B_in['w_gate'], 'B_w_up': _B_in['w_up'], 'B_w_down': _B_in['w_down']}

def reference(A_x, A_mem0, A_Wq, A_Wk, A_Wv, A_Wo, A_seg_len, B_x, B_w_gate, B_w_up, B_w_down):

    def _A_ref(x, mem0, Wq, Wk, Wv, Wo, seg_len):
        B, S, Dm = x.shape
        H, Dh = (Wq.shape[1], Wq.shape[2])
        M = mem0.shape[1]
        scale = Dh ** (-0.5)
        n_seg = S // seg_len
        L = M + seg_len
        idx = torch.arange(L)
        mask = (idx[:, None] < M) | (idx[:, None] >= idx[None, :])
        mem = mem0
        outs = []
        for s in range(n_seg):
            xs = x[:, s * seg_len:(s + 1) * seg_len, :].clone()
            h = torch.concatenate([mem, xs], axis=1)
            q = torch.einsum('btd,dhe->bhte', h, Wq)
            k = torch.einsum('btd,dhe->bhte', h, Wk)
            v = torch.einsum('btd,dhe->bhte', h, Wv)
            scores = torch.einsum('bhqe,bhke->bhqk', q, k) * scale
            scores = torch.where(mask[None, None], scores, -1000000000.0)
            p = _softmax(scores, axis=-1)
            o = torch.einsum('bhqk,bhke->bhqe', p, v)
            o = torch.einsum('bhte,hed->btd', o, Wo)
            mem = o[:, :M, :].clone()
            outs.append(o[:, M:, :])
        return torch.concatenate(outs, axis=1)

    def _B_ref(x, w_gate, w_up, w_down):
        g = _silu(x @ w_gate)
        u = x @ w_up
        return g * u @ w_down
    x = A_x
    xn = _layernorm(x, axis=-1)
    return x + _A_ref(xn, A_mem0, A_Wq, A_Wk, A_Wv, A_Wo, A_seg_len) + _B_ref(xn, B_w_gate, B_w_up, B_w_down)
```

```asm
; @launch grid=(256,1,1) block=(256,1,1) lds=163840
.amdgcn_target "amdgcn-amd-amdhsa--gfx950"
.text
.globl parallel_sum__memory_aug_recurrent_mem_tr__swiglu_ffn__prompt_kernel
.p2align 8
.type parallel_sum__memory_aug_recurrent_mem_tr__swiglu_ffn__prompt_kernel,@function
parallel_sum__memory_aug_recurrent_mem_tr__swiglu_ffn__prompt_kernel:
    s_cmp_ge_u32 s2, 256
    s_cbranch_scc1 L_exit
    s_load_dwordx16 s[64:79], s[0:1], 0
    s_load_dwordx8 s[80:87], s[0:1], 64
    s_load_dwordx4 s[88:91], s[0:1], 96
    v_lshrrev_b32 v1, 6, v0
    s_nop 0
    v_readfirstlane_b32 s16, v1
    s_waitcnt lgkmcnt(0)
    s_add_u32 s4, s90, 2097151
    s_addc_u32 s5, s91, 0
    s_and_b32 s4, s4, 0xffe00000
    s_and_b32 s5, s5, 0xffff
    s_mov_b32 s6, 0xfe00000
    s_mov_b32 s7, 0x20000
    s_mov_b32 s12, s88
    s_and_b32 s13, s89, 0xffff
    s_mov_b32 s14, 0x100
    s_mov_b32 s15, 0x20000
    s_and_b32 s20, s2, 7
    s_lshr_b32 s21, s2, 3
    s_cmp_ge_u32 s20, 4
    s_cbranch_scc1 L_side_b
    s_cmp_ge_u32 s21, 16
    s_cbranch_scc1 L_side_a_rest
    s_lshr_b32 s22, s21, 1
    s_lshl_b32 s17, s20, 3
    s_add_u32 s17, s17, s22
    s_and_b32 s18, s21, 1
    s_lshl_b32 s19, s20, 4
    s_add_u32 s19, s19, s21
    v_and_b32 v108, 63, v0
    v_lshlrev_b32 v1, 4, v108
    v_lshlrev_b32 v2, 3, v108
    v_and_b32 v109, 15, v108
    v_lshrrev_b32 v110, 4, v108
    v_and_b32 v111, 1, v110
    v_lshrrev_b32 v100, 1, v110
    v_mov_b32 v101, 0x88888888
    v_mov_b32 v102, 0xdddddddd
    v_cmp_gt_u32 vcc, 8, v109
    s_nop 1
    v_cndmask_b32 v0, v102, v101, vcc
    v_lshrrev_b32 v101, 3, v109
    v_lshlrev_b32 v101, 4, v101
    v_lshl_add_u32 v101, v100, 5, v101
    v_lshl_add_u32 v101, v111, 3, v101
    v_and_b32 v102, 7, v109
    v_add_u32 v101, v101, v102
    v_lshrrev_b32 v103, 3, v101
    v_lshlrev_b32 v103, 14, v103
    v_lshl_add_u32 v11, v102, 4, v103
    v_lshrrev_b32 v103, 4, v101
    v_lshlrev_b32 v103, 14, v103
    v_and_b32 v104, 15, v101
    v_lshl_add_u32 v12, v104, 3, v103
    v_mov_b32 v106, v101
    v_lshrrev_b32 v101, 2, v109
    v_lshl_add_u32 v102, v100, 1, v111
    v_xor_b32 v102, v102, v101
    v_lshlrev_b32 v102, 5, v102
    v_lshl_add_u32 v102, v101, 7, v102
    v_and_b32 v103, 3, v109
    v_lshl_add_u32 v102, v103, 3, v102
    s_lshl_b32 s50, s16, 10
    s_add_u32 s50, s50, 10240
    v_add_u32 v7, s50, v102
    v_lshrrev_b32 v101, 3, v109
    v_lshlrev_b32 v101, 9, v101
    v_lshl_add_u32 v101, v111, 7, v101
    v_and_b32 v102, 7, v109
    v_lshl_add_u32 v102, v102, 1, v100
    v_lshl_add_u32 v101, v102, 3, v101
    s_lshr_b32 s50, s16, 1
    s_lshl_b32 s50, s50, 10
    s_xor_b32 s51, s16, s18
    s_and_b32 s51, s51, 1
    s_lshl_b32 s52, s51, 8
    s_add_u32 s50, s50, s52
    s_add_u32 s50, s50, 14336
    v_add_u32 v10, s50, v101
    v_lshrrev_b32 v101, 2, v108
    v_and_b32 v101, 3, v101
    v_and_b32 v102, 1, v108
    v_lshl_add_u32 v103, v110, 2, v101
    v_lshrrev_b32 v104, 3, v103
    v_lshlrev_b32 v104, 4, v104
    v_lshl_add_u32 v104, v102, 3, v104
    v_and_b32 v103, 7, v103
    v_add_u32 v104, v104, v103
    s_mul_i32 s52, s51, 5120
    s_sub_u32 s53, 5120, s52
    s_add_u32 s52, s52, 0
    v_lshl_add_u32 v3, v104, 4, s53
    v_lshl_add_u32 v4, v104, 3, s53
    v_lshl_add_u32 v5, v104, 4, s52
    v_lshl_add_u32 v6, v104, 3, s52
    v_and_b32 v103, 1, v101
    v_lshl_add_u32 v103, v103, 1, v102
    v_lshrrev_b32 v104, 1, v101
    v_lshl_add_u32 v104, v111, 1, v104
    v_lshlrev_b32 v104, 3, v104
    v_add_u32 v104, 10240, v104
    v_lshl_add_u32 v105, v100, 1, 0
    v_xor_b32 v101, v103, v105
    v_lshlrev_b32 v101, 5, v101
    v_lshl_add_u32 v101, v105, 7, v101
    v_add_u32 v8, v101, v104
    v_lshl_add_u32 v105, v100, 1, 1
    v_xor_b32 v101, v103, v105
    v_lshlrev_b32 v101, 5, v101
    v_lshl_add_u32 v101, v105, 7, v101
    v_add_u32 v9, v101, v104
    v_and_b32 v101, 4, v108
    v_lshlrev_b32 v101, 10, v101
    v_and_b32 v102, 3, v108
    v_lshl_add_u32 v101, v102, 2, v101
    s_lshl_b32 s50, s17, 7
    s_add_u32 s50, s50, 6291456
    v_add_u32 v13, s50, v101
    v_add_u32 v14, 40960, v1
    s_mul_i32 s50, s16, 40960
    s_add_u32 s50, s50, 16384
    v_add_u32 v15, s50, v1
    s_mul_i32 s50, s16, 2560
    s_add_u32 s50, s50, 0
    v_add_u32 v16, s50, v1
    s_add_u32 s51, s50, 2048
    v_add_u32 v17, s51, v2
    v_lshl_add_u32 v107, v106, 3, s51
    v_lshl_add_u32 v106, v106, 4, s50
    s_mov_b32 s8, s66
    s_and_b32 s9, s67, 0xffff
    s_mov_b32 s10, 0x2800
    s_mov_b32 s11, 0x20000
    v_and_b32 v109, 15, v108
    v_lshlrev_b32 v109, 2, v109
    v_lshrrev_b32 v110, 4, v108
    v_and_b32 v110, 1, v110
    v_mul_u32_u24 v110, 5120, v110
    v_add_u32 v109, v109, v110
    s_mul_i32 s50, s16, 320
    s_add_u32 s51, s50, 0
    buffer_load_dword v18, v109, s[8:11], s51 offen offset:0
    buffer_load_dword v19, v109, s[8:11], s51 offen offset:1280
    buffer_load_dword v20, v109, s[8:11], s51 offen offset:2560
    buffer_load_dword v21, v109, s[8:11], s51 offen offset:3840
    s_add_u32 s51, s50, 64
    buffer_load_dword v22, v109, s[8:11], s51 offen offset:0
    buffer_load_dword v23, v109, s[8:11], s51 offen offset:1280
    buffer_load_dword v24, v109, s[8:11], s51 offen offset:2560
    buffer_load_dword v25, v109, s[8:11], s51 offen offset:3840
    s_add_u32 s51, s50, 128
    buffer_load_dword v26, v109, s[8:11], s51 offen offset:0
    buffer_load_dword v27, v109, s[8:11], s51 offen offset:1280
    buffer_load_dword v28, v109, s[8:11], s51 offen offset:2560
    buffer_load_dword v29, v109, s[8:11], s51 offen offset:3840
    s_add_u32 s51, s50, 192
    buffer_load_dword v30, v109, s[8:11], s51 offen offset:0
    buffer_load_dword v31, v109, s[8:11], s51 offen offset:1280
    buffer_load_dword v32, v109, s[8:11], s51 offen offset:2560
    buffer_load_dword v33, v109, s[8:11], s51 offen offset:3840
    s_add_u32 s51, s50, 256
    buffer_load_dword v34, v109, s[8:11], s51 offen offset:0
    buffer_load_dword v35, v109, s[8:11], s51 offen offset:1280
    buffer_load_dword v36, v109, s[8:11], s51 offen offset:2560
    buffer_load_dword v37, v109, s[8:11], s51 offen offset:3840
    s_cmp_lt_u32 s16, 2
    s_cselect_b32 s24, s68, s70
    s_cselect_b32 s25, s69, s71
    s_mov_b32 s20, s24
    s_and_b32 s21, s25, 0xffff
    s_mov_b32 s22, 0x500000
    s_mov_b32 s23, 0x20000
    s_mov_b32 s28, s72
    s_and_b32 s29, s73, 0xffff
    s_mov_b32 s30, 0x500000
    s_mov_b32 s31, 0x20000
    s_mov_b32 s52, s74
    s_and_b32 s53, s75, 0xffff
    s_mov_b32 s54, 0x500000
    s_mov_b32 s55, 0x20000
    v_lshrrev_b32 v109, 4, v108
    v_lshlrev_b32 v109, 1, v109
    v_bfe_u32 v110, v108, 3, 1
    v_lshl_add_u32 v109, v110, 3, v109
    v_bfe_u32 v110, v108, 2, 1
    v_add_u32 v109, v109, v110
    v_lshlrev_b32 v109, 13, v109
    v_and_b32 v110, 3, v108
    v_lshl_add_u32 v104, v110, 4, v109
    v_lshrrev_b32 v109, 4, v108
    v_bfe_u32 v100, v108, 3, 1
    v_lshl_add_u32 v109, v100, 2, v109
    v_bfe_u32 v100, v108, 2, 1
    v_lshl_add_u32 v109, v100, 4, v109
    v_mul_u32_u24 v109, 1280, v109
    v_lshl_add_u32 v105, v110, 4, v109
    s_mul_i32 s59, s16, 40960
    v_lshlrev_b32 v109, 2, v108
    v_add_u32 v103, s59, v109
    v_lshrrev_b32 v109, 5, v108
    v_lshlrev_b32 v109, 1, v109
    v_bfe_u32 v100, v108, 4, 1
    v_lshl_add_u32 v109, v100, 3, v109
    v_bfe_u32 v100, v108, 3, 1
    v_add_u32 v109, v109, v100
    v_lshlrev_b32 v109, 13, v109
    v_lshlrev_b32 v100, 2, v100
    v_and_b32 v110, 7, v108
    v_xor_b32 v110, v110, v100
    v_lshl_add_u32 v102, v110, 4, v109
    v_lshrrev_b32 v109, 4, v108
    v_and_b32 v110, 1, v109
    v_lshlrev_b32 v109, 7, v109
    v_lshl_add_u32 v109, v110, 6, v109
    v_and_b32 v110, 15, v108
    v_lshl_add_u32 v109, v110, 2, v109
    v_add_u32 v64, s59, v109
    v_xor_b32 v65, 64, v64
    s_lshl_b32 s56, s17, 8
    s_and_b32 s50, s16, 1
    s_lshl_b32 s50, s50, 7
    s_add_u32 s56, s56, s50
    s_lshl_b32 s57, s17, 8
    s_lshl_b32 s50, s18, 7
    s_add_u32 s57, s57, s50
    s_lshr_b32 s50, s16, 1
    s_lshl_b32 s50, s50, 6
    s_add_u32 s57, s57, s50
    s_xor_b32 s50, s16, s18
    s_and_b32 s50, s50, 1
    s_mul_i32 s51, s50, 2621440
    s_add_u32 s57, s57, s51
    s_add_u32 s49, s56, s51
    s_sub_u32 s51, 2621440, s51
    s_add_u32 s56, s56, s51
    s_lshl_b32 s58, s17, 7
    s_lshl_b32 s50, s18, 6
    s_add_u32 s58, s58, s50
    s_mul_i32 s58, s58, 1280
    s_mul_i32 s50, s16, 320
    s_add_u32 s58, s58, s50
    s_add_u32 m0, s59, 0
    s_add_u32 s50, s56, 524288
    buffer_load_dwordx4 v102, s[20:23], s50 offen lds
    s_add_u32 m0, s59, 1024
    s_add_u32 s50, s56, 557056
    buffer_load_dwordx4 v102, s[20:23], s50 offen lds
    s_add_u32 m0, s59, 2048
    s_add_u32 s50, s56, 655360
    buffer_load_dwordx4 v102, s[20:23], s50 offen lds
    s_add_u32 m0, s59, 3072
    s_add_u32 s50, s56, 688128
    buffer_load_dwordx4 v102, s[20:23], s50 offen lds
    s_add_u32 m0, s59, 4096
    s_add_u32 s50, s56, 786432
    buffer_load_dwordx4 v102, s[20:23], s50 offen lds
    s_add_u32 m0, s59, 5120
    s_add_u32 s50, s56, 819200
    buffer_load_dwordx4 v102, s[20:23], s50 offen lds
    s_add_u32 m0, s59, 6144
    s_add_u32 s50, s56, 917504
    buffer_load_dwordx4 v102, s[20:23], s50 offen lds
    s_add_u32 m0, s59, 7168
    s_add_u32 s50, s56, 950272
    buffer_load_dwordx4 v102, s[20:23], s50 offen lds
    s_add_u32 m0, s59, 8192
    s_add_u32 s50, s56, 1048576
    buffer_load_dwordx4 v102, s[20:23], s50 offen lds
    s_add_u32 m0, s59, 9216
    s_add_u32 s50, s56, 1081344
    buffer_load_dwordx4 v102, s[20:23], s50 offen lds
    s_add_u32 m0, s59, 10240
    s_add_u32 s50, s56, 1179648
    buffer_load_dwordx4 v102, s[20:23], s50 offen lds
    s_add_u32 m0, s59, 11264
    s_add_u32 s50, s56, 1212416
    buffer_load_dwordx4 v102, s[20:23], s50 offen lds
    s_add_u32 m0, s59, 12288
    s_add_u32 s50, s56, 1310720
    buffer_load_dwordx4 v102, s[20:23], s50 offen lds
    s_add_u32 m0, s59, 13312
    s_add_u32 s50, s56, 1343488
    buffer_load_dwordx4 v102, s[20:23], s50 offen lds
    s_add_u32 m0, s59, 14336
    s_add_u32 s50, s56, 1441792
    buffer_load_dwordx4 v102, s[20:23], s50 offen lds
    s_add_u32 m0, s59, 15360
    s_add_u32 s50, s56, 1474560
    buffer_load_dwordx4 v102, s[20:23], s50 offen lds
    s_add_u32 m0, s59, 16384
    s_add_u32 s50, s56, 1572864
    buffer_load_dwordx4 v102, s[20:23], s50 offen lds
    s_add_u32 m0, s59, 17408
    s_add_u32 s50, s56, 1605632
    buffer_load_dwordx4 v102, s[20:23], s50 offen lds
    s_add_u32 m0, s59, 18432
    s_add_u32 s50, s56, 1703936
    buffer_load_dwordx4 v102, s[20:23], s50 offen lds
    s_add_u32 m0, s59, 19456
    s_add_u32 s50, s56, 1736704
    buffer_load_dwordx4 v102, s[20:23], s50 offen lds
    s_add_u32 m0, s59, 20480
    s_add_u32 s50, s56, 1835008
    buffer_load_dwordx4 v102, s[20:23], s50 offen lds
    s_add_u32 m0, s59, 21504
    s_add_u32 s50, s56, 1867776
    buffer_load_dwordx4 v102, s[20:23], s50 offen lds
    s_add_u32 m0, s59, 22528
    s_add_u32 s50, s56, 1966080
    buffer_load_dwordx4 v102, s[20:23], s50 offen lds
    s_add_u32 m0, s59, 23552
    s_add_u32 s50, s56, 1998848
    buffer_load_dwordx4 v102, s[20:23], s50 offen lds
    s_add_u32 m0, s59, 24576
    s_add_u32 s50, s56, 2097152
    buffer_load_dwordx4 v102, s[20:23], s50 offen lds
    s_add_u32 m0, s59, 25600
    s_add_u32 s50, s56, 2129920
    buffer_load_dwordx4 v102, s[20:23], s50 offen lds
    s_add_u32 m0, s59, 26624
    s_add_u32 s50, s56, 2228224
    buffer_load_dwordx4 v102, s[20:23], s50 offen lds
    s_add_u32 m0, s59, 27648
    s_add_u32 s50, s56, 2260992
    buffer_load_dwordx4 v102, s[20:23], s50 offen lds
    s_add_u32 m0, s59, 28672
    s_add_u32 s50, s56, 2359296
    buffer_load_dwordx4 v102, s[20:23], s50 offen lds
    s_add_u32 m0, s59, 29696
    s_add_u32 s50, s56, 2392064
    buffer_load_dwordx4 v102, s[20:23], s50 offen lds
    s_add_u32 m0, s59, 30720
    s_add_u32 s50, s56, 2490368
    buffer_load_dwordx4 v102, s[20:23], s50 offen lds
    s_add_u32 m0, s59, 31744
    s_add_u32 s50, s56, 2523136
    buffer_load_dwordx4 v102, s[20:23], s50 offen lds
    s_add_u32 m0, s59, 32768
    s_add_u32 s50, s49, 0
    buffer_load_dwordx4 v102, s[20:23], s50 offen lds
    s_add_u32 m0, s59, 33792
    s_add_u32 s50, s49, 32768
    buffer_load_dwordx4 v102, s[20:23], s50 offen lds
    s_add_u32 m0, s59, 34816
    s_add_u32 s50, s49, 131072
    buffer_load_dwordx4 v102, s[20:23], s50 offen lds
    s_add_u32 m0, s59, 35840
    s_add_u32 s50, s49, 163840
    buffer_load_dwordx4 v102, s[20:23], s50 offen lds
    s_add_u32 m0, s59, 36864
    s_add_u32 s50, s49, 262144
    buffer_load_dwordx4 v102, s[20:23], s50 offen lds
    s_add_u32 m0, s59, 37888
    s_add_u32 s50, s49, 294912
    buffer_load_dwordx4 v102, s[20:23], s50 offen lds
    s_add_u32 m0, s59, 38912
    s_add_u32 s50, s49, 393216
    buffer_load_dwordx4 v102, s[20:23], s50 offen lds
    s_add_u32 m0, s59, 39936
    s_add_u32 s50, s49, 425984
    buffer_load_dwordx4 v102, s[20:23], s50 offen lds
    s_waitcnt vmcnt(40)
    v_mov_b32 v100, 0x05040100
    v_mov_b32 v101, 0x07060302
    v_cmp_gt_u32 vcc, 32, v108
    s_nop 1
    v_cndmask_b32 v111, v101, v100, vcc
    v_perm_b32 v38, v19, v18, v111
    v_perm_b32 v39, v21, v20, v111
    v_perm_b32 v40, v23, v22, v111
    v_perm_b32 v41, v25, v24, v111
    v_perm_b32 v42, v27, v26, v111
    v_perm_b32 v43, v29, v28, v111
    v_perm_b32 v44, v31, v30, v111
    v_perm_b32 v45, v33, v32, v111
    v_perm_b32 v46, v35, v34, v111
    v_perm_b32 v47, v37, v36, v111
    s_waitcnt vmcnt(36)
    ds_read2st64_b32 a[0:1], v64 offset0:0 offset1:2
    ds_read2st64_b32 a[2:3], v64 offset0:4 offset1:6
    ds_read2st64_b32 a[4:5], v64 offset0:8 offset1:10
    ds_read2st64_b32 a[6:7], v64 offset0:12 offset1:14
    ds_read2st64_b32 a[8:9], v65 offset0:0 offset1:2
    ds_read2st64_b32 a[10:11], v65 offset0:4 offset1:6
    ds_read2st64_b32 a[12:13], v65 offset0:8 offset1:10
    ds_read2st64_b32 a[14:15], v65 offset0:12 offset1:14
    s_waitcnt vmcnt(32)
    ds_read2st64_b32 a[16:17], v64 offset0:16 offset1:18
    ds_read2st64_b32 a[18:19], v64 offset0:20 offset1:22
    ds_read2st64_b32 a[20:21], v64 offset0:24 offset1:26
    ds_read2st64_b32 a[22:23], v64 offset0:28 offset1:30
    ds_read2st64_b32 a[24:25], v65 offset0:16 offset1:18
    ds_read2st64_b32 a[26:27], v65 offset0:20 offset1:22
    ds_read2st64_b32 a[28:29], v65 offset0:24 offset1:26
    ds_read2st64_b32 a[30:31], v65 offset0:28 offset1:30
    s_waitcnt lgkmcnt(8)
    s_add_u32 m0, s59, 0
    s_add_u32 s50, s49, 524288
    buffer_load_dwordx4 v102, s[20:23], s50 offen lds
    s_add_u32 m0, s59, 1024
    s_add_u32 s50, s49, 557056
    buffer_load_dwordx4 v102, s[20:23], s50 offen lds
    s_add_u32 m0, s59, 2048
    s_add_u32 s50, s49, 655360
    buffer_load_dwordx4 v102, s[20:23], s50 offen lds
    s_add_u32 m0, s59, 3072
    s_add_u32 s50, s49, 688128
    buffer_load_dwordx4 v102, s[20:23], s50 offen lds
    s_waitcnt vmcnt(32)
    ds_read2st64_b32 a[32:33], v64 offset0:32 offset1:34
    ds_read2st64_b32 a[34:35], v64 offset0:36 offset1:38
    ds_read2st64_b32 a[36:37], v64 offset0:40 offset1:42
    ds_read2st64_b32 a[38:39], v64 offset0:44 offset1:46
    ds_read2st64_b32 a[40:41], v65 offset0:32 offset1:34
    ds_read2st64_b32 a[42:43], v65 offset0:36 offset1:38
    ds_read2st64_b32 a[44:45], v65 offset0:40 offset1:42
    ds_read2st64_b32 a[46:47], v65 offset0:44 offset1:46
    s_waitcnt lgkmcnt(8)
    s_add_u32 m0, s59, 4096
    s_add_u32 s50, s49, 786432
    buffer_load_dwordx4 v102, s[20:23], s50 offen lds
    s_add_u32 m0, s59, 5120
    s_add_u32 s50, s49, 819200
    buffer_load_dwordx4 v102, s[20:23], s50 offen lds
    s_add_u32 m0, s59, 6144
    s_add_u32 s50, s49, 917504
    buffer_load_dwordx4 v102, s[20:23], s50 offen lds
    s_add_u32 m0, s59, 7168
    s_add_u32 s50, s49, 950272
    buffer_load_dwordx4 v102, s[20:23], s50 offen lds
    s_waitcnt vmcnt(32)
    ds_read2st64_b32 a[48:49], v64 offset0:48 offset1:50
    ds_read2st64_b32 a[50:51], v64 offset0:52 offset1:54
    ds_read2st64_b32 a[52:53], v64 offset0:56 offset1:58
    ds_read2st64_b32 a[54:55], v64 offset0:60 offset1:62
    ds_read2st64_b32 a[56:57], v65 offset0:48 offset1:50
    ds_read2st64_b32 a[58:59], v65 offset0:52 offset1:54
    ds_read2st64_b32 a[60:61], v65 offset0:56 offset1:58
    ds_read2st64_b32 a[62:63], v65 offset0:60 offset1:62
    s_waitcnt lgkmcnt(8)
    s_add_u32 m0, s59, 8192
    s_add_u32 s50, s49, 1048576
    buffer_load_dwordx4 v102, s[20:23], s50 offen lds
    s_add_u32 m0, s59, 9216
    s_add_u32 s50, s49, 1081344
    buffer_load_dwordx4 v102, s[20:23], s50 offen lds
    s_add_u32 m0, s59, 10240
    s_add_u32 s50, s49, 1179648
    buffer_load_dwordx4 v102, s[20:23], s50 offen lds
    s_add_u32 m0, s59, 11264
    s_add_u32 s50, s49, 1212416
    buffer_load_dwordx4 v102, s[20:23], s50 offen lds
    s_waitcnt vmcnt(32)
    ds_read2st64_b32 a[64:65], v64 offset0:64 offset1:66
    ds_read2st64_b32 a[66:67], v64 offset0:68 offset1:70
    ds_read2st64_b32 a[68:69], v64 offset0:72 offset1:74
    ds_read2st64_b32 a[70:71], v64 offset0:76 offset1:78
    ds_read2st64_b32 a[72:73], v65 offset0:64 offset1:66
    ds_read2st64_b32 a[74:75], v65 offset0:68 offset1:70
    ds_read2st64_b32 a[76:77], v65 offset0:72 offset1:74
    ds_read2st64_b32 a[78:79], v65 offset0:76 offset1:78
    s_waitcnt lgkmcnt(8)
    s_add_u32 m0, s59, 12288
    s_add_u32 s50, s49, 1310720
    buffer_load_dwordx4 v102, s[20:23], s50 offen lds
    s_add_u32 m0, s59, 13312
    s_add_u32 s50, s49, 1343488
    buffer_load_dwordx4 v102, s[20:23], s50 offen lds
    s_add_u32 m0, s59, 14336
    s_add_u32 s50, s49, 1441792
    buffer_load_dwordx4 v102, s[20:23], s50 offen lds
    s_add_u32 m0, s59, 15360
    s_add_u32 s50, s49, 1474560
    buffer_load_dwordx4 v102, s[20:23], s50 offen lds
    s_waitcnt vmcnt(32)
    ds_read2st64_b32 a[80:81], v64 offset0:80 offset1:82
    ds_read2st64_b32 a[82:83], v64 offset0:84 offset1:86
    ds_read2st64_b32 a[84:85], v64 offset0:88 offset1:90
    ds_read2st64_b32 a[86:87], v64 offset0:92 offset1:94
    ds_read2st64_b32 a[88:89], v65 offset0:80 offset1:82
    ds_read2st64_b32 a[90:91], v65 offset0:84 offset1:86
    ds_read2st64_b32 a[92:93], v65 offset0:88 offset1:90
    ds_read2st64_b32 a[94:95], v65 offset0:92 offset1:94
    s_waitcnt lgkmcnt(8)
    s_add_u32 m0, s59, 16384
    s_add_u32 s50, s49, 1572864
    buffer_load_dwordx4 v102, s[20:23], s50 offen lds
    s_add_u32 m0, s59, 17408
    s_add_u32 s50, s49, 1605632
    buffer_load_dwordx4 v102, s[20:23], s50 offen lds
    s_add_u32 m0, s59, 18432
    s_add_u32 s50, s49, 1703936
    buffer_load_dwordx4 v102, s[20:23], s50 offen lds
    s_add_u32 m0, s59, 19456
    s_add_u32 s50, s49, 1736704
    buffer_load_dwordx4 v102, s[20:23], s50 offen lds
    s_waitcnt vmcnt(32)
    ds_read2st64_b32 a[96:97], v64 offset0:96 offset1:98
    ds_read2st64_b32 a[98:99], v64 offset0:100 offset1:102
    ds_read2st64_b32 a[100:101], v64 offset0:104 offset1:106
    ds_read2st64_b32 a[102:103], v64 offset0:108 offset1:110
    ds_read2st64_b32 a[104:105], v65 offset0:96 offset1:98
    ds_read2st64_b32 a[106:107], v65 offset0:100 offset1:102
    ds_read2st64_b32 a[108:109], v65 offset0:104 offset1:106
    ds_read2st64_b32 a[110:111], v65 offset0:108 offset1:110
    s_waitcnt lgkmcnt(8)
    s_add_u32 m0, s59, 20480
    s_add_u32 s50, s49, 1835008
    buffer_load_dwordx4 v102, s[20:23], s50 offen lds
    s_add_u32 m0, s59, 21504
    s_add_u32 s50, s49, 1867776
    buffer_load_dwordx4 v102, s[20:23], s50 offen lds
    s_add_u32 m0, s59, 22528
    s_add_u32 s50, s49, 1966080
    buffer_load_dwordx4 v102, s[20:23], s50 offen lds
    s_add_u32 m0, s59, 23552
    s_add_u32 s50, s49, 1998848
    buffer_load_dwordx4 v102, s[20:23], s50 offen lds
    s_waitcnt vmcnt(32)
    ds_read2st64_b32 a[112:113], v64 offset0:112 offset1:114
    ds_read2st64_b32 a[114:115], v64 offset0:116 offset1:118
    ds_read2st64_b32 a[116:117], v64 offset0:120 offset1:122
    ds_read2st64_b32 a[118:119], v64 offset0:124 offset1:126
    ds_read2st64_b32 a[120:121], v65 offset0:112 offset1:114
    ds_read2st64_b32 a[122:123], v65 offset0:116 offset1:118
    ds_read2st64_b32 a[124:125], v65 offset0:120 offset1:122
    ds_read2st64_b32 a[126:127], v65 offset0:124 offset1:126
    s_waitcnt lgkmcnt(8)
    s_add_u32 m0, s59, 24576
    s_add_u32 s50, s49, 2097152
    buffer_load_dwordx4 v102, s[20:23], s50 offen lds
    s_add_u32 m0, s59, 25600
    s_add_u32 s50, s49, 2129920
    buffer_load_dwordx4 v102, s[20:23], s50 offen lds
    s_add_u32 m0, s59, 26624
    s_add_u32 s50, s49, 2228224
    buffer_load_dwordx4 v102, s[20:23], s50 offen lds
    s_add_u32 m0, s59, 27648
    s_add_u32 s50, s49, 2260992
    buffer_load_dwordx4 v102, s[20:23], s50 offen lds
    s_waitcnt vmcnt(32)
    ds_read2st64_b32 a[128:129], v64 offset0:128 offset1:130
    ds_read2st64_b32 a[130:131], v64 offset0:132 offset1:134
    ds_read2st64_b32 a[132:133], v64 offset0:136 offset1:138
    ds_read2st64_b32 a[134:135], v64 offset0:140 offset1:142
    ds_read2st64_b32 a[136:137], v65 offset0:128 offset1:130
    ds_read2st64_b32 a[138:139], v65 offset0:132 offset1:134
    ds_read2st64_b32 a[140:141], v65 offset0:136 offset1:138
    ds_read2st64_b32 a[142:143], v65 offset0:140 offset1:142
    s_waitcnt lgkmcnt(8)
    s_add_u32 m0, s59, 28672
    s_add_u32 s50, s49, 2359296
    buffer_load_dwordx4 v102, s[20:23], s50 offen lds
    s_add_u32 m0, s59, 29696
    s_add_u32 s50, s49, 2392064
    buffer_load_dwordx4 v102, s[20:23], s50 offen lds
    s_add_u32 m0, s59, 30720
    s_add_u32 s50, s49, 2490368
    buffer_load_dwordx4 v102, s[20:23], s50 offen lds
    s_add_u32 m0, s59, 31744
    s_add_u32 s50, s49, 2523136
    buffer_load_dwordx4 v102, s[20:23], s50 offen lds
    s_waitcnt vmcnt(32)
    ds_read2st64_b32 a[144:145], v64 offset0:144 offset1:146
    ds_read2st64_b32 a[146:147], v64 offset0:148 offset1:150
    ds_read2st64_b32 a[148:149], v64 offset0:152 offset1:154
    ds_read2st64_b32 a[150:151], v64 offset0:156 offset1:158
    ds_read2st64_b32 a[152:153], v65 offset0:144 offset1:146
    ds_read2st64_b32 a[154:155], v65 offset0:148 offset1:150
    ds_read2st64_b32 a[156:157], v65 offset0:152 offset1:154
    ds_read2st64_b32 a[158:159], v65 offset0:156 offset1:158
    s_waitcnt lgkmcnt(8)
    s_add_u32 m0, s59, 32768
    s_add_u32 s50, s57, 0
    buffer_load_dwordx4 v104, s[28:31], s50 offen lds
    s_add_u32 m0, s59, 33792
    s_add_u32 s50, s57, 131072
    buffer_load_dwordx4 v104, s[28:31], s50 offen lds
    s_add_u32 m0, s59, 34816
    s_add_u32 s50, s57, 262144
    buffer_load_dwordx4 v104, s[28:31], s50 offen lds
    s_add_u32 m0, s59, 35840
    s_add_u32 s50, s57, 393216
    buffer_load_dwordx4 v104, s[28:31], s50 offen lds
    s_waitcnt vmcnt(32)
    ds_read2st64_b32 a[160:161], v64 offset0:0 offset1:2
    ds_read2st64_b32 a[162:163], v64 offset0:4 offset1:6
    ds_read2st64_b32 a[164:165], v64 offset0:8 offset1:10
    ds_read2st64_b32 a[166:167], v64 offset0:12 offset1:14
    ds_read2st64_b32 a[168:169], v65 offset0:0 offset1:2
    ds_read2st64_b32 a[170:171], v65 offset0:4 offset1:6
    ds_read2st64_b32 a[172:173], v65 offset0:8 offset1:10
    ds_read2st64_b32 a[174:175], v65 offset0:12 offset1:14
    s_waitcnt lgkmcnt(8)
    s_add_u32 m0, s59, 36864
    s_add_u32 s50, s57, 524288
    buffer_load_dwordx4 v104, s[28:31], s50 offen lds
    s_add_u32 m0, s59, 37888
    s_add_u32 s50, s57, 655360
    buffer_load_dwordx4 v104, s[28:31], s50 offen lds
    s_add_u32 m0, s59, 38912
    s_add_u32 s50, s57, 786432
    buffer_load_dwordx4 v104, s[28:31], s50 offen lds
    s_add_u32 m0, s59, 39936
    s_add_u32 s50, s57, 917504
    buffer_load_dwordx4 v104, s[28:31], s50 offen lds
    s_waitcnt vmcnt(32)
    ds_read2st64_b32 a[176:177], v64 offset0:16 offset1:18
    ds_read2st64_b32 a[178:179], v64 offset0:20 offset1:22
    ds_read2st64_b32 a[180:181], v64 offset0:24 offset1:26
    ds_read2st64_b32 a[182:183], v64 offset0:28 offset1:30
    ds_read2st64_b32 a[184:185], v65 offset0:16 offset1:18
    ds_read2st64_b32 a[186:187], v65 offset0:20 offset1:22
    ds_read2st64_b32 a[188:189], v65 offset0:24 offset1:26
    ds_read2st64_b32 a[190:191], v65 offset0:28 offset1:30
    s_waitcnt lgkmcnt(8)
    s_add_u32 m0, s59, 0
    s_add_u32 s50, s57, 1048576
    buffer_load_dwordx4 v104, s[28:31], s50 offen lds
    s_add_u32 m0, s59, 1024
    s_add_u32 s50, s57, 1179648
    buffer_load_dwordx4 v104, s[28:31], s50 offen lds
    s_add_u32 m0, s59, 2048
    s_add_u32 s50, s57, 1310720
    buffer_load_dwordx4 v104, s[28:31], s50 offen lds
    s_add_u32 m0, s59, 3072
    s_add_u32 s50, s57, 1441792
    buffer_load_dwordx4 v104, s[28:31], s50 offen lds
    s_waitcnt vmcnt(32)
    ds_read2st64_b32 a[192:193], v64 offset0:32 offset1:34
    ds_read2st64_b32 a[194:195], v64 offset0:36 offset1:38
    ds_read2st64_b32 a[196:197], v64 offset0:40 offset1:42
    ds_read2st64_b32 a[198:199], v64 offset0:44 offset1:46
    ds_read2st64_b32 a[200:201], v65 offset0:32 offset1:34
    ds_read2st64_b32 a[202:203], v65 offset0:36 offset1:38
    ds_read2st64_b32 a[204:205], v65 offset0:40 offset1:42
    ds_read2st64_b32 a[206:207], v65 offset0:44 offset1:46
    s_waitcnt lgkmcnt(8)
    s_add_u32 m0, s59, 4096
    s_add_u32 s50, s57, 1572864
    buffer_load_dwordx4 v104, s[28:31], s50 offen lds
    s_add_u32 m0, s59, 5120
    s_add_u32 s50, s57, 1703936
    buffer_load_dwordx4 v104, s[28:31], s50 offen lds
    s_add_u32 m0, s59, 6144
    s_add_u32 s50, s57, 1835008
    buffer_load_dwordx4 v104, s[28:31], s50 offen lds
    s_add_u32 m0, s59, 7168
    s_add_u32 s50, s57, 1966080
    buffer_load_dwordx4 v104, s[28:31], s50 offen lds
    s_waitcnt vmcnt(32)
    ds_read2st64_b32 a[208:209], v64 offset0:48 offset1:50
    ds_read2st64_b32 a[210:211], v64 offset0:52 offset1:54
    ds_read2st64_b32 a[212:213], v64 offset0:56 offset1:58
    ds_read2st64_b32 a[214:215], v64 offset0:60 offset1:62
    ds_read2st64_b32 a[216:217], v65 offset0:48 offset1:50
    ds_read2st64_b32 a[218:219], v65 offset0:52 offset1:54
    ds_read2st64_b32 a[220:221], v65 offset0:56 offset1:58
    ds_read2st64_b32 a[222:223], v65 offset0:60 offset1:62
    s_waitcnt lgkmcnt(8)
    s_add_u32 m0, s59, 8192
    s_add_u32 s50, s57, 2097152
    buffer_load_dwordx4 v104, s[28:31], s50 offen lds
    s_add_u32 m0, s59, 9216
    s_add_u32 s50, s57, 2228224
    buffer_load_dwordx4 v104, s[28:31], s50 offen lds
    s_add_u32 m0, s59, 10240
    s_add_u32 s50, s57, 2359296
    buffer_load_dwordx4 v104, s[28:31], s50 offen lds
    s_add_u32 m0, s59, 11264
    s_add_u32 s50, s57, 2490368
    buffer_load_dwordx4 v104, s[28:31], s50 offen lds
    s_waitcnt vmcnt(32)
    ds_read2st64_b32 a[224:225], v64 offset0:64 offset1:66
    ds_read2st64_b32 a[226:227], v64 offset0:68 offset1:70
    ds_read2st64_b32 a[228:229], v64 offset0:72 offset1:74
    ds_read2st64_b32 a[230:231], v64 offset0:76 offset1:78
    ds_read2st64_b32 a[232:233], v65 offset0:64 offset1:66
    ds_read2st64_b32 a[234:235], v65 offset0:68 offset1:70
    ds_read2st64_b32 a[236:237], v65 offset0:72 offset1:74
    ds_read2st64_b32 a[238:239], v65 offset0:76 offset1:78
    s_waitcnt lgkmcnt(8)
    s_add_u32 m0, s59, 12288
    s_add_u32 s50, s58, 41088
    buffer_load_dwordx4 v105, s[52:55], s50 offen lds
    s_add_u32 m0, s59, 13312
    s_add_u32 s50, s58, 51328
    buffer_load_dwordx4 v105, s[52:55], s50 offen lds
    s_add_u32 m0, s59, 14336
    s_add_u32 s50, s58, 41152
    buffer_load_dwordx4 v105, s[52:55], s50 offen lds
    s_add_u32 m0, s59, 15360
    s_add_u32 s50, s58, 51392
    buffer_load_dwordx4 v105, s[52:55], s50 offen lds
    s_waitcnt vmcnt(32)
    ds_read2st64_b32 a[240:241], v64 offset0:80 offset1:82
    ds_read2st64_b32 a[242:243], v64 offset0:84 offset1:86
    ds_read2st64_b32 a[244:245], v64 offset0:88 offset1:90
    ds_read2st64_b32 a[246:247], v64 offset0:92 offset1:94
    ds_read2st64_b32 a[248:249], v65 offset0:80 offset1:82
    ds_read2st64_b32 a[250:251], v65 offset0:84 offset1:86
    ds_read2st64_b32 a[252:253], v65 offset0:88 offset1:90
    ds_read2st64_b32 a[254:255], v65 offset0:92 offset1:94
    s_waitcnt lgkmcnt(8)
    s_add_u32 m0, s59, 16384
    s_add_u32 s50, s58, 256
    buffer_load_dwordx4 v105, s[52:55], s50 offen lds
    s_add_u32 m0, s59, 17408
    s_add_u32 s50, s58, 10496
    buffer_load_dwordx4 v105, s[52:55], s50 offen lds
    s_add_u32 m0, s59, 18432
    s_add_u32 s50, s58, 41216
    buffer_load_dwordx4 v105, s[52:55], s50 offen lds
    s_add_u32 m0, s59, 19456
    s_add_u32 s50, s58, 51456
    buffer_load_dwordx4 v105, s[52:55], s50 offen lds
    s_waitcnt vmcnt(32)
    ds_read2st64_b32 v[112:113], v64 offset0:96 offset1:98
    ds_read2st64_b32 v[114:115], v64 offset0:100 offset1:102
    ds_read2st64_b32 v[116:117], v64 offset0:104 offset1:106
    ds_read2st64_b32 v[118:119], v64 offset0:108 offset1:110
    ds_read2st64_b32 v[120:121], v65 offset0:96 offset1:98
    ds_read2st64_b32 v[122:123], v65 offset0:100 offset1:102
    ds_read2st64_b32 v[124:125], v65 offset0:104 offset1:106
    ds_read2st64_b32 v[126:127], v65 offset0:108 offset1:110
    s_waitcnt lgkmcnt(8)
    s_add_u32 m0, s59, 20480
    s_add_u32 s50, s56, 0
    buffer_load_dwordx4 v102, s[20:23], s50 offen lds
    s_add_u32 m0, s59, 21504
    s_add_u32 s50, s56, 32768
    buffer_load_dwordx4 v102, s[20:23], s50 offen lds
    s_add_u32 m0, s59, 22528
    s_add_u32 s50, s56, 131072
    buffer_load_dwordx4 v102, s[20:23], s50 offen lds
    s_add_u32 m0, s59, 23552
    s_add_u32 s50, s56, 163840
    buffer_load_dwordx4 v102, s[20:23], s50 offen lds
    s_waitcnt vmcnt(32)
    ds_read2st64_b32 v[128:129], v64 offset0:112 offset1:114
    ds_read2st64_b32 v[130:131], v64 offset0:116 offset1:118
    ds_read2st64_b32 v[132:133], v64 offset0:120 offset1:122
    ds_read2st64_b32 v[134:135], v64 offset0:124 offset1:126
    ds_read2st64_b32 v[136:137], v65 offset0:112 offset1:114
    ds_read2st64_b32 v[138:139], v65 offset0:116 offset1:118
    ds_read2st64_b32 v[140:141], v65 offset0:120 offset1:122
    ds_read2st64_b32 v[142:143], v65 offset0:124 offset1:126
    s_waitcnt lgkmcnt(8)
    s_add_u32 m0, s59, 24576
    s_add_u32 s50, s56, 262144
    buffer_load_dwordx4 v102, s[20:23], s50 offen lds
    s_add_u32 m0, s59, 25600
    s_add_u32 s50, s56, 294912
    buffer_load_dwordx4 v102, s[20:23], s50 offen lds
    s_add_u32 m0, s59, 26624
    s_add_u32 s50, s56, 393216
    buffer_load_dwordx4 v102, s[20:23], s50 offen lds
    s_add_u32 m0, s59, 27648
    s_add_u32 s50, s56, 425984
    buffer_load_dwordx4 v102, s[20:23], s50 offen lds
    s_waitcnt vmcnt(34)
    ds_read2st64_b32 v[144:145], v103 offset0:128 offset1:129
    ds_read2st64_b32 v[146:147], v103 offset0:130 offset1:131
    ds_read2st64_b32 v[148:149], v103 offset0:132 offset1:133
    ds_read2st64_b32 v[150:151], v103 offset0:134 offset1:135
    s_waitcnt lgkmcnt(4)
    s_add_u32 m0, s59, 28672
    s_add_u32 s50, s58, 0
    buffer_load_dwordx4 v105, s[52:55], s50 offen lds
    s_add_u32 m0, s59, 29696
    s_add_u32 s50, s58, 10240
    buffer_load_dwordx4 v105, s[52:55], s50 offen lds
    s_add_u32 m0, s59, 30720
    s_add_u32 s50, s58, 64
    buffer_load_dwordx4 v105, s[52:55], s50 offen lds
    s_add_u32 m0, s59, 31744
    s_add_u32 s50, s58, 10304
    buffer_load_dwordx4 v105, s[52:55], s50 offen lds
    s_waitcnt vmcnt(36)
    ds_read2st64_b32 v[152:153], v103 offset0:136 offset1:137
    ds_read2st64_b32 v[154:155], v103 offset0:138 offset1:139
    ds_read2st64_b32 v[156:157], v103 offset0:140 offset1:141
    ds_read2st64_b32 v[158:159], v103 offset0:142 offset1:143
    s_waitcnt lgkmcnt(4)
    s_add_u32 m0, s59, 32768
    s_add_u32 s50, s58, 128
    buffer_load_dwordx4 v105, s[52:55], s50 offen lds
    s_add_u32 m0, s59, 33792
    s_add_u32 s50, s58, 10368
    buffer_load_dwordx4 v105, s[52:55], s50 offen lds
    s_waitcnt vmcnt(36)
    ds_read2st64_b32 v[160:161], v103 offset0:144 offset1:145
    ds_read2st64_b32 v[162:163], v103 offset0:146 offset1:147
    ds_read2st64_b32 v[164:165], v103 offset0:148 offset1:149
    ds_read2st64_b32 v[166:167], v103 offset0:150 offset1:151
    s_waitcnt lgkmcnt(4)
    s_add_u32 m0, s59, 34816
    s_add_u32 s50, s58, 40960
    buffer_load_dwordx4 v105, s[52:55], s50 offen lds
    s_add_u32 m0, s59, 35840
    s_add_u32 s50, s58, 51200
    buffer_load_dwordx4 v105, s[52:55], s50 offen lds
    s_waitcnt vmcnt(36)
    ds_read2st64_b32 v[168:169], v103 offset0:152 offset1:153
    ds_read2st64_b32 v[170:171], v103 offset0:154 offset1:155
    ds_read2st64_b32 v[172:173], v103 offset0:156 offset1:157
    ds_read2st64_b32 v[174:175], v103 offset0:158 offset1:159
    s_waitcnt lgkmcnt(4)
    s_add_u32 m0, s59, 36864
    s_add_u32 s50, s58, 41024
    buffer_load_dwordx4 v105, s[52:55], s50 offen lds
    s_add_u32 m0, s59, 37888
    s_add_u32 s50, s58, 51264
    buffer_load_dwordx4 v105, s[52:55], s50 offen lds
    s_waitcnt vmcnt(36)
    ds_read2st64_b32 v[176:177], v103 offset0:0 offset1:1
    ds_read2st64_b32 v[178:179], v103 offset0:2 offset1:3
    ds_read2st64_b32 v[180:181], v103 offset0:4 offset1:5
    ds_read2st64_b32 v[182:183], v103 offset0:6 offset1:7
    s_waitcnt lgkmcnt(4)
    s_add_u32 m0, s59, 38912
    s_add_u32 s50, s58, 192
    buffer_load_dwordx4 v105, s[52:55], s50 offen lds
    s_add_u32 m0, s59, 39936
    s_add_u32 s50, s58, 10432
    buffer_load_dwordx4 v105, s[52:55], s50 offen lds
    s_waitcnt vmcnt(36)
    ds_read2st64_b32 v[184:185], v103 offset0:8 offset1:9
    ds_read2st64_b32 v[186:187], v103 offset0:10 offset1:11
    ds_read2st64_b32 v[188:189], v103 offset0:12 offset1:13
    ds_read2st64_b32 v[190:191], v103 offset0:14 offset1:15
    s_waitcnt lgkmcnt(4)
    s_waitcnt vmcnt(34)
    ds_read2st64_b32 v[192:193], v103 offset0:16 offset1:17
    ds_read2st64_b32 v[194:195], v103 offset0:18 offset1:19
    ds_read2st64_b32 v[196:197], v103 offset0:20 offset1:21
    ds_read2st64_b32 v[198:199], v103 offset0:22 offset1:23
    s_waitcnt lgkmcnt(4)
    s_waitcnt vmcnt(32)
    ds_read2st64_b32 v[200:201], v103 offset0:24 offset1:25
    ds_read2st64_b32 v[202:203], v103 offset0:26 offset1:27
    ds_read2st64_b32 v[204:205], v103 offset0:28 offset1:29
    ds_read2st64_b32 v[206:207], v103 offset0:30 offset1:31
    s_waitcnt lgkmcnt(4)
    s_waitcnt vmcnt(30)
    ds_read2st64_b32 v[208:209], v103 offset0:32 offset1:33
    ds_read2st64_b32 v[210:211], v103 offset0:34 offset1:35
    ds_read2st64_b32 v[212:213], v103 offset0:36 offset1:37
    ds_read2st64_b32 v[214:215], v103 offset0:38 offset1:39
    s_waitcnt lgkmcnt(4)
    s_waitcnt vmcnt(28)
    ds_read2st64_b32 v[216:217], v103 offset0:40 offset1:41
    ds_read2st64_b32 v[218:219], v103 offset0:42 offset1:43
    ds_read2st64_b32 v[220:221], v103 offset0:44 offset1:45
    ds_read2st64_b32 v[222:223], v103 offset0:46 offset1:47
    s_waitcnt lgkmcnt(4)
    s_waitcnt vmcnt(26)
    ds_read2st64_b32 v[224:225], v103 offset0:48 offset1:49
    ds_read2st64_b32 v[226:227], v103 offset0:50 offset1:51
    ds_read2st64_b32 v[228:229], v103 offset0:52 offset1:53
    ds_read2st64_b32 v[230:231], v103 offset0:54 offset1:55
    s_waitcnt lgkmcnt(4)
    s_waitcnt vmcnt(24)
    ds_read2st64_b32 v[232:233], v103 offset0:56 offset1:57
    ds_read2st64_b32 v[234:235], v103 offset0:58 offset1:59
    ds_read2st64_b32 v[236:237], v103 offset0:60 offset1:61
    ds_read2st64_b32 v[238:239], v103 offset0:62 offset1:63
    s_waitcnt lgkmcnt(4)
    s_waitcnt vmcnt(22)
    ds_read2st64_b32 v[240:241], v103 offset0:64 offset1:65
    ds_read2st64_b32 v[242:243], v103 offset0:66 offset1:67
    ds_read2st64_b32 v[244:245], v103 offset0:68 offset1:69
    ds_read2st64_b32 v[246:247], v103 offset0:70 offset1:71
    s_waitcnt lgkmcnt(4)
    s_waitcnt vmcnt(20)
    ds_read2st64_b32 v[248:249], v103 offset0:72 offset1:73
    ds_read2st64_b32 v[250:251], v103 offset0:74 offset1:75
    ds_read2st64_b32 v[252:253], v103 offset0:76 offset1:77
    ds_read2st64_b32 v[254:255], v103 offset0:78 offset1:79
    s_waitcnt lgkmcnt(4)
    s_waitcnt lgkmcnt(0)
    s_waitcnt vmcnt(16)
    ds_read2st64_b32 v[48:49], v64 offset0:80 offset1:82
    ds_read2st64_b32 v[50:51], v64 offset0:84 offset1:86
    ds_read2st64_b32 v[52:53], v64 offset0:88 offset1:90
    ds_read2st64_b32 v[54:55], v64 offset0:92 offset1:94
    ds_read2st64_b32 v[56:57], v65 offset0:80 offset1:82
    ds_read2st64_b32 v[58:59], v65 offset0:84 offset1:86
    ds_read2st64_b32 v[60:61], v65 offset0:88 offset1:90
    ds_read2st64_b32 v[62:63], v65 offset0:92 offset1:94
    s_waitcnt lgkmcnt(0)
    ds_write_b128 v15, v[48:51] offset:4096
    ds_write_b128 v15, v[52:55] offset:5120
    ds_write_b128 v15, v[56:59] offset:6144
    ds_write_b128 v15, v[60:63] offset:7168
    s_waitcnt vmcnt(12)
    ds_read2st64_b32 v[48:49], v64 offset0:96 offset1:98
    ds_read2st64_b32 v[50:51], v64 offset0:100 offset1:102
    ds_read2st64_b32 v[52:53], v64 offset0:104 offset1:106
    ds_read2st64_b32 v[54:55], v64 offset0:108 offset1:110
    ds_read2st64_b32 v[56:57], v65 offset0:96 offset1:98
    ds_read2st64_b32 v[58:59], v65 offset0:100 offset1:102
    ds_read2st64_b32 v[60:61], v65 offset0:104 offset1:106
    ds_read2st64_b32 v[62:63], v65 offset0:108 offset1:110
    s_waitcnt lgkmcnt(0)
    ds_write_b128 v15, v[48:51] offset:8192
    ds_write_b128 v15, v[52:55] offset:9216
    ds_write_b128 v15, v[56:59] offset:10240
    ds_write_b128 v15, v[60:63] offset:11264
    s_waitcnt vmcnt(10)
    ds_read2st64_b32 v[48:49], v103 offset0:112 offset1:113
    ds_read2st64_b32 v[50:51], v103 offset0:114 offset1:115
    ds_read2st64_b32 v[52:53], v103 offset0:116 offset1:117
    ds_read2st64_b32 v[54:55], v103 offset0:118 offset1:119
    s_waitcnt lgkmcnt(0)
    ds_write_b128 v15, v[48:51] offset:12288
    ds_write_b128 v15, v[52:55] offset:13312
    s_waitcnt vmcnt(8)
    ds_read2st64_b32 v[56:57], v103 offset0:120 offset1:121
    ds_read2st64_b32 v[58:59], v103 offset0:122 offset1:123
    ds_read2st64_b32 v[60:61], v103 offset0:124 offset1:125
    ds_read2st64_b32 v[62:63], v103 offset0:126 offset1:127
    s_waitcnt lgkmcnt(0)
    ds_write_b128 v15, v[56:59] offset:14336
    ds_write_b128 v15, v[60:63] offset:15360
    s_waitcnt vmcnt(6)
    ds_read2st64_b32 v[48:49], v103 offset0:128 offset1:129
    ds_read2st64_b32 v[50:51], v103 offset0:130 offset1:131
    ds_read2st64_b32 v[52:53], v103 offset0:132 offset1:133
    ds_read2st64_b32 v[54:55], v103 offset0:134 offset1:135
    s_waitcnt lgkmcnt(0)
    ds_write_b128 v15, v[48:51] offset:16384
    ds_write_b128 v15, v[52:55] offset:17408
    s_waitcnt vmcnt(4)
    ds_read2st64_b32 v[56:57], v103 offset0:136 offset1:137
    ds_read2st64_b32 v[58:59], v103 offset0:138 offset1:139
    ds_read2st64_b32 v[60:61], v103 offset0:140 offset1:141
    ds_read2st64_b32 v[62:63], v103 offset0:142 offset1:143
    s_waitcnt lgkmcnt(0)
    ds_write_b128 v15, v[56:59] offset:18432
    ds_write_b128 v15, v[60:63] offset:19456
    s_waitcnt vmcnt(2)
    ds_read2st64_b32 v[48:49], v103 offset0:144 offset1:145
    ds_read2st64_b32 v[50:51], v103 offset0:146 offset1:147
    ds_read2st64_b32 v[52:53], v103 offset0:148 offset1:149
    ds_read2st64_b32 v[54:55], v103 offset0:150 offset1:151
    s_waitcnt lgkmcnt(0)
    ds_write_b128 v15, v[48:51] offset:20480
    ds_write_b128 v15, v[52:55] offset:21504
    s_waitcnt vmcnt(0)
    ds_read2st64_b32 v[56:57], v103 offset0:152 offset1:153
    ds_read2st64_b32 v[58:59], v103 offset0:154 offset1:155
    ds_read2st64_b32 v[60:61], v103 offset0:156 offset1:157
    ds_read2st64_b32 v[62:63], v103 offset0:158 offset1:159
    s_waitcnt lgkmcnt(0)
    ds_write_b128 v15, v[56:59] offset:22528
    ds_write_b128 v15, v[60:63] offset:23552
    s_waitcnt lgkmcnt(0)
    s_barrier
    ds_write_b64 v106, v[38:39] offset:0
    ds_write_b64 v106, v[40:41] offset:8
    ds_write_b64 v106, v[42:43] offset:1024
    ds_write_b64 v106, v[44:45] offset:1032
    ds_write_b64 v107, v[46:47]
    v_mov_b32 v18, 0x3f003f00
    v_mov_b32 v19, 0x3f003f00
    v_mov_b32 v44, 0x3f803f80
    v_mov_b32 v45, 0x3f803f80
    v_mov_b32 v46, 0x3f803f80
    v_mov_b32 v47, 0x3f803f80
    s_mov_b32 s60, 0x3e0293ee
    s_mov_b32 s61, 0x3e0293ee
    v_and_b32 v48, 1, v108
    v_mul_u32_u24 v49, 132, v48
    v_mov_b32 v50, 64
    v_mov_b32 v51, 0x80000000
    v_cmp_eq_u32 vcc, 1, v48
    s_nop 1
    v_cndmask_b32 v50, v50, v51, vcc
    s_mov_b32 s62, 0
    s_cmp_lg_u32 s16, 0
    s_cbranch_scc1 L_cst_bar
L_cst:
    buffer_load_dword v51, v49, s[12:15], 0 offen sc1
    s_waitcnt vmcnt(0)
    v_cmp_gt_u32 vcc, v50, v51
    s_cbranch_vccz L_cst_bar
    s_sleep 8
    s_add_u32 s62, s62, 1
    s_cmp_lt_u32 s62, 2000000
    s_cbranch_scc1 L_cst
    v_mov_b32 v1, 257
    v_mov_b32 v2, 192
    buffer_store_dword v1, v2, s[12:15], 0 offen sc1
    s_waitcnt vmcnt(0)
    s_endpgm
L_cst_bar:
    s_barrier
    buffer_load_dword v51, v49, s[12:15], 0 offen sc1
    s_lshr_b32 s50, s19, 4
    s_mul_i32 s50, s50, 20
    s_and_b32 s51, s19, 15
    s_add_u32 s50, s50, s51
    s_add_u32 s50, s50, 4
    s_lshr_b32 s51, s19, 2
    s_mul_i32 s51, s51, 20
    s_and_b32 s52, s19, 3
    s_add_u32 s51, s51, s52
    s_cmp_lt_u32 s19, 16
    s_cselect_b32 s51, s51, -1
    s_bitcmp1_b32 s16, 0
    s_cselect_b32 s33, s51, s50
    s_max_i32 s50, s33, 0
    s_lshl_b32 s42, s50, 14
    s_mul_i32 s51, s50, 3277
    s_lshr_b32 s51, s51, 16
    s_mul_i32 s52, s51, 20
    s_sub_u32 s52, s50, s52
    s_lshl_b32 s39, s52, 7
    s_lshr_b32 s52, s51, 1
    s_lshl_b32 s52, s52, 14
    s_add_u32 s39, s39, s52
    s_and_b32 s52, s51, 1
    s_lshl_b32 s52, s52, 12
    s_add_u32 s39, s39, s52
    s_lshr_b32 s52, s16, 1
    s_lshl_b32 s40, s52, 14
    s_and_b32 s52, s16, 1
    s_lshl_b32 s52, s52, 12
    s_add_u32 s40, s40, s52
    s_mul_i32 s41, s16, 327680
    s_lshl_b32 s52, s19, 7
    s_add_u32 s41, s41, s52
    s_lshl_b32 s50, s17, 19
    s_add_u32 s43, s50, 11534336
    s_lshl_b32 s51, s18, 12
    s_add_u32 s44, s50, s51
    s_add_u32 s44, s44, 28311552
    s_lshl_b32 s50, s17, 17
    s_add_u32 s45, s50, 69206016
    s_lshl_b32 s50, s17, 18
    s_lshl_b32 s51, s18, 11
    s_add_u32 s46, s50, s51
    s_add_u32 s46, s46, 73400320
    s_lshl_b32 s50, s17, 1
    s_add_u32 s50, s50, s18
    s_lshl_b32 s50, s50, 7
    s_lshl_b32 s51, s16, 2
    s_add_u32 s47, s50, s51
    s_add_u32 s47, s47, 6307840
    s_mov_b32 s48, 40960
    s_mov_b32 s32, 0
    s_mov_b32 s10, 12288
    s_cmp_eq_u32 s16, 2
    s_cselect_b32 s10, 14336, s10
    s_cselect_b32 s9, s46, s45
    s_lshl_b32 s50, s16, 12
    s_add_u32 s8, s43, s50
    s_cmp_eq_u32 s16, 2
    s_cselect_b32 s8, s44, s8
    s_add_u32 s8, s8, 8192
    s_lshl_b32 s11, s16, 8
    s_add_u32 s11, s11, 122880
    v_and_b32 v52, 1, v108
    v_lshlrev_b32 v52, 4, v52
    v_mov_b32 v53, 0x3f80
    v_lshlrev_b32 v53, v52, v53
    v_bfe_u32 v52, v108, 1, 2
    v_cmp_eq_u32 vcc, 0, v52
    s_nop 1
    v_cndmask_b32 v56, 0, v53, vcc
    v_cmp_eq_u32 vcc, 1, v52
    s_nop 1
    v_cndmask_b32 v57, 0, v53, vcc
    v_cmp_eq_u32 vcc, 2, v52
    s_nop 1
    v_cndmask_b32 v58, 0, v53, vcc
    v_cmp_eq_u32 vcc, 3, v52
    s_nop 1
    v_cndmask_b32 v59, 0, v53, vcc
    ds_write_b128 v15, v[56:59]
    v_and_b32 v56, 7, v108
    v_lshlrev_b32 v56, 4, v56
    v_bfe_u32 v57, v108, 4, 1
    v_lshl_add_u32 v56, v57, 3, v56
    v_mov_b32 v61, 0x7ffffff0
    v_and_b32 v57, 31, v108
    v_lshlrev_b32 v57, 7, v57
    s_cmp_lt_u32 s16, 3
    s_cselect_b32 s50, 32, 0
    v_cmp_gt_u32 vcc, s50, v108
    s_nop 1
    v_cndmask_b32 v57, v61, v57, vcc
    v_mov_b32 v58, 0
    v_mov_b32 v59, 0
    ds_write_b128 v15, v[56:59] offset:1024
    v_lshrrev_b32 v56, 1, v108
    v_and_b32 v57, 1, v108
    v_lshlrev_b32 v57, 6, v57
    v_lshl_add_u32 v53, v56, 14, v57
    v_mov_b32 v52, -1
    v_mov_b32 v54, -1
    v_mov_b32 v55, 0
    v_cmp_lt_u32 vcc, 39, v108
    s_nop 1
    v_cndmask_b32 v53, v53, v61, vcc
    v_cndmask_b32 v54, v54, v55, vcc
    s_cmp_ge_u32 s16, 2
    s_cselect_b32 s50, 20, 99
    s_cmp_lt_i32 s33, 0
    s_cselect_b32 s50, 99, s50
    v_cmp_eq_u32 vcc, s50, v56
    s_nop 1
    v_cndmask_b32 v53, v53, v57, vcc
    v_cndmask_b32 v55, v55, v52, vcc
    v_mov_b32 v57, s47
    v_cmp_eq_u32 vcc, 42, v108
    s_nop 1
    v_cndmask_b32 v53, v53, v57, vcc
    v_cndmask_b32 v52, v52, 0, vcc
    ds_write_b128 v15, v[52:55] offset:2048
    s_waitcnt vmcnt(0)
    v_readlane_b32 s50, v51, 1
    s_and_b32 s51, s50, 1
    s_lshl_b32 s34, s51, 13
    s_lshr_b32 s51, s50, 1
    s_and_b32 s51, s51, 1
    s_lshl_b32 s51, s51, 13
    s_add_u32 s35, s51, 2097152
    s_lshr_b32 s51, s50, 2
    s_and_b32 s51, s51, 1
    s_lshl_b32 s51, s51, 13
    s_add_u32 s49, s51, 4194304
    s_add_u32 s36, s34, 1310720
    s_add_u32 s37, s34, 1343488
    s_add_u32 s38, s34, 1376256
    s_mov_b32 s62, 0
L_kvw_1:
    buffer_load_dword v98, v13, s[4:7], 0 offen sc1
    s_waitcnt vmcnt(0)
    v_cmp_gt_u32 vcc, 1, v98
    s_cbranch_vccz L_kvok_2
    s_sleep 2
    s_add_u32 s62, s62, 1
    s_cmp_lt_u32 s62, 2000000
    s_cbranch_scc1 L_kvw_1
    v_mov_b32 v1, 258
    v_mov_b32 v2, 192
    buffer_store_dword v1, v2, s[12:15], 0 offen sc1
    s_waitcnt vmcnt(0)
    s_endpgm
L_kvok_2:
    s_lshl_b32 s50, s16, 11
    s_add_u32 m0, s48, s50
    s_add_u32 s51, s43, s50
    buffer_load_dwordx4 v1, s[4:7], s51 offen lds
    buffer_load_dwordx4 v1, s[4:7], s51 offen offset:1024 lds
    s_lshr_b32 s50, s50, 1
    s_add_u32 s51, s44, s50
    s_add_u32 s50, s50, 8192
    s_add_u32 m0, s48, s50
    s_nop 0
    buffer_load_dwordx4 v1, s[4:7], s51 offen lds
    s_add_u32 s43, s43, 8192
    s_add_u32 s44, s44, 8192
    s_xor_b32 s48, s48, 122880
    v_cmp_gt_u32 s[100:101], 2, v98
    s_waitcnt lgkmcnt(0)
    ds_read_b128 v[92:95], v15 offset:2048
    s_add_u32 s50, s35, s41
    s_waitcnt lgkmcnt(0)
    s_bfm_b64 exec, 40, 0
    buffer_store_dword v92, v93, s[4:7], s50 offen sc1
    s_mov_b64 exec, -1
    ds_read_b128 v[48:51], v15 offset:4096
    ds_read_b128 v[52:55], v15 offset:5120
    ds_read_b128 v[56:59], v15 offset:6144
    ds_read_b128 v[60:63], v15 offset:7168
    ds_read_b128 v[64:67], v15 offset:8192
    ds_read_b128 v[68:71], v15 offset:9216
    ds_read_b128 v[72:75], v15 offset:10240
    ds_read_b128 v[76:79], v15 offset:11264
    ds_read_b32 v36, v15 offset:1028
    ds_read_b128 v[108:111], v15 offset:2048
    s_add_u32 s59, s49, s41
    s_add_u32 s52, s37, s39
    v_mov_b32 v91, s32
    s_waitcnt lgkmcnt(0)
    v_and_b32 v110, s59, v110
    v_and_b32 v111, s52, v111
    v_add3_u32 v109, v109, v110, v111
    v_or_b32 v108, v108, v91
    v_mov_b64 v[20:21], 0
    v_mov_b64 v[22:23], 0
    v_mov_b64 v[24:25], 0
    v_mov_b64 v[26:27], 0
    v_mov_b64 v[28:29], 0
    v_mov_b64 v[30:31], 0
    s_waitcnt vmcnt(0) lgkmcnt(0)
.p2align 6
L_step:
    s_waitcnt lgkmcnt(0)
    s_barrier
    ds_read_b64_tr_b16 v[80:81], v3 offset:0
    ds_read_b64_tr_b16 v[82:83], v3 offset:512
    ds_read_b64_tr_b16 v[96:97], v3 offset:8
    ds_read_b64_tr_b16 v[98:99], v3 offset:520
    s_cmp_lg_u64 s[100:101], 0
    s_cbranch_scc1 L_kv_slow
L_kv_ready:
    ds_read_b64_tr_b16 v[84:85], v3 offset:1024
    ds_read_b64_tr_b16 v[86:87], v3 offset:1536
    ds_read_b64_tr_b16 v[100:101], v3 offset:1032
    ds_read_b64_tr_b16 v[102:103], v3 offset:1544
    s_waitcnt lgkmcnt(6)
    v_smfmac_f32_16x16x64_bf16 v[20:23], v[80:83], v[48:55], v0
    ds_read_b64_tr_b16 v[88:89], v4 offset:2048
    v_smfmac_f32_16x16x64_bf16 v[24:27], v[80:83], v[56:63], v0
    ds_read_b64_tr_b16 v[90:91], v4 offset:2304
    buffer_load_dword v32, v13, s[4:7], 0 offen sc1
    s_add_u32 s54, s32, 3
    s_min_u32 s54, s54, 64
    s_mov_b32 m0, s11
    s_waitcnt lgkmcnt(6)
    v_smfmac_f32_16x16x64_bf16 v[20:23], v[96:99], v[64:71], v0
    ds_read_b64_tr_b16 v[80:81], v3 offset:2560
    v_smfmac_f32_16x16x64_bf16 v[24:27], v[96:99], v[72:79], v0
    ds_read_b64_tr_b16 v[82:83], v3 offset:3072
    buffer_load_dword v36, s[4:7], s8 offen lds
    s_add_u32 s8, s8, 8192
    s_waitcnt lgkmcnt(6)
    v_smfmac_f32_16x16x64_bf16 v[20:23], v[84:87], a[0:7], v0
    ds_read_b64_tr_b16 v[96:97], v3 offset:2568
    v_smfmac_f32_16x16x64_bf16 v[24:27], v[84:87], a[8:15], v0
    ds_read_b64_tr_b16 v[98:99], v3 offset:3080
    s_waitcnt lgkmcnt(6)
    v_smfmac_f32_16x16x64_bf16 v[20:23], v[100:103], a[16:23], v0
    ds_read_b64_tr_b16 v[84:85], v3 offset:3584
    v_smfmac_f32_16x16x64_bf16 v[24:27], v[100:103], a[24:31], v0
    ds_read_b64_tr_b16 v[86:87], v3 offset:4096
    buffer_store_dword v108, v109, s[4:7], 0 offen sc1
    s_waitcnt lgkmcnt(6)
    v_smfmac_f32_16x16x64_bf16 v[20:23], v[88:91], a[32:39], v0
    ds_read_b64_tr_b16 v[100:101], v3 offset:3592
    v_smfmac_f32_16x16x64_bf16 v[24:27], v[88:91], a[40:47], v0
    ds_read_b64_tr_b16 v[102:103], v3 offset:4104
    s_waitcnt lgkmcnt(6)
    v_smfmac_f32_16x16x64_bf16 v[20:23], v[80:83], a[48:55], v0
    ds_read_b64_tr_b16 v[88:89], v4 offset:4608
    v_smfmac_f32_16x16x64_bf16 v[24:27], v[80:83], a[56:63], v0
    ds_read_b64_tr_b16 v[90:91], v4 offset:4864
    s_waitcnt lgkmcnt(6)
    v_smfmac_f32_16x16x64_bf16 v[20:23], v[96:99], a[64:71], v0
    ds_read_b64_tr_b16 v[80:81], v5 offset:0
    v_smfmac_f32_16x16x64_bf16 v[24:27], v[96:99], a[72:79], v0
    ds_read_b64_tr_b16 v[82:83], v5 offset:512
    s_waitcnt lgkmcnt(6)
    v_smfmac_f32_16x16x64_bf16 v[20:23], v[84:87], a[80:87], v0
    ds_read_b64_tr_b16 v[96:97], v5 offset:8
    v_smfmac_f32_16x16x64_bf16 v[24:27], v[84:87], a[88:95], v0
    ds_read_b64_tr_b16 v[98:99], v5 offset:520
    s_waitcnt lgkmcnt(6)
    v_smfmac_f32_16x16x64_bf16 v[20:23], v[100:103], a[96:103], v0
    ds_read_b64_tr_b16 v[84:85], v5 offset:1024
    v_smfmac_f32_16x16x64_bf16 v[24:27], v[100:103], a[104:111], v0
    ds_read_b64_tr_b16 v[86:87], v5 offset:1536
    s_waitcnt lgkmcnt(6)
    v_smfmac_f32_16x16x64_bf16 v[20:23], v[88:91], a[112:119], v0
    ds_read_b64_tr_b16 v[100:101], v5 offset:1032
    v_smfmac_f32_16x16x64_bf16 v[24:27], v[88:91], a[120:127], v0
    ds_read_b64_tr_b16 v[102:103], v5 offset:1544
    s_waitcnt lgkmcnt(6)
    v_smfmac_f32_16x16x64_bf16 v[20:23], v[80:83], a[128:135], v0
    ds_read_b64_tr_b16 v[88:89], v6 offset:2048
    v_smfmac_f32_16x16x64_bf16 v[24:27], v[80:83], a[136:143], v0
    ds_read_b64_tr_b16 v[90:91], v6 offset:2304
    s_waitcnt lgkmcnt(6)
    v_smfmac_f32_16x16x64_bf16 v[20:23], v[96:99], a[144:151], v0
    ds_read_b64_tr_b16 v[104:105], v5 offset:2560
    v_smfmac_f32_16x16x64_bf16 v[24:27], v[96:99], a[152:159], v0
    ds_read_b64_tr_b16 v[106:107], v5 offset:3072
    s_waitcnt lgkmcnt(6)
    v_smfmac_f32_16x16x64_bf16 v[20:23], v[84:87], a[160:167], v0
    ds_read_b64_tr_b16 v[92:93], v5 offset:2568
    v_smfmac_f32_16x16x64_bf16 v[24:27], v[84:87], a[168:175], v0
    ds_read_b64_tr_b16 v[94:95], v5 offset:3080
    s_waitcnt vmcnt(2)
    s_waitcnt lgkmcnt(6)
    v_smfmac_f32_16x16x64_bf16 v[20:23], v[100:103], a[176:183], v0
    ds_read_b64_tr_b16 v[108:109], v5 offset:3584
    v_smfmac_f32_16x16x64_bf16 v[24:27], v[100:103], a[184:191], v0
    ds_read_b64_tr_b16 v[110:111], v5 offset:4096
    v_cmp_gt_u32 s[100:101], s54, v32
    s_waitcnt lgkmcnt(6)
    v_smfmac_f32_16x16x64_bf16 v[20:23], v[88:91], a[192:199], v0
    ds_read_b64_tr_b16 v[40:41], v5 offset:3592
    v_smfmac_f32_16x16x64_bf16 v[24:27], v[88:91], a[200:207], v0
    ds_read_b64_tr_b16 v[42:43], v5 offset:4104
    s_waitcnt lgkmcnt(6)
    v_smfmac_f32_16x16x64_bf16 v[20:23], v[104:107], a[208:215], v0
    ds_read_b64_tr_b16 v[32:33], v6 offset:4608
    v_smfmac_f32_16x16x64_bf16 v[24:27], v[104:107], a[216:223], v0
    ds_read_b64_tr_b16 v[34:35], v6 offset:4864
    s_waitcnt lgkmcnt(6)
    v_smfmac_f32_16x16x64_bf16 v[20:23], v[92:95], a[224:231], v0
    ds_read_b128 v[48:51], v14 offset:0
    v_smfmac_f32_16x16x64_bf16 v[24:27], v[92:95], a[232:239], v0
    ds_read_b128 v[64:67], v14 offset:4096
    s_waitcnt lgkmcnt(6)
    v_smfmac_f32_16x16x64_bf16 v[20:23], v[108:111], a[240:247], v0
    ds_read_b128 v[52:55], v14 offset:1024
    v_smfmac_f32_16x16x64_bf16 v[24:27], v[108:111], a[248:255], v0
    ds_read_b128 v[68:71], v14 offset:5120
    s_waitcnt lgkmcnt(4)
    v_smfmac_f32_16x16x64_bf16 v[20:23], v[40:43], v[112:119], v0
    ds_read_b128 v[56:59], v14 offset:2048
    v_smfmac_f32_16x16x64_bf16 v[20:23], v[32:35], v[128:135], v0
    ds_read_b128 v[72:75], v14 offset:6144
    v_smfmac_f32_16x16x64_bf16 v[24:27], v[40:43], v[120:127], v0
    ds_read_b128 v[60:63], v14 offset:3072
    v_smfmac_f32_16x16x64_bf16 v[24:27], v[32:35], v[136:143], v0
    ds_read_b128 v[76:79], v14 offset:7168
    v_smfmac_f32_16x16x64_bf16 v[28:31], v[80:83], v[144:151], v0
    s_nop 1
    v_cvt_pk_bf16_f32 v20, v20, v21
    v_cvt_pk_bf16_f32 v21, v22, v23
    v_smfmac_f32_16x16x64_bf16 v[28:31], v[96:99], v[152:159], v0
    ds_write_b64 v7, v[20:21]
    v_cvt_pk_bf16_f32 v24, v24, v25
    v_cvt_pk_bf16_f32 v25, v26, v27
    ds_write_b64 v7, v[24:25] offset:512
    v_smfmac_f32_16x16x64_bf16 v[28:31], v[84:87], v[160:167], v0
    v_smfmac_f32_16x16x64_bf16 v[28:31], v[100:103], v[168:175], v0
    v_smfmac_f32_16x16x64_bf16 v[28:31], v[88:91], v[176:183], v0
    v_smfmac_f32_16x16x64_bf16 v[28:31], v[104:107], v[184:191], v0
    s_waitcnt lgkmcnt(0)
    s_barrier
    ds_read_b64_tr_b16 v[80:81], v8 offset:0
    ds_read_b64_tr_b16 v[82:83], v9 offset:0
    ds_read_b64_tr_b16 v[96:97], v8 offset:2048
    ds_read_b64_tr_b16 v[98:99], v9 offset:2048
    v_smfmac_f32_16x16x64_bf16 v[28:31], v[92:95], v[192:199], v0
    ds_read_b64_tr_b16 v[84:85], v8 offset:512
    ds_read_b64_tr_b16 v[86:87], v9 offset:512
    v_smfmac_f32_16x16x64_bf16 v[28:31], v[108:111], v[200:207], v0
    ds_read_b64_tr_b16 v[100:101], v8 offset:2560
    ds_read_b64_tr_b16 v[102:103], v9 offset:2560
    v_smfmac_f32_16x16x64_bf16 v[28:31], v[40:43], v[208:215], v0
    ds_read_b64_tr_b16 v[88:89], v8 offset:1024
    ds_read_b64_tr_b16 v[90:91], v9 offset:1024
    v_smfmac_f32_16x16x64_bf16 v[28:31], v[32:35], v[216:223], v0
    ds_read_b64_tr_b16 v[104:105], v8 offset:3072
    ds_read_b64_tr_b16 v[106:107], v9 offset:3072
    s_waitcnt lgkmcnt(8)
    v_mfma_f32_16x16x32_bf16 v[36:39], v[96:99], v[80:83], 0
    ds_read_b64_tr_b16 v[92:93], v8 offset:1536
    ds_read_b64_tr_b16 v[94:95], v9 offset:1536
    v_mfma_f32_16x16x32_bf16 v[20:23], v[48:51], v[80:83], 0
    ds_read_b64_tr_b16 v[108:109], v8 offset:3584
    ds_read_b64_tr_b16 v[110:111], v9 offset:3584
    v_mfma_f32_16x16x32_bf16 v[24:27], v[64:67], v[80:83], 0
    ds_read_b128 v[48:51], v14 offset:8192
    s_waitcnt lgkmcnt(9)
    v_mfma_f32_16x16x32_bf16 v[36:39], v[100:103], v[84:87], v[36:39]
    v_cvt_pk_bf16_f32 v28, v28, v29
    v_cvt_pk_bf16_f32 v29, v30, v31
    v_mfma_f32_16x16x32_bf16 v[20:23], v[52:55], v[84:87], v[20:23]
    ds_write_b64 v10, v[28:29]
    v_mfma_f32_16x16x32_bf16 v[24:27], v[68:71], v[84:87], v[24:27]
    ds_read_b128 v[52:55], v14 offset:9216
    s_waitcnt lgkmcnt(7)
    v_mfma_f32_16x16x32_bf16 v[36:39], v[104:107], v[88:91], v[36:39]
    ds_read_b128 v[80:83], v15 offset:12288
    v_mfma_f32_16x16x32_bf16 v[20:23], v[56:59], v[88:91], v[20:23]
    ds_read_b128 v[84:87], v15 offset:13312
    v_mfma_f32_16x16x32_bf16 v[24:27], v[72:75], v[88:91], v[24:27]
    ds_read_b128 v[56:59], v14 offset:10240
    s_waitcnt lgkmcnt(4)
    s_barrier
    s_cmp_eq_u32 s32, 63
    v_mfma_f32_16x16x32_bf16 v[36:39], v[108:111], v[92:95], v[36:39]
    ds_read_b64 v[64:65], v2 offset:14336
    ds_read_b64 v[66:67], v2 offset:14848
    v_mfma_f32_16x16x32_bf16 v[20:23], v[60:63], v[92:95], v[20:23]
    ds_read_b64 v[68:69], v2 offset:15360
    ds_read_b64 v[70:71], v2 offset:15872
    v_mfma_f32_16x16x32_bf16 v[24:27], v[76:79], v[92:95], v[24:27]
    ds_read_b128 v[60:63], v14 offset:11264
    s_cbranch_scc1 L_chain_exit
    v_max3_f32 v32, v36, v37, v38
    s_nop 1
    v_max3_f32 v33, v20, v21, v22
    v_max3_f32 v32, v32, v39, v23
    s_nop 0
    v_max3_f32 v33, v33, v24, v25
    v_max3_f32 v32, v32, v26, v27
    v_max_f32 v34, v32, v33
    v_max_f32 v32, v32, v33
    v_xor_b32 v14, 122880, v14
    s_nop 0
    v_permlane32_swap_b32 v32, v34
    v_max_f32 v33, v32, v34
    v_max_f32 v32, v32, v34
    s_nop 1
    v_permlane16_swap_b32 v32, v33
    v_max_f32 v32, v32, v33
    v_mul_f32 v34, 0xbe0293ee, v32
    v_pk_fma_f32 v[20:21], v[20:21], s[60:61], v[34:35] op_sel_hi:[1,0,0]
    v_pk_fma_f32 v[22:23], v[22:23], s[60:61], v[34:35] op_sel_hi:[1,0,0]
    v_pk_fma_f32 v[24:25], v[24:25], s[60:61], v[34:35] op_sel_hi:[1,0,0]
    v_pk_fma_f32 v[26:27], v[26:27], s[60:61], v[34:35] op_sel_hi:[1,0,0]
    v_exp_f32 v20, v20
    v_exp_f32 v21, v21
    v_exp_f32 v22, v22
    v_exp_f32 v23, v23
    v_exp_f32 v24, v24
    v_exp_f32 v25, v25
    v_exp_f32 v26, v26
    v_exp_f32 v27, v27
    v_pk_fma_f32 v[36:37], v[36:37], s[60:61], v[34:35] op_sel_hi:[1,0,0]
    v_cvt_pk_bf16_f32 v20, v20, v21
    v_cvt_pk_bf16_f32 v21, v22, v23
    v_cvt_pk_bf16_f32 v22, v24, v25
    v_cvt_pk_bf16_f32 v23, v26, v27
    v_pk_fma_f32 v[38:39], v[38:39], s[60:61], v[34:35] op_sel_hi:[1,0,0]
    s_waitcnt lgkmcnt(0)
    v_exp_f32 v36, v36
    v_mfma_f32_16x16x32_bf16 v[28:31], v[44:47], v[20:23], 0
    ds_read_b128 v[72:75], v15 offset:14336
    v_exp_f32 v37, v37
    v_mfma_f32_16x16x32_bf16 v[96:99], v[48:51], v[20:23], 0
    ds_read_b128 v[76:79], v15 offset:15360
    v_exp_f32 v38, v38
    v_mfma_f32_16x16x32_bf16 v[100:103], v[52:55], v[20:23], 0
    ds_read_b128 v[88:91], v15 offset:16384
    v_exp_f32 v39, v39
    v_mfma_f32_16x16x32_bf16 v[104:107], v[56:59], v[20:23], 0
    ds_read_b128 v[92:95], v15 offset:17408
    v_cvt_pk_bf16_f32 v40, v36, v37
    v_cvt_pk_bf16_f32 v41, v38, v39
    v_mfma_f32_16x16x32_bf16 v[108:111], v[60:63], v[20:23], 0
    ds_read_b128 v[48:51], v15 offset:18432
    v_mov_b64 v[20:21], 0
    v_mfma_f32_16x16x16_bf16 v[28:31], v[18:19], v[40:41], v[28:31]
    ds_read_b128 v[52:55], v15 offset:19456
    v_mov_b64 v[22:23], 0
    v_mfma_f32_16x16x16_bf16 v[96:99], v[64:65], v[40:41], v[96:99]
    ds_read_b128 v[56:59], v15 offset:20480
    v_mov_b64 v[24:25], 0
    v_mfma_f32_16x16x16_bf16 v[100:103], v[66:67], v[40:41], v[100:103]
    ds_read_b128 v[60:63], v15 offset:21504
    v_mov_b64 v[26:27], 0
    v_mfma_f32_16x16x16_bf16 v[104:107], v[68:69], v[40:41], v[104:107]
    v_mov_b64 v[32:33], 0
    v_mfma_f32_16x16x16_bf16 v[108:111], v[70:71], v[40:41], v[108:111]
    v_mov_b64 v[34:35], 0
    v_rcp_f32 v42, v28
    v_mov_b64 v[28:29], 0
    v_mov_b64 v[30:31], 0
    v_pk_mul_f32 v[96:97], v[96:97], v[42:43] op_sel_hi:[1,0]
    v_pk_mul_f32 v[98:99], v[98:99], v[42:43] op_sel_hi:[1,0]
    v_pk_mul_f32 v[100:101], v[100:101], v[42:43] op_sel_hi:[1,0]
    v_pk_mul_f32 v[102:103], v[102:103], v[42:43] op_sel_hi:[1,0]
    v_cvt_pk_bf16_f32 v96, v96, v97
    v_cvt_pk_bf16_f32 v97, v98, v99
    v_cvt_pk_bf16_f32 v98, v100, v101
    v_cvt_pk_bf16_f32 v99, v102, v103
    v_pk_mul_f32 v[104:105], v[104:105], v[42:43] op_sel_hi:[1,0]
    v_pk_mul_f32 v[106:107], v[106:107], v[42:43] op_sel_hi:[1,0]
    s_waitcnt lgkmcnt(14)
    v_smfmac_f32_16x16x64_bf16 v[20:23], v[96:99], v[80:87], v0
    ds_read_b128 v[64:67], v15 offset:22528
    v_pk_mul_f32 v[108:109], v[108:109], v[42:43] op_sel_hi:[1,0]
    v_pk_mul_f32 v[110:111], v[110:111], v[42:43] op_sel_hi:[1,0]
    s_waitcnt lgkmcnt(7)
    v_smfmac_f32_16x16x64_bf16 v[24:27], v[96:99], v[72:79], v0
    ds_read_b128 v[68:71], v15 offset:23552
    v_cvt_pk_bf16_f32 v100, v104, v105
    v_cvt_pk_bf16_f32 v101, v106, v107
    s_waitcnt lgkmcnt(6)
    v_smfmac_f32_16x16x64_bf16 v[28:31], v[96:99], v[88:95], v0
    v_cvt_pk_bf16_f32 v102, v108, v109
    v_cvt_pk_bf16_f32 v103, v110, v111
    s_waitcnt lgkmcnt(4)
    s_nop 0
    v_smfmac_f32_16x16x64_bf16 v[20:23], v[100:103], v[48:55], v0
    s_add_u32 s50, s34, s41
    s_add_u32 s51, s50, 131072
    v_mov_b64 v[36:37], 0
    s_waitcnt lgkmcnt(2)
    v_smfmac_f32_16x16x64_bf16 v[24:27], v[100:103], v[56:63], v0
    s_add_u32 s52, s50, 262144
    s_mov_b32 s55, 0xfffffffe
    v_mov_b64 v[38:39], 0
    s_waitcnt lgkmcnt(0)
    v_smfmac_f32_16x16x64_bf16 v[32:35], v[96:99], v[64:71], v0
    s_add_u32 s32, s32, 1
    s_add_u32 s53, s34, s42
    v_smfmac_f32_16x16x64_bf16 v[28:31], v[100:103], v[224:231], v0
    s_add_u32 s54, s53, 4096
    s_add_u32 s58, s36, s39
    v_cvt_pk_bf16_f32 v20, v20, v21
    v_cvt_pk_bf16_f32 v21, v22, v23
    v_min_u32 v20, s55, v20
    v_smfmac_f32_16x16x64_bf16 v[32:35], v[100:103], v[232:239], v0
    v_cvt_pk_bf16_f32 v22, v24, v25
    v_cvt_pk_bf16_f32 v23, v26, v27
    buffer_store_dwordx4 v[20:23], v11, s[4:7], s50 offen sc1
    v_smfmac_f32_16x16x64_bf16 v[36:39], v[96:99], v[240:247], v0
    v_smfmac_f32_16x16x64_bf16 v[36:39], v[100:103], v[248:255], v0
    s_cmp_ge_u32 s16, 2
    v_cvt_pk_bf16_f32 v28, v28, v29
    v_cvt_pk_bf16_f32 v29, v30, v31
    v_min_u32 v28, s55, v28
    v_cvt_pk_bf16_f32 v30, v32, v33
    v_cvt_pk_bf16_f32 v31, v34, v35
    buffer_store_dwordx4 v[28:31], v11, s[4:7], s51 offen sc1
    s_nop 0
    v_cvt_pk_bf16_f32 v36, v36, v37
    v_cvt_pk_bf16_f32 v37, v38, v39
    v_min_u32 v36, s55, v36
    buffer_store_dwordx2 v[36:37], v12, s[4:7], s52 offen sc1
    s_cbranch_scc1 L_house
    s_cmp_lt_i32 s33, 0
    s_cbranch_scc1 L_plain
    ds_read_b128 v[80:83], v15
    ds_read_b32 v84, v15 offset:1024
    s_mov_b32 s62, 0
    s_waitcnt vmcnt(2)
    s_cmp_eq_u32 s16, 1
    s_cbranch_scc1 L_sel
    s_waitcnt vmcnt(0)
L_sel:
    s_sleep 2
L_poll1:
    buffer_load_dwordx4 v[48:51], v1, s[4:7], s53 offen offset:0 sc1
    buffer_load_dwordx4 v[52:55], v1, s[4:7], s53 offen offset:1024 sc1
    buffer_load_dwordx4 v[56:59], v1, s[4:7], s53 offen offset:2048 sc1
    buffer_load_dwordx4 v[60:63], v1, s[4:7], s53 offen offset:3072 sc1
    buffer_load_dwordx4 v[64:67], v1, s[4:7], s54 offen offset:0 sc1
    buffer_load_dwordx4 v[68:71], v1, s[4:7], s54 offen offset:1024 sc1
    buffer_load_dwordx4 v[72:75], v1, s[4:7], s54 offen offset:2048 sc1
    buffer_load_dwordx4 v[76:79], v1, s[4:7], s54 offen offset:3072 sc1
    s_waitcnt lgkmcnt(0)
    s_waitcnt vmcnt(7)
    v_mfma_f32_16x16x32_bf16 v[24:27], v[80:83], v[48:51], 0
    s_waitcnt vmcnt(6)
    v_mfma_f32_16x16x32_bf16 v[24:27], v[80:83], v[52:55], v[24:27]
    v_max_u32 v86, v48, v52
    s_waitcnt vmcnt(5)
    v_mfma_f32_16x16x32_bf16 v[24:27], v[80:83], v[56:59], v[24:27]
    s_waitcnt vmcnt(4)
    v_mfma_f32_16x16x32_bf16 v[24:27], v[80:83], v[60:63], v[24:27]
    v_max3_u32 v86, v86, v56, v60
    s_waitcnt vmcnt(3)
    v_mfma_f32_16x16x32_bf16 v[24:27], v[80:83], v[64:67], v[24:27]
    s_waitcnt vmcnt(2)
    v_mfma_f32_16x16x32_bf16 v[24:27], v[80:83], v[68:71], v[24:27]
    v_max3_u32 v86, v86, v64, v68
    s_waitcnt vmcnt(1)
    v_mfma_f32_16x16x32_bf16 v[24:27], v[80:83], v[72:75], v[24:27]
    s_waitcnt vmcnt(0)
    v_max3_u32 v86, v86, v72, v76
    v_mfma_f32_16x16x32_bf16 v[24:27], v[80:83], v[76:79], v[24:27]
    v_cmp_eq_u32 vcc, -1, v86
    s_nop 6
    v_add_f32_dpp v28, v24, v24 row_ror:8 row_mask:0xf bank_mask:0xf
    v_add_f32_dpp v29, v25, v25 row_ror:8 row_mask:0xf bank_mask:0xf
    v_add_f32_dpp v30, v26, v26 row_ror:8 row_mask:0xf bank_mask:0xf
    v_add_f32_dpp v31, v27, v27 row_ror:8 row_mask:0xf bank_mask:0xf
    v_cvt_pk_bf16_f32 v28, v28, v29
    v_cvt_pk_bf16_f32 v29, v30, v31
    v_min_u32 v28, s55, v28
    s_cbranch_vccnz L_retry1
    s_mov_b64 exec, 0x00ff00ff
    buffer_store_dwordx2 v[28:29], v84, s[4:7], s58 offen sc1
    s_mov_b64 exec, -1
    s_barrier
    s_mov_b32 s51, s34
    s_mov_b32 s34, s35
    s_mov_b32 s35, s49
    s_mov_b32 s49, s51
    s_add_u32 s50, s36, s40
    s_mov_b32 s51, s36
    s_mov_b32 s36, s37
    s_mov_b32 s37, s38
    s_mov_b32 s38, s51
    ds_read_b128 v[48:51], v15 offset:4096
    ds_read_b128 v[52:55], v15 offset:5120
    ds_read_b128 v[56:59], v15 offset:6144
    ds_read_b128 v[60:63], v15 offset:7168
    ds_read_b128 v[64:67], v15 offset:8192
    ds_read_b128 v[68:71], v15 offset:9216
    ds_read_b128 v[72:75], v15 offset:10240
    ds_read_b128 v[76:79], v15 offset:11264
    ds_read_b32 v36, v15 offset:1028
    ds_read_b128 v[108:111], v15 offset:2048
    s_add_u32 s59, s49, s41
    s_add_u32 s52, s37, s39
    v_mov_b32 v91, s32
    s_waitcnt lgkmcnt(0)
    v_and_b32 v110, s59, v110
    v_and_b32 v111, s52, v111
    v_add3_u32 v109, v109, v110, v111
    v_or_b32 v108, v108, v91
    v_mov_b64 v[20:21], 0
    v_mov_b64 v[22:23], 0
    v_mov_b64 v[24:25], 0
    v_mov_b64 v[26:27], 0
    v_mov_b64 v[28:29], 0
    v_mov_b64 v[30:31], 0
    s_sleep 5
L_gather:
    buffer_load_dwordx4 v[80:83], v1, s[4:7], s50 offen sc1
    buffer_load_dwordx4 v[84:87], v1, s[4:7], s50 offen offset:1024 sc1
    buffer_load_dwordx2 v[88:89], v2, s[4:7], s50 offen offset:2048 sc1
    s_mov_b32 s62, 0
    s_waitcnt vmcnt(2)
    ds_write_b128 v16, v[80:83]
    s_waitcnt vmcnt(1)
    ds_write_b128 v16, v[84:87] offset:1024
    s_waitcnt vmcnt(0)
    ds_write_b64 v17, v[88:89]
    v_max3_u32 v90, v80, v84, v88
    v_cmp_eq_u32 vcc, -1, v90
    s_cbranch_vccnz L_retry2
L_got2:
    s_branch L_step
L_house:
    s_and_b32 s50, s16, 1
    s_lshl_b32 s50, s50, 12
    s_add_u32 m0, s48, s50
    s_add_u32 s51, s43, s50
    buffer_load_dwordx4 v1, s[4:7], s51 offen offset:0 lds
    buffer_load_dwordx4 v1, s[4:7], s51 offen offset:1024 lds
    buffer_load_dwordx4 v1, s[4:7], s51 offen offset:2048 lds
    buffer_load_dwordx4 v1, s[4:7], s51 offen offset:3072 lds
    s_lshr_b32 s50, s50, 1
    s_add_u32 s51, s44, s50
    s_add_u32 s50, s50, 8192
    s_add_u32 m0, s48, s50
    s_nop 0
    buffer_load_dwordx4 v1, s[4:7], s51 offen offset:0 lds
    buffer_load_dwordx4 v1, s[4:7], s51 offen offset:1024 lds
    v_add_u32 v64, s10, v1
    ds_read_b128 v[48:51], v64
    ds_read_b128 v[52:55], v64 offset:1024
    s_cmp_eq_u32 s16, 3
    s_cselect_b32 s50, s18, 0
    s_cmp_lg_u32 s50, 0
    s_cbranch_scc1 L_house2
    s_waitcnt lgkmcnt(0)
    buffer_store_dwordx4 v[48:51], v1, s[4:7], s9 offen sc1
    buffer_store_dwordx4 v[52:55], v1, s[4:7], s9 offen offset:1024 sc1
L_house2:
    s_mov_b32 s50, 2048
    s_cmp_eq_u32 s16, 2
    s_cselect_b32 s50, 4096, s50
    s_add_u32 s9, s9, s50
    s_waitcnt lgkmcnt(0)
    s_add_u32 s43, s43, 8192
    s_add_u32 s44, s44, 8192
    s_xor_b32 s48, s48, 122880
    s_branch L_plain2
L_plain:
L_plain2:
    s_mov_b32 s51, s34
    s_mov_b32 s34, s35
    s_mov_b32 s35, s49
    s_mov_b32 s49, s51
    s_add_u32 s50, s36, s40
    s_mov_b32 s51, s36
    s_mov_b32 s36, s37
    s_mov_b32 s37, s38
    s_mov_b32 s38, s51
    ds_read_b128 v[48:51], v15 offset:4096
    ds_read_b128 v[52:55], v15 offset:5120
    ds_read_b128 v[56:59], v15 offset:6144
    ds_read_b128 v[60:63], v15 offset:7168
    ds_read_b128 v[64:67], v15 offset:8192
    ds_read_b128 v[68:71], v15 offset:9216
    ds_read_b128 v[72:75], v15 offset:10240
    ds_read_b128 v[76:79], v15 offset:11264
    ds_read_b32 v36, v15 offset:1028
    ds_read_b128 v[108:111], v15 offset:2048
    s_add_u32 s59, s49, s41
    s_add_u32 s52, s37, s39
    v_mov_b32 v91, s32
    s_waitcnt lgkmcnt(0)
    v_and_b32 v110, s59, v110
    v_and_b32 v111, s52, v111
    v_add3_u32 v109, v109, v110, v111
    v_or_b32 v108, v108, v91
    v_mov_b64 v[20:21], 0
    v_mov_b64 v[22:23], 0
    v_mov_b64 v[24:25], 0
    v_mov_b64 v[26:27], 0
    v_mov_b64 v[28:29], 0
    v_mov_b64 v[30:31], 0
    s_barrier
    s_sleep 8
    s_branch L_gather
L_kv_slow:
    s_add_u32 s54, s32, 2
    s_min_u32 s54, s54, 64
    s_mov_b32 s62, 0
L_kvw_3:
    buffer_load_dword v32, v13, s[4:7], 0 offen sc1
    s_waitcnt vmcnt(0)
    v_cmp_gt_u32 vcc, s54, v32
    s_cbranch_vccz L_kvok_4
    s_sleep 2
    s_add_u32 s62, s62, 1
    s_cmp_lt_u32 s62, 2000000
    s_cbranch_scc1 L_kvw_3
    v_mov_b32 v1, 259
    v_mov_b32 v2, 192
    buffer_store_dword v1, v2, s[12:15], 0 offen sc1
    s_waitcnt vmcnt(0)
    s_endpgm
L_kvok_4:
    s_branch L_kv_ready
L_retry1:
    s_waitcnt vmcnt(0)
    s_add_u32 s62, s62, 1
    s_cmp_lt_u32 s62, 2000000
    s_cbranch_scc1 L_poll1
    v_mov_b32 v1, 260
    v_mov_b32 v2, 192
    buffer_store_dword v1, v2, s[12:15], 0 offen sc1
    s_waitcnt vmcnt(0)
    s_endpgm
L_retry2:
L_poll2:
    buffer_load_dwordx4 v[80:83], v1, s[4:7], s50 offen sc1
    buffer_load_dwordx4 v[84:87], v1, s[4:7], s50 offen offset:1024 sc1
    buffer_load_dwordx2 v[88:89], v2, s[4:7], s50 offen offset:2048 sc1
    s_waitcnt vmcnt(2)
    ds_write_b128 v16, v[80:83]
    s_waitcnt vmcnt(1)
    ds_write_b128 v16, v[84:87] offset:1024
    s_waitcnt vmcnt(0)
    ds_write_b64 v17, v[88:89]
    v_max3_u32 v90, v80, v84, v88
    v_cmp_eq_u32 vcc, -1, v90
    s_cbranch_vccz L_got2
    s_add_u32 s62, s62, 1
    s_cmp_lt_u32 s62, 2000000
    s_cbranch_scc1 L_poll2
    v_mov_b32 v1, 261
    v_mov_b32 v2, 192
    buffer_store_dword v1, v2, s[12:15], 0 offen sc1
    s_waitcnt vmcnt(0)
    s_endpgm
L_chain_exit:
    s_cmp_lt_u32 s16, 2
    s_cbranch_scc1 L_exit_flag
    v_add_u32 v64, s10, v1
    ds_read_b128 v[48:51], v64
    ds_read_b128 v[52:55], v64 offset:1024
    s_cmp_eq_u32 s16, 3
    s_cselect_b32 s50, s18, 0
    s_cmp_lg_u32 s50, 0
    s_cbranch_scc1 L_exit_flag
    s_waitcnt lgkmcnt(0)
    buffer_store_dwordx4 v[48:51], v1, s[4:7], s9 offen sc1
    buffer_store_dwordx4 v[52:55], v1, s[4:7], s9 offen offset:1024 sc1
L_exit_flag:
    s_waitcnt vmcnt(0)
    v_mov_b32 v64, 64
    s_mov_b64 exec, 1
    buffer_store_dword v64, v1, s[4:7], s47 offen sc1
    s_waitcnt vmcnt(0)
    s_endpgm
L_side_a_rest:
    s_mul_i32 s19, s20, 6
    s_add_u32 s19, s19, s21
    s_add_u32 s19, s19, 24
    s_mov_b32 s18, 3
    s_cmp_lt_u32 s21, 22
    s_cbranch_scc1 L_aux
    s_cmp_lg_u32 s2, 251
    s_cbranch_scc1 L_exit
    v_and_b32 v10, 63, v0
    v_mov_b32 v3, 0
    v_mov_b32 v4, -1
    v_mov_b32 v5, -1
    ds_write_b64 v3, v[4:5]
    v_mov_b32 v5, 0
    s_waitcnt lgkmcnt(0)
    s_cmp_lg_u32 s16, 0
    s_cbranch_scc1 L_ww_5
    s_mov_b32 s62, 0
L_pw_6:
    buffer_load_dword v6, v5, s[12:15], 0 offen sc1
    s_waitcnt vmcnt(0)
    v_cmp_gt_u32 vcc, 64, v6
    s_cbranch_vccz L_pok_7
    s_sleep 12
    s_add_u32 s62, s62, 1
    s_cmp_lt_u32 s62, 2000000
    s_cbranch_scc1 L_pw_6
    v_mov_b32 v1, 514
    v_mov_b32 v2, 192
    buffer_store_dword v1, v2, s[12:15], 0 offen sc1
    s_waitcnt vmcnt(0)
    s_endpgm
L_pok_7:
L_ww_5:
    s_barrier
    s_and_b32 s25, s16, 1
    s_lshl_b32 s26, s25, 2
    v_mov_b32 v8, s26
    s_lshl_b32 s20, s25, 13
    s_lshr_b32 s21, s16, 1
    s_lshl_b32 s21, s21, 8
    s_add_u32 s20, s20, s21
    s_add_u32 s20, s20, 1835008
    s_mov_b32 s24, 0
    s_mov_b64 exec, 1
    buffer_load_dword v16, v3, s[4:7], s20 offen offset:128 sc1
    s_waitcnt vmcnt(0)
L_probe:
    s_and_b32 s22, s24, 15
    s_lshl_b32 s22, s22, 9
    s_lshr_b32 s23, s24, 4
    s_lshl_b32 s23, s23, 14
    s_add_u32 s22, s22, s23
    s_add_u32 s22, s22, s20
    s_memtime s[26:27]
    s_waitcnt lgkmcnt(0)
    buffer_load_dword v16, v3, s[4:7], s22 offen sc1
    s_waitcnt vmcnt(0)
    s_memtime s[28:29]
    s_waitcnt lgkmcnt(0)
    s_sub_u32 s23, s28, s26
    v_mov_b32 v7, s23
    ds_min_u32 v8, v7
    s_waitcnt lgkmcnt(0)
    s_barrier
    ds_read_b64 v[6:7], v3
    s_waitcnt lgkmcnt(0)
    v_readfirstlane_b32 s26, v6
    v_readfirstlane_b32 s27, v7
    s_barrier
    s_add_u32 s24, s24, 1
    s_cmp_lt_u32 s24, 3
    s_cbranch_scc1 L_probe
    s_sub_i32 s28, s26, s27
    s_abs_i32 s28, s28
    s_min_u32 s29, s26, s27
    s_lshr_b32 s29, s29, 2
    s_cmp_ge_u32 s28, s29
    s_cbranch_scc1 L_probe_end
    s_cmp_lt_u32 s24, 32
    s_cbranch_scc1 L_probe
L_probe_end:
    s_cmp_lt_u32 s26, s27
    s_cselect_b32 s21, 2, 5
    s_or_b32 s21, s21, 0x80000000
    v_mov_b32 v2, s21
    v_mov_b32 v5, 132
    buffer_store_dword v2, v5, s[12:15], 0 offen sc1
    s_mov_b64 exec, -1
    s_endpgm
L_side_b:
    s_sub_u32 s20, s20, 4
    s_cmp_lt_u32 s21, 10
    s_cbranch_scc1 L_role_fin
    s_lshl_b32 s17, s20, 3
    s_add_u32 s17, s17, s21
    s_sub_u32 s17, s17, 10
    s_cmp_lt_u32 s21, 18
    s_cbranch_scc1 L_role_V
    s_sub_u32 s17, s17, 8
    s_cmp_lt_u32 s21, 26
    s_cbranch_scc1 L_role_Q
    s_sub_u32 s22, s21, 26
    s_lshl_b32 s17, s20, 2
    s_sub_u32 s23, s20, 2
    s_max_i32 s23, s23, 0
    s_sub_u32 s17, s17, s23
    s_cmp_lt_u32 s20, 2
    s_cselect_b32 s24, 4, 3
    s_add_u32 s17, s17, s22
    s_cmp_lt_u32 s22, s24
    s_cbranch_scc1 L_role_F
    s_lshl_b32 s17, s20, 1
    s_add_u32 s17, s17, s23
    s_add_u32 s17, s17, s22
    s_sub_u32 s17, s17, s24
    s_add_u32 s17, s17, 14
L_role_P:
    v_and_b32 v10, 63, v0
    v_lshlrev_b32 v1, 4, v10
    s_endpgm
L_role_Q:
    v_and_b32 v10, 63, v0
    v_lshlrev_b32 v1, 4, v10
    s_sub_u32 s50, s17, 0
    s_lshl_b32 s50, s50, 2
    s_add_u32 s50, s50, s16
    s_bitcmp1_b32 s50, 3
    s_cselect_b32 s24, s68, s70
    s_cselect_b32 s25, s69, s71
    s_mov_b32 s20, s24
    s_and_b32 s21, s25, 0xffff
    s_mov_b32 s22, 0x500000
    s_mov_b32 s23, 0x20000
    v_lshrrev_b32 v11, 4, v10
    v_lshlrev_b32 v11, 13, v11
    v_and_b32 v12, 15, v10
    v_lshl_add_u32 v11, v12, 4, v11
    s_and_b32 s51, s50, 7
    s_lshl_b32 s51, s51, 10
    s_add_u32 s51, s51, 256
    s_lshr_b32 s52, s50, 4
    s_mul_i32 s52, s52, 20
    s_add_u32 s53, s52, 0
    s_lshl_b32 s53, s53, 15
    s_add_u32 s53, s53, s51
    buffer_load_dwordx4 v[16:19], v11, s[20:23], s53 offen
    s_add_u32 s53, s52, 1
    s_lshl_b32 s53, s53, 15
    s_add_u32 s53, s53, s51
    buffer_load_dwordx4 v[16:19], v11, s[20:23], s53 offen
    s_add_u32 s53, s52, 2
    s_lshl_b32 s53, s53, 15
    s_add_u32 s53, s53, s51
    buffer_load_dwordx4 v[16:19], v11, s[20:23], s53 offen
    s_add_u32 s53, s52, 3
    s_lshl_b32 s53, s53, 15
    s_add_u32 s53, s53, s51
    buffer_load_dwordx4 v[16:19], v11, s[20:23], s53 offen
    s_add_u32 s53, s52, 4
    s_lshl_b32 s53, s53, 15
    s_add_u32 s53, s53, s51
    buffer_load_dwordx4 v[16:19], v11, s[20:23], s53 offen
    s_add_u32 s53, s52, 5
    s_lshl_b32 s53, s53, 15
    s_add_u32 s53, s53, s51
    buffer_load_dwordx4 v[16:19], v11, s[20:23], s53 offen
    s_add_u32 s53, s52, 6
    s_lshl_b32 s53, s53, 15
    s_add_u32 s53, s53, s51
    buffer_load_dwordx4 v[16:19], v11, s[20:23], s53 offen
    s_add_u32 s53, s52, 7
    s_lshl_b32 s53, s53, 15
    s_add_u32 s53, s53, s51
    buffer_load_dwordx4 v[16:19], v11, s[20:23], s53 offen
    s_add_u32 s53, s52, 8
    s_lshl_b32 s53, s53, 15
    s_add_u32 s53, s53, s51
    buffer_load_dwordx4 v[16:19], v11, s[20:23], s53 offen
    s_add_u32 s53, s52, 9
    s_lshl_b32 s53, s53, 15
    s_add_u32 s53, s53, s51
    buffer_load_dwordx4 v[16:19], v11, s[20:23], s53 offen
    s_add_u32 s53, s52, 10
    s_lshl_b32 s53, s53, 15
    s_add_u32 s53, s53, s51
    buffer_load_dwordx4 v[16:19], v11, s[20:23], s53 offen
    s_add_u32 s53, s52, 11
    s_lshl_b32 s53, s53, 15
    s_add_u32 s53, s53, s51
    buffer_load_dwordx4 v[16:19], v11, s[20:23], s53 offen
    s_add_u32 s53, s52, 12
    s_lshl_b32 s53, s53, 15
    s_add_u32 s53, s53, s51
    buffer_load_dwordx4 v[16:19], v11, s[20:23], s53 offen
    s_add_u32 s53, s52, 13
    s_lshl_b32 s53, s53, 15
    s_add_u32 s53, s53, s51
    buffer_load_dwordx4 v[16:19], v11, s[20:23], s53 offen
    s_add_u32 s53, s52, 14
    s_lshl_b32 s53, s53, 15
    s_add_u32 s53, s53, s51
    buffer_load_dwordx4 v[16:19], v11, s[20:23], s53 offen
    s_add_u32 s53, s52, 15
    s_lshl_b32 s53, s53, 15
    s_add_u32 s53, s53, s51
    buffer_load_dwordx4 v[16:19], v11, s[20:23], s53 offen
    s_add_u32 s53, s52, 16
    s_lshl_b32 s53, s53, 15
    s_add_u32 s53, s53, s51
    buffer_load_dwordx4 v[16:19], v11, s[20:23], s53 offen
    s_add_u32 s53, s52, 17
    s_lshl_b32 s53, s53, 15
    s_add_u32 s53, s53, s51
    buffer_load_dwordx4 v[16:19], v11, s[20:23], s53 offen
    s_add_u32 s53, s52, 18
    s_lshl_b32 s53, s53, 15
    s_add_u32 s53, s53, s51
    buffer_load_dwordx4 v[16:19], v11, s[20:23], s53 offen
    s_add_u32 s53, s52, 19
    s_lshl_b32 s53, s53, 15
    s_add_u32 s53, s53, s51
    buffer_load_dwordx4 v[16:19], v11, s[20:23], s53 offen
    s_waitcnt vmcnt(30)
    s_mov_b32 s8, s74
    s_and_b32 s9, s75, 0xffff
    s_mov_b32 s10, 0x500000
    s_mov_b32 s11, 0x20000
    s_mul_i32 s50, s50, 40960
    buffer_load_dwordx4 v[16:19], v1, s[8:11], s50 offen offset:0
    buffer_load_dwordx4 v[16:19], v1, s[8:11], s50 offen offset:1024
    buffer_load_dwordx4 v[16:19], v1, s[8:11], s50 offen offset:2048
    buffer_load_dwordx4 v[16:19], v1, s[8:11], s50 offen offset:3072
    s_add_u32 s50, s50, 4096
    buffer_load_dwordx4 v[16:19], v1, s[8:11], s50 offen offset:0
    buffer_load_dwordx4 v[16:19], v1, s[8:11], s50 offen offset:1024
    buffer_load_dwordx4 v[16:19], v1, s[8:11], s50 offen offset:2048
    buffer_load_dwordx4 v[16:19], v1, s[8:11], s50 offen offset:3072
    s_add_u32 s50, s50, 4096
    buffer_load_dwordx4 v[16:19], v1, s[8:11], s50 offen offset:0
    buffer_load_dwordx4 v[16:19], v1, s[8:11], s50 offen offset:1024
    buffer_load_dwordx4 v[16:19], v1, s[8:11], s50 offen offset:2048
    buffer_load_dwordx4 v[16:19], v1, s[8:11], s50 offen offset:3072
    s_add_u32 s50, s50, 4096
    buffer_load_dwordx4 v[16:19], v1, s[8:11], s50 offen offset:0
    buffer_load_dwordx4 v[16:19], v1, s[8:11], s50 offen offset:1024
    buffer_load_dwordx4 v[16:19], v1, s[8:11], s50 offen offset:2048
    buffer_load_dwordx4 v[16:19], v1, s[8:11], s50 offen offset:3072
    s_add_u32 s50, s50, 4096
    buffer_load_dwordx4 v[16:19], v1, s[8:11], s50 offen offset:0
    buffer_load_dwordx4 v[16:19], v1, s[8:11], s50 offen offset:1024
    buffer_load_dwordx4 v[16:19], v1, s[8:11], s50 offen offset:2048
    buffer_load_dwordx4 v[16:19], v1, s[8:11], s50 offen offset:3072
    s_add_u32 s50, s50, 4096
    buffer_load_dwordx4 v[16:19], v1, s[8:11], s50 offen offset:0
    buffer_load_dwordx4 v[16:19], v1, s[8:11], s50 offen offset:1024
    buffer_load_dwordx4 v[16:19], v1, s[8:11], s50 offen offset:2048
    buffer_load_dwordx4 v[16:19], v1, s[8:11], s50 offen offset:3072
    s_add_u32 s50, s50, 4096
    buffer_load_dwordx4 v[16:19], v1, s[8:11], s50 offen offset:0
    buffer_load_dwordx4 v[16:19], v1, s[8:11], s50 offen offset:1024
    buffer_load_dwordx4 v[16:19], v1, s[8:11], s50 offen offset:2048
    buffer_load_dwordx4 v[16:19], v1, s[8:11], s50 offen offset:3072
    s_add_u32 s50, s50, 4096
    buffer_load_dwordx4 v[16:19], v1, s[8:11], s50 offen offset:0
    buffer_load_dwordx4 v[16:19], v1, s[8:11], s50 offen offset:1024
    buffer_load_dwordx4 v[16:19], v1, s[8:11], s50 offen offset:2048
    buffer_load_dwordx4 v[16:19], v1, s[8:11], s50 offen offset:3072
    s_add_u32 s50, s50, 4096
    s_waitcnt vmcnt(54)
    buffer_load_dwordx4 v[16:19], v1, s[8:11], s50 offen offset:0
    buffer_load_dwordx4 v[16:19], v1, s[8:11], s50 offen offset:1024
    buffer_load_dwordx4 v[16:19], v1, s[8:11], s50 offen offset:2048
    buffer_load_dwordx4 v[16:19], v1, s[8:11], s50 offen offset:3072
    s_add_u32 s50, s50, 4096
    buffer_load_dwordx4 v[16:19], v1, s[8:11], s50 offen offset:0
    buffer_load_dwordx4 v[16:19], v1, s[8:11], s50 offen offset:1024
    buffer_load_dwordx4 v[16:19], v1, s[8:11], s50 offen offset:2048
    buffer_load_dwordx4 v[16:19], v1, s[8:11], s50 offen offset:3072
    s_waitcnt vmcnt(0)
    v_mov_b32 v5, 132
    s_mov_b32 s20, 0x80000000
    s_cmp_lg_u32 s16, 0
    s_cbranch_scc1 L_ww_8
    s_mov_b32 s62, 0
L_pw_9:
    buffer_load_dword v6, v5, s[12:15], 0 offen sc1
    s_waitcnt vmcnt(0)
    v_cmp_gt_u32 vcc, s20, v6
    s_cbranch_vccz L_pok_10
    s_sleep 32
    s_add_u32 s62, s62, 1
    s_cmp_lt_u32 s62, 2000000
    s_cbranch_scc1 L_pw_9
    v_mov_b32 v1, 534
    v_mov_b32 v2, 192
    buffer_store_dword v1, v2, s[12:15], 0 offen sc1
    s_waitcnt vmcnt(0)
    s_endpgm
L_pok_10:
L_ww_8:
    s_barrier
    v_lshrrev_b32 v11, 4, v10
    v_lshlrev_b32 v12, 2, v11
    v_sub_u32 v12, v10, v12
    v_and_b32 v12, 15, v12
    s_lshl_b32 s50, s16, 2
    v_add_u32 v11, s50, v11
    s_lshl_b32 s32, s16, 10
    s_mov_b32 s8, s68
    s_and_b32 s9, s69, 0xffff
    s_mov_b32 s10, 0x500000
    s_mov_b32 s11, 0x20000
    v_lshlrev_b32 v11, 13, v11
    v_lshl_add_u32 v13, v12, 4, v11
    s_lshl_b32 s50, s17, 8
    s_add_u32 m0, s32, 0
    s_add_u32 s51, s50, 0
    buffer_load_dwordx4 v13, s[8:11], s51 offen lds
    s_add_u32 m0, s32, 4096
    s_add_u32 s51, s50, 131072
    buffer_load_dwordx4 v13, s[8:11], s51 offen lds
    s_add_u32 m0, s32, 8192
    s_add_u32 s51, s50, 262144
    buffer_load_dwordx4 v13, s[8:11], s51 offen lds
    s_add_u32 m0, s32, 12288
    s_add_u32 s51, s50, 393216
    buffer_load_dwordx4 v13, s[8:11], s51 offen lds
    s_add_u32 m0, s32, 16384
    s_add_u32 s51, s50, 524288
    buffer_load_dwordx4 v13, s[8:11], s51 offen lds
    s_add_u32 m0, s32, 20480
    s_add_u32 s51, s50, 655360
    buffer_load_dwordx4 v13, s[8:11], s51 offen lds
    s_add_u32 m0, s32, 24576
    s_add_u32 s51, s50, 786432
    buffer_load_dwordx4 v13, s[8:11], s51 offen lds
    s_add_u32 m0, s32, 28672
    s_add_u32 s51, s50, 917504
    buffer_load_dwordx4 v13, s[8:11], s51 offen lds
    s_add_u32 m0, s32, 32768
    s_add_u32 s51, s50, 1048576
    buffer_load_dwordx4 v13, s[8:11], s51 offen lds
    s_add_u32 m0, s32, 36864
    s_add_u32 s51, s50, 1179648
    buffer_load_dwordx4 v13, s[8:11], s51 offen lds
    s_add_u32 m0, s32, 40960
    s_add_u32 s51, s50, 1310720
    buffer_load_dwordx4 v13, s[8:11], s51 offen lds
    s_add_u32 m0, s32, 45056
    s_add_u32 s51, s50, 1441792
    buffer_load_dwordx4 v13, s[8:11], s51 offen lds
    s_add_u32 m0, s32, 49152
    s_add_u32 s51, s50, 1572864
    buffer_load_dwordx4 v13, s[8:11], s51 offen lds
    s_add_u32 m0, s32, 53248
    s_add_u32 s51, s50, 1703936
    buffer_load_dwordx4 v13, s[8:11], s51 offen lds
    s_add_u32 m0, s32, 57344
    s_add_u32 s51, s50, 1835008
    buffer_load_dwordx4 v13, s[8:11], s51 offen lds
    s_add_u32 m0, s32, 61440
    s_add_u32 s51, s50, 1966080
    buffer_load_dwordx4 v13, s[8:11], s51 offen lds
    s_add_u32 m0, s32, 65536
    s_add_u32 s51, s50, 2097152
    buffer_load_dwordx4 v13, s[8:11], s51 offen lds
    s_add_u32 m0, s32, 69632
    s_add_u32 s51, s50, 2228224
    buffer_load_dwordx4 v13, s[8:11], s51 offen lds
    s_add_u32 m0, s32, 73728
    s_add_u32 s51, s50, 2359296
    buffer_load_dwordx4 v13, s[8:11], s51 offen lds
    s_add_u32 m0, s32, 77824
    s_add_u32 s51, s50, 2490368
    buffer_load_dwordx4 v13, s[8:11], s51 offen lds
    s_add_u32 m0, s32, 81920
    s_add_u32 s51, s50, 2621440
    buffer_load_dwordx4 v13, s[8:11], s51 offen lds
    s_add_u32 m0, s32, 86016
    s_add_u32 s51, s50, 2752512
    buffer_load_dwordx4 v13, s[8:11], s51 offen lds
    s_add_u32 m0, s32, 90112
    s_add_u32 s51, s50, 2883584
    buffer_load_dwordx4 v13, s[8:11], s51 offen lds
    s_add_u32 m0, s32, 94208
    s_add_u32 s51, s50, 3014656
    buffer_load_dwordx4 v13, s[8:11], s51 offen lds
    s_add_u32 m0, s32, 98304
    s_add_u32 s51, s50, 3145728
    buffer_load_dwordx4 v13, s[8:11], s51 offen lds
    s_add_u32 m0, s32, 102400
    s_add_u32 s51, s50, 3276800
    buffer_load_dwordx4 v13, s[8:11], s51 offen lds
    s_add_u32 m0, s32, 106496
    s_add_u32 s51, s50, 3407872
    buffer_load_dwordx4 v13, s[8:11], s51 offen lds
    s_add_u32 m0, s32, 110592
    s_add_u32 s51, s50, 3538944
    buffer_load_dwordx4 v13, s[8:11], s51 offen lds
    s_add_u32 m0, s32, 114688
    s_add_u32 s51, s50, 3670016
    buffer_load_dwordx4 v13, s[8:11], s51 offen lds
    s_add_u32 m0, s32, 118784
    s_add_u32 s51, s50, 3801088
    buffer_load_dwordx4 v13, s[8:11], s51 offen lds
    s_add_u32 m0, s32, 122880
    s_add_u32 s51, s50, 3932160
    buffer_load_dwordx4 v13, s[8:11], s51 offen lds
    s_add_u32 m0, s32, 126976
    s_add_u32 s51, s50, 4063232
    buffer_load_dwordx4 v13, s[8:11], s51 offen lds
    s_add_u32 m0, s32, 131072
    s_add_u32 s51, s50, 4194304
    buffer_load_dwordx4 v13, s[8:11], s51 offen lds
    s_add_u32 m0, s32, 135168
    s_add_u32 s51, s50, 4325376
    buffer_load_dwordx4 v13, s[8:11], s51 offen lds
    s_add_u32 m0, s32, 139264
    s_add_u32 s51, s50, 4456448
    buffer_load_dwordx4 v13, s[8:11], s51 offen lds
    s_add_u32 m0, s32, 143360
    s_add_u32 s51, s50, 4587520
    buffer_load_dwordx4 v13, s[8:11], s51 offen lds
    s_add_u32 m0, s32, 147456
    s_add_u32 s51, s50, 4718592
    buffer_load_dwordx4 v13, s[8:11], s51 offen lds
    s_add_u32 m0, s32, 151552
    s_add_u32 s51, s50, 4849664
    buffer_load_dwordx4 v13, s[8:11], s51 offen lds
    s_add_u32 m0, s32, 155648
    s_add_u32 s51, s50, 4980736
    buffer_load_dwordx4 v13, s[8:11], s51 offen lds
    s_add_u32 m0, s32, 159744
    s_add_u32 s51, s50, 5111808
    buffer_load_dwordx4 v13, s[8:11], s51 offen lds
    v_bfe_u32 v11, v10, 2, 2
    v_bfe_u32 v12, v10, 4, 1
    v_lshlrev_b32 v12, 1, v12
    v_lshl_add_u32 v12, v11, 2, v12
    v_bfe_u32 v14, v10, 1, 1
    v_add_u32 v12, v12, v14
    s_lshl_b32 s50, s16, 2
    v_add_u32 v12, s50, v12
    v_and_b32 v12, 15, v12
    v_lshlrev_b32 v12, 4, v12
    v_lshl_add_u32 v12, v11, 8, v12
    v_lshrrev_b32 v11, 5, v10
    v_lshl_add_u32 v12, v11, 11, v12
    v_and_b32 v11, 1, v10
    v_lshl_add_u32 v2, v11, 3, v12
    v_add_u32 v15, 65536, v2
    v_add_u32 v14, 131072, v2
    v_bfe_u32 v11, v10, 4, 1
    v_lshlrev_b32 v11, 12, v11
    v_lshrrev_b32 v12, 5, v10
    v_lshl_add_u32 v11, v12, 8, v11
    v_and_b32 v12, 15, v10
    v_lshl_add_u32 v3, v12, 4, v11
    s_lshl_b32 s37, s17, 7
    s_lshl_b32 s52, s16, 2
    s_add_u32 s37, s37, s52
    s_add_u32 s37, s37, 6299648
    s_waitcnt vmcnt(32)
    s_barrier
    ds_read_b64_tr_b16 a[0:1], v2 offset:0
    ds_read_b64_tr_b16 a[2:3], v2 offset:1024
    ds_read_b64_tr_b16 a[4:5], v2 offset:4096
    ds_read_b64_tr_b16 a[6:7], v2 offset:5120
    ds_read_b64_tr_b16 a[8:9], v2 offset:8192
    ds_read_b64_tr_b16 a[10:11], v2 offset:9216
    ds_read_b64_tr_b16 a[12:13], v2 offset:12288
    ds_read_b64_tr_b16 a[14:15], v2 offset:13312
    ds_read_b64_tr_b16 a[16:17], v2 offset:16384
    ds_read_b64_tr_b16 a[18:19], v2 offset:17408
    ds_read_b64_tr_b16 a[20:21], v2 offset:20480
    ds_read_b64_tr_b16 a[22:23], v2 offset:21504
    ds_read_b64_tr_b16 a[24:25], v2 offset:24576
    ds_read_b64_tr_b16 a[26:27], v2 offset:25600
    ds_read_b64_tr_b16 a[28:29], v2 offset:28672
    ds_read_b64_tr_b16 a[30:31], v2 offset:29696
    s_waitcnt vmcnt(24)
    s_barrier
    ds_read_b64_tr_b16 a[32:33], v2 offset:32768
    ds_read_b64_tr_b16 a[34:35], v2 offset:33792
    ds_read_b64_tr_b16 a[36:37], v2 offset:36864
    ds_read_b64_tr_b16 a[38:39], v2 offset:37888
    ds_read_b64_tr_b16 a[40:41], v2 offset:40960
    ds_read_b64_tr_b16 a[42:43], v2 offset:41984
    ds_read_b64_tr_b16 a[44:45], v2 offset:45056
    ds_read_b64_tr_b16 a[46:47], v2 offset:46080
    ds_read_b64_tr_b16 a[48:49], v2 offset:49152
    ds_read_b64_tr_b16 a[50:51], v2 offset:50176
    ds_read_b64_tr_b16 a[52:53], v2 offset:53248
    ds_read_b64_tr_b16 a[54:55], v2 offset:54272
    ds_read_b64_tr_b16 a[56:57], v2 offset:57344
    ds_read_b64_tr_b16 a[58:59], v2 offset:58368
    ds_read_b64_tr_b16 a[60:61], v2 offset:61440
    ds_read_b64_tr_b16 a[62:63], v2 offset:62464
    s_waitcnt vmcnt(16)
    s_barrier
    ds_read_b64_tr_b16 a[64:65], v15 offset:0
    ds_read_b64_tr_b16 a[66:67], v15 offset:1024
    ds_read_b64_tr_b16 a[68:69], v15 offset:4096
    ds_read_b64_tr_b16 a[70:71], v15 offset:5120
    ds_read_b64_tr_b16 a[72:73], v15 offset:8192
    ds_read_b64_tr_b16 a[74:75], v15 offset:9216
    ds_read_b64_tr_b16 a[76:77], v15 offset:12288
    ds_read_b64_tr_b16 a[78:79], v15 offset:13312
    ds_read_b64_tr_b16 a[80:81], v15 offset:16384
    ds_read_b64_tr_b16 a[82:83], v15 offset:17408
    ds_read_b64_tr_b16 a[84:85], v15 offset:20480
    ds_read_b64_tr_b16 a[86:87], v15 offset:21504
    ds_read_b64_tr_b16 a[88:89], v15 offset:24576
    ds_read_b64_tr_b16 a[90:91], v15 offset:25600
    ds_read_b64_tr_b16 a[92:93], v15 offset:28672
    ds_read_b64_tr_b16 a[94:95], v15 offset:29696
    s_waitcnt vmcnt(8)
    s_barrier
    ds_read_b64_tr_b16 a[96:97], v15 offset:32768
    ds_read_b64_tr_b16 a[98:99], v15 offset:33792
    ds_read_b64_tr_b16 a[100:101], v15 offset:36864
    ds_read_b64_tr_b16 a[102:103], v15 offset:37888
    ds_read_b64_tr_b16 a[104:105], v15 offset:40960
    ds_read_b64_tr_b16 a[106:107], v15 offset:41984
    ds_read_b64_tr_b16 a[108:109], v15 offset:45056
    ds_read_b64_tr_b16 a[110:111], v15 offset:46080
    ds_read_b64_tr_b16 a[112:113], v15 offset:49152
    ds_read_b64_tr_b16 a[114:115], v15 offset:50176
    ds_read_b64_tr_b16 a[116:117], v15 offset:53248
    ds_read_b64_tr_b16 a[118:119], v15 offset:54272
    ds_read_b64_tr_b16 a[120:121], v15 offset:57344
    ds_read_b64_tr_b16 a[122:123], v15 offset:58368
    ds_read_b64_tr_b16 a[124:125], v15 offset:61440
    ds_read_b64_tr_b16 a[126:127], v15 offset:62464
    s_waitcnt vmcnt(0)
    s_barrier
    ds_read_b64_tr_b16 a[128:129], v14 offset:0
    ds_read_b64_tr_b16 a[130:131], v14 offset:1024
    ds_read_b64_tr_b16 a[132:133], v14 offset:4096
    ds_read_b64_tr_b16 a[134:135], v14 offset:5120
    ds_read_b64_tr_b16 a[136:137], v14 offset:8192
    ds_read_b64_tr_b16 a[138:139], v14 offset:9216
    ds_read_b64_tr_b16 a[140:141], v14 offset:12288
    ds_read_b64_tr_b16 a[142:143], v14 offset:13312
    ds_read_b64_tr_b16 a[144:145], v14 offset:16384
    ds_read_b64_tr_b16 a[146:147], v14 offset:17408
    ds_read_b64_tr_b16 a[148:149], v14 offset:20480
    ds_read_b64_tr_b16 a[150:151], v14 offset:21504
    ds_read_b64_tr_b16 a[152:153], v14 offset:24576
    ds_read_b64_tr_b16 a[154:155], v14 offset:25600
    ds_read_b64_tr_b16 a[156:157], v14 offset:28672
    ds_read_b64_tr_b16 a[158:159], v14 offset:29696
    v_and_b32 v11, 4, v10
    v_lshlrev_b32 v11, 10, v11
    v_and_b32 v12, 3, v10
    v_lshl_add_u32 v11, v12, 2, v11
    s_lshl_b32 s50, s17, 7
    s_add_u32 s50, s50, 6291456
    v_add_u32 v7, s50, v11
    v_and_b32 v11, 4, v10
    v_lshlrev_b32 v11, 5, v11
    v_lshl_add_u32 v11, v12, 2, v11
    s_lshl_b32 s50, s17, 8
    s_add_u32 s50, s50, 6307840
    v_add_u32 v8, s50, v11
    v_lshlrev_b32 v65, 3, v10
    v_lshrrev_b32 v11, 4, v10
    v_and_b32 v12, 1, v11
    v_lshrrev_b32 v11, 1, v11
    v_bfe_u32 v13, v10, 2, 2
    v_and_b32 v14, 1, v10
    v_and_b32 v15, 1, v13
    v_lshl_add_u32 v15, v15, 1, v14
    v_lshrrev_b32 v13, 1, v13
    v_lshl_add_u32 v13, v12, 1, v13
    v_lshlrev_b32 v13, 3, v13
    v_add_u32 v13, 106496, v13
    v_lshl_add_u32 v14, v11, 1, 0
    v_xor_b32 v5, v15, v14
    v_lshlrev_b32 v5, 5, v5
    v_lshl_add_u32 v5, v14, 7, v5
    v_add_u32 v9, v5, v13
    v_lshl_add_u32 v14, v11, 1, 1
    v_xor_b32 v5, v15, v14
    v_lshlrev_b32 v5, 5, v5
    v_lshl_add_u32 v5, v14, 7, v5
    v_add_u32 v64, v5, v13
    v_lshl_add_u32 v5, v11, 1, v12
    v_lshrrev_b32 v13, 1, v5
    v_lshlrev_b32 v13, 10, v13
    v_and_b32 v14, 1, v5
    v_lshl_add_u32 v13, v14, 9, v13
    v_and_b32 v14, 15, v10
    v_lshl_add_u32 v13, v14, 4, v13
    s_lshr_b32 s50, s16, 1
    s_lshl_b32 s51, s50, 12
    s_and_b32 s52, s16, 1
    s_lshl_b32 s53, s52, 8
    s_add_u32 s51, s51, s53
    v_add_u32 v66, s51, v13
    s_lshl_b32 s53, s52, 12
    s_add_u32 s53, s53, 81920
    v_lshlrev_b32 v13, 4, v10
    v_add_u32 v67, s53, v13
    s_lshl_b32 s53, s50, 12
    s_add_u32 s53, s53, 98304
    v_add_u32 v68, s53, v13
    s_lshl_b32 s53, s50, 11
    s_add_u32 s53, s53, 108544
    v_add_u32 v65, s53, v65
    s_lshl_b32 s52, s52, 4
    v_add_u32 v14, s52, v14
    v_lshlrev_b32 v5, 2, v5
    v_sub_u32 v14, v14, v5
    v_mov_b32 v13, 0xd028965f
    v_cmp_gt_i32 vcc, 0, v14
    s_nop 1
    v_cndmask_b32 v72, 0, v13, vcc
    v_cmp_gt_i32 vcc, 1, v14
    s_nop 1
    v_cndmask_b32 v73, 0, v13, vcc
    v_cmp_gt_i32 vcc, 2, v14
    s_nop 1
    v_cndmask_b32 v74, 0, v13, vcc
    v_cmp_gt_i32 vcc, 3, v14
    s_nop 1
    v_cndmask_b32 v75, 0, v13, vcc
    v_cmp_gt_i32 vcc, 16, v14
    s_nop 1
    v_cndmask_b32 v76, 0, v13, vcc
    v_cmp_gt_i32 vcc, 17, v14
    s_nop 1
    v_cndmask_b32 v77, 0, v13, vcc
    v_cmp_gt_i32 vcc, 18, v14
    s_nop 1
    v_cndmask_b32 v78, 0, v13, vcc
    v_cmp_gt_i32 vcc, 19, v14
    s_nop 1
    v_cndmask_b32 v79, 0, v13, vcc
    v_mov_b32 v80, 0x3f803f80
    v_mov_b32 v81, 0x3f803f80
    v_mov_b32 v82, 0x3f803f80
    v_mov_b32 v83, 0x3f803f80
    v_mov_b32 v84, 0x3f003f00
    v_mov_b32 v85, 0x3f003f00
    s_mov_b32 s60, 0x3e0293ee
    s_mov_b32 s61, 0x3e0293ee
    s_lshl_b32 s50, s17, 19
    s_lshl_b32 s51, s16, 11
    s_add_u32 s50, s50, s51
    s_add_u32 s40, s50, 11534336
    s_add_u32 s41, s50, 28311552
    s_lshl_b32 s50, s17, 17
    s_lshl_b32 s51, s16, 9
    s_add_u32 s42, s50, s51
    s_add_u32 s42, s42, 69206016
    s_lshl_b32 s50, s17, 18
    s_lshl_b32 s51, s16, 10
    s_add_u32 s43, s50, s51
    s_add_u32 s43, s43, 73400320
    s_lshl_b32 s44, s17, 13
    s_add_u32 s44, s44, 45088768
    s_lshl_b32 s50, s16, 10
    s_add_u32 s45, s50, 81920
    v_add_u32 v69, s45, v3
    s_mov_b32 s47, 0
    v_mov_b32 v5, 0
    s_cmp_lg_u32 s16, 0
    s_cbranch_scc1 L_ww_11
    s_mov_b32 s62, 0
L_pw_12:
    buffer_load_dword v6, v5, s[12:15], 0 offen sc1
    s_waitcnt vmcnt(0)
    v_cmp_gt_u32 vcc, 64, v6
    s_cbranch_vccz L_pok_13
    s_sleep 12
    s_add_u32 s62, s62, 1
    s_cmp_lt_u32 s62, 2000000
    s_cbranch_scc1 L_pw_12
    v_mov_b32 v1, 530
    v_mov_b32 v2, 192
    buffer_store_dword v1, v2, s[12:15], 0 offen sc1
    s_waitcnt vmcnt(0)
    s_endpgm
L_pok_13:
L_ww_11:
    s_barrier
    s_waitcnt lgkmcnt(0)
    s_barrier
    s_mul_i32 s34, s16, 10240
    s_add_u32 s34, s34, 8388608
    s_mul_i32 s38, s16, 10240
    s_mov_b32 s35, 0
    s_mov_b32 s33, 0
    s_add_u32 m0, s38, 0
    s_add_u32 s53, s34, 0
    buffer_load_dwordx4 v1, s[4:7], s53 offen offset:0 lds
    buffer_load_dwordx4 v1, s[4:7], s53 offen offset:1024 lds
    buffer_load_dwordx4 v1, s[4:7], s53 offen offset:2048 lds
    buffer_load_dwordx4 v1, s[4:7], s53 offen offset:3072 lds
    s_add_u32 m0, s38, 4096
    s_add_u32 s53, s34, 4096
    buffer_load_dwordx4 v1, s[4:7], s53 offen offset:0 lds
    buffer_load_dwordx4 v1, s[4:7], s53 offen offset:1024 lds
    buffer_load_dwordx4 v1, s[4:7], s53 offen offset:2048 lds
    buffer_load_dwordx4 v1, s[4:7], s53 offen offset:3072 lds
    s_add_u32 m0, s38, 8192
    s_add_u32 s53, s34, 8192
    buffer_load_dwordx4 v1, s[4:7], s53 offen offset:0 lds
    buffer_load_dwordx4 v1, s[4:7], s53 offen offset:1024 lds
    s_add_u32 s34, s34, 40960
    s_add_u32 s38, s38, 40960
    s_cmp_ge_u32 s38, 81920
    s_cselect_b32 s54, 81920, 0
    s_sub_u32 s38, s38, s54
    s_waitcnt vmcnt(0)
L_Q_loop:
    s_barrier
    v_add_u32 v5, s35, v1
    s_add_u32 s46, s33, 1
    s_mov_b32 s49, 0
    ds_read_b128 v[32:35], v5 offset:0
    ds_read_b128 v[36:39], v5 offset:1024
    ds_read_b128 v[40:43], v5 offset:2048
    ds_read_b128 v[44:47], v5 offset:3072
    ds_read_b128 v[48:51], v5 offset:4096
    s_waitcnt lgkmcnt(4)
    v_mfma_f32_32x32x16_bf16 v[16:31], a[0:3], v[32:35], 0
    ds_read_b128 v[52:55], v5 offset:5120
    s_add_u32 m0, s38, 0
    s_add_u32 s53, s34, 0
    buffer_load_dwordx4 v1, s[4:7], s53 offen offset:0 lds
    s_waitcnt lgkmcnt(4)
    v_mfma_f32_32x32x16_bf16 v[16:31], a[4:7], v[36:39], v[16:31]
    ds_read_b128 v[32:35], v5 offset:6144
    buffer_load_dwordx4 v1, s[4:7], s53 offen offset:1024 lds
    s_waitcnt lgkmcnt(4)
    v_mfma_f32_32x32x16_bf16 v[16:31], a[8:11], v[40:43], v[16:31]
    ds_read_b128 v[36:39], v5 offset:7168
    buffer_load_dwordx4 v1, s[4:7], s53 offen offset:2048 lds
    s_waitcnt lgkmcnt(4)
    v_mfma_f32_32x32x16_bf16 v[16:31], a[12:15], v[44:47], v[16:31]
    ds_read_b128 v[40:43], v5 offset:8192
    buffer_load_dwordx4 v1, s[4:7], s53 offen offset:3072 lds
    s_waitcnt lgkmcnt(4)
    v_mfma_f32_32x32x16_bf16 v[16:31], a[16:19], v[48:51], v[16:31]
    ds_read_b128 v[44:47], v5 offset:9216
    s_add_u32 m0, s38, 4096
    s_add_u32 s53, s34, 4096
    buffer_load_dwordx4 v1, s[4:7], s53 offen offset:0 lds
    s_waitcnt lgkmcnt(4)
    v_mfma_f32_32x32x16_bf16 v[16:31], a[20:23], v[52:55], v[16:31]
    ds_read_b128 v[48:51], v5 offset:10240
    buffer_load_dwordx4 v1, s[4:7], s53 offen offset:1024 lds
    s_waitcnt lgkmcnt(4)
    v_mfma_f32_32x32x16_bf16 v[16:31], a[24:27], v[32:35], v[16:31]
    ds_read_b128 v[52:55], v5 offset:11264
    buffer_load_dwordx4 v1, s[4:7], s53 offen offset:2048 lds
    s_waitcnt lgkmcnt(4)
    v_mfma_f32_32x32x16_bf16 v[16:31], a[28:31], v[36:39], v[16:31]
    ds_read_b128 v[32:35], v5 offset:12288
    buffer_load_dwordx4 v1, s[4:7], s53 offen offset:3072 lds
    s_waitcnt lgkmcnt(4)
    v_mfma_f32_32x32x16_bf16 v[16:31], a[32:35], v[40:43], v[16:31]
    ds_read_b128 v[36:39], v5 offset:13312
    s_add_u32 m0, s38, 8192
    s_add_u32 s53, s34, 8192
    buffer_load_dwordx4 v1, s[4:7], s53 offen offset:0 lds
    s_waitcnt lgkmcnt(4)
    v_mfma_f32_32x32x16_bf16 v[16:31], a[36:39], v[44:47], v[16:31]
    ds_read_b128 v[40:43], v5 offset:14336
    buffer_load_dwordx4 v1, s[4:7], s53 offen offset:1024 lds
    s_waitcnt lgkmcnt(4)
    v_mfma_f32_32x32x16_bf16 v[16:31], a[40:43], v[48:51], v[16:31]
    ds_read_b128 v[44:47], v5 offset:15360
    s_add_u32 s34, s34, 40960
    s_add_u32 s38, s38, 40960
    s_cmp_ge_u32 s38, 81920
    s_cselect_b32 s54, 81920, 0
    s_sub_u32 s38, s38, s54
    s_add_u32 s35, s35, 40960
    s_cmp_ge_u32 s35, 81920
    s_cselect_b32 s54, 81920, 0
    s_sub_u32 s35, s35, s54
    s_waitcnt lgkmcnt(4)
    v_mfma_f32_32x32x16_bf16 v[16:31], a[44:47], v[52:55], v[16:31]
    ds_read_b128 v[48:51], v5 offset:16384
    s_cmp_ge_u32 s47, s46
    s_cbranch_scc1 L_qk_14
    s_mov_b32 s62, 0
L_pw_15:
    buffer_load_dword v6, v7, s[4:7], 0 offen sc1
    s_waitcnt vmcnt(0)
    v_cmp_gt_u32 vcc, s46, v6
    s_cbranch_vccz L_pok_16
    s_sleep 4
    s_add_u32 s62, s62, 1
    s_cmp_lt_u32 s62, 2000000
    s_cbranch_scc1 L_pw_15
    v_mov_b32 v1, 544
    v_mov_b32 v2, 192
    buffer_store_dword v1, v2, s[12:15], 0 offen sc1
    s_waitcnt vmcnt(0)
    s_endpgm
L_pok_16:
    v_readlane_b32 s47, v6, 0
    v_readlane_b32 s48, v6, 1
    s_min_u32 s47, s47, s48
    v_readlane_b32 s48, v6, 2
    s_min_u32 s47, s47, s48
    v_readlane_b32 s48, v6, 3
    s_min_u32 s47, s47, s48
    v_readlane_b32 s48, v6, 4
    s_min_u32 s47, s47, s48
    v_readlane_b32 s48, v6, 5
    s_min_u32 s47, s47, s48
    v_readlane_b32 s48, v6, 6
    s_min_u32 s47, s47, s48
    v_readlane_b32 s48, v6, 7
    s_min_u32 s47, s47, s48
L_qk_14:
    s_waitcnt lgkmcnt(4)
    v_mfma_f32_32x32x16_bf16 v[16:31], a[48:51], v[32:35], v[16:31]
    ds_read_b128 v[52:55], v5 offset:17408
    s_lshl_b32 s50, s16, 11
    s_add_u32 m0, s50, 90112
    s_nop 0
    buffer_load_dwordx4 v1, s[4:7], s40 offen offset:0 lds
    s_waitcnt lgkmcnt(4)
    v_mfma_f32_32x32x16_bf16 v[16:31], a[52:55], v[36:39], v[16:31]
    ds_read_b128 v[32:35], v5 offset:18432
    buffer_load_dwordx4 v1, s[4:7], s40 offen offset:1024 lds
    s_waitcnt lgkmcnt(4)
    v_mfma_f32_32x32x16_bf16 v[16:31], a[56:59], v[40:43], v[16:31]
    ds_read_b128 v[36:39], v5 offset:19456
    s_add_u32 m0, s50, 98304
    s_add_u32 s40, s40, 8192
    buffer_load_dwordx4 v1, s[4:7], s41 offen offset:0 lds
    s_waitcnt lgkmcnt(4)
    v_mfma_f32_32x32x16_bf16 v[16:31], a[60:63], v[44:47], v[16:31]
    ds_read_b128 v[40:43], v5 offset:20480
    buffer_load_dwordx4 v1, s[4:7], s41 offen offset:1024 lds
    s_add_u32 s41, s41, 8192
    s_waitcnt lgkmcnt(4)
    v_mfma_f32_32x32x16_bf16 v[16:31], a[64:67], v[48:51], v[16:31]
    ds_read_b128 v[44:47], v5 offset:21504
    s_waitcnt lgkmcnt(4)
    v_mfma_f32_32x32x16_bf16 v[16:31], a[68:71], v[52:55], v[16:31]
    ds_read_b128 v[48:51], v5 offset:22528
    s_waitcnt lgkmcnt(4)
    v_mfma_f32_32x32x16_bf16 v[16:31], a[72:75], v[32:35], v[16:31]
    ds_read_b128 v[52:55], v5 offset:23552
    s_waitcnt lgkmcnt(4)
    v_mfma_f32_32x32x16_bf16 v[16:31], a[76:79], v[36:39], v[16:31]
    ds_read_b128 v[32:35], v5 offset:24576
    buffer_load_dword v71, v8, s[4:7], 0 offen sc1
    s_waitcnt lgkmcnt(4)
    v_mfma_f32_32x32x16_bf16 v[16:31], a[80:83], v[40:43], v[16:31]
    ds_read_b128 v[36:39], v5 offset:25600
    s_waitcnt vmcnt(15)
    v_mov_b32 v6, s33
    s_mov_b64 exec, 1
    buffer_store_dword v6, v1, s[4:7], s37 offen sc1
    s_mov_b64 exec, -1
    s_waitcnt lgkmcnt(4)
    v_mfma_f32_32x32x16_bf16 v[16:31], a[84:87], v[44:47], v[16:31]
    ds_read_b128 v[40:43], v5 offset:26624
    s_waitcnt lgkmcnt(4)
    v_mfma_f32_32x32x16_bf16 v[16:31], a[88:91], v[48:51], v[16:31]
    ds_read_b128 v[44:47], v5 offset:27648
    s_waitcnt lgkmcnt(4)
    v_mfma_f32_32x32x16_bf16 v[16:31], a[92:95], v[52:55], v[16:31]
    ds_read_b128 v[48:51], v5 offset:28672
    s_waitcnt lgkmcnt(4)
    v_mfma_f32_32x32x16_bf16 v[16:31], a[96:99], v[32:35], v[16:31]
    ds_read_b128 v[52:55], v5 offset:29696
    s_waitcnt lgkmcnt(4)
    v_mfma_f32_32x32x16_bf16 v[16:31], a[100:103], v[36:39], v[16:31]
    ds_read_b128 v[32:35], v5 offset:30720
    s_waitcnt lgkmcnt(4)
    v_mfma_f32_32x32x16_bf16 v[16:31], a[104:107], v[40:43], v[16:31]
    ds_read_b128 v[36:39], v5 offset:31744
    s_waitcnt lgkmcnt(4)
    v_mfma_f32_32x32x16_bf16 v[16:31], a[108:111], v[44:47], v[16:31]
    ds_read_b128 v[40:43], v5 offset:32768
    s_waitcnt lgkmcnt(4)
    v_mfma_f32_32x32x16_bf16 v[16:31], a[112:115], v[48:51], v[16:31]
    ds_read_b128 v[44:47], v5 offset:33792
    s_waitcnt lgkmcnt(4)
    v_mfma_f32_32x32x16_bf16 v[16:31], a[116:119], v[52:55], v[16:31]
    ds_read_b128 v[48:51], v5 offset:34816
    s_waitcnt lgkmcnt(4)
    v_mfma_f32_32x32x16_bf16 v[16:31], a[120:123], v[32:35], v[16:31]
    ds_read_b128 v[52:55], v5 offset:35840
    s_waitcnt lgkmcnt(4)
    v_mfma_f32_32x32x16_bf16 v[16:31], a[124:127], v[36:39], v[16:31]
    ds_read_b128 v[32:35], v5 offset:36864
    s_waitcnt lgkmcnt(4)
    v_mfma_f32_32x32x16_bf16 v[16:31], a[128:131], v[40:43], v[16:31]
    ds_read_b128 v[36:39], v5 offset:37888
    s_waitcnt lgkmcnt(4)
    v_mfma_f32_32x32x16_bf16 v[16:31], a[132:135], v[44:47], v[16:31]
    ds_read_b128 v[40:43], v5 offset:38912
    s_waitcnt lgkmcnt(4)
    v_mfma_f32_32x32x16_bf16 v[16:31], a[136:139], v[48:51], v[16:31]
    ds_read_b128 v[44:47], v5 offset:39936
    s_waitcnt lgkmcnt(4)
    v_mfma_f32_32x32x16_bf16 v[16:31], a[140:143], v[52:55], v[16:31]
    s_waitcnt lgkmcnt(3)
    v_mfma_f32_32x32x16_bf16 v[16:31], a[144:147], v[32:35], v[16:31]
    s_waitcnt lgkmcnt(2)
    v_mfma_f32_32x32x16_bf16 v[16:31], a[148:151], v[36:39], v[16:31]
    s_waitcnt lgkmcnt(1)
    v_mfma_f32_32x32x16_bf16 v[16:31], a[152:155], v[40:43], v[16:31]
    s_waitcnt lgkmcnt(0)
    v_mfma_f32_32x32x16_bf16 v[16:31], a[156:159], v[44:47], v[16:31]
    s_nop 11
    v_cvt_pk_bf16_f32 v56, v16, v17
    v_cvt_pk_bf16_f32 v57, v18, v19
    v_cvt_pk_bf16_f32 v58, v20, v21
    v_cvt_pk_bf16_f32 v59, v22, v23
    v_cvt_pk_bf16_f32 v60, v24, v25
    v_cvt_pk_bf16_f32 v61, v26, v27
    v_cvt_pk_bf16_f32 v62, v28, v29
    v_cvt_pk_bf16_f32 v63, v30, v31
    ds_write_b128 v69, v[56:59] offset:0
    ds_write_b128 v69, v[60:63] offset:512
    s_waitcnt vmcnt(1)
    v_cmp_gt_u32 vcc, s46, v71
    s_cbranch_vccz L_km_17
    s_mov_b32 s62, 0
L_pw_18:
    buffer_load_dword v6, v8, s[4:7], 0 offen sc1
    s_waitcnt vmcnt(0)
    v_cmp_gt_u32 vcc, s46, v6
    s_cbranch_vccz L_pok_19
    s_sleep 2
    s_add_u32 s62, s62, 1
    s_cmp_lt_u32 s62, 2000000
    s_cbranch_scc1 L_pw_18
    v_mov_b32 v1, 545
    v_mov_b32 v2, 192
    buffer_store_dword v1, v2, s[12:15], 0 offen sc1
    s_waitcnt vmcnt(0)
    s_endpgm
L_pok_19:
L_km_17:
    s_lshl_b32 s50, s16, 9
    s_add_u32 m0, s50, 106496
    s_mov_b32 exec_hi, 0
    buffer_load_dwordx4 v1, s[4:7], s42 offen lds
    s_mov_b32 exec_hi, -1
    s_lshl_b32 s50, s16, 10
    s_add_u32 m0, s50, 108544
    s_add_u32 s42, s42, 2048
    buffer_load_dwordx4 v1, s[4:7], s43 offen lds
    s_add_u32 s43, s43, 4096
    v_add_u32 v5, 90112, v1
    s_waitcnt vmcnt(3) lgkmcnt(0)
    s_barrier
    ds_read_b128 v[88:91], v67 offset:0
    ds_read_b128 v[104:107], v5 offset:0
    ds_read_b128 v[120:123], v5 offset:4096
    ds_read_b128 v[92:95], v67 offset:1024
    ds_read_b128 v[108:111], v5 offset:1024
    ds_read_b128 v[124:127], v5 offset:5120
    ds_read_b128 v[96:99], v67 offset:2048
    ds_read_b128 v[112:115], v5 offset:2048
    ds_read_b128 v[128:131], v5 offset:6144
    ds_read_b128 v[100:103], v67 offset:3072
    ds_read_b128 v[116:119], v5 offset:3072
    ds_read_b128 v[132:135], v5 offset:7168
    s_waitcnt lgkmcnt(9)
    v_mfma_f32_16x16x32_bf16 v[16:19], v[104:107], v[88:91], v[72:75]
    ds_read_b128 v[152:155], v68 offset:0
    v_mfma_f32_16x16x32_bf16 v[20:23], v[120:123], v[88:91], v[76:79]
    s_waitcnt lgkmcnt(7)
    v_mfma_f32_16x16x32_bf16 v[16:19], v[108:111], v[92:95], v[16:19]
    ds_read_b128 v[156:159], v68 offset:1024
    v_mfma_f32_16x16x32_bf16 v[20:23], v[124:127], v[92:95], v[20:23]
    s_waitcnt lgkmcnt(5)
    v_mfma_f32_16x16x32_bf16 v[16:19], v[112:115], v[96:99], v[16:19]
    ds_read_b128 v[160:163], v68 offset:2048
    v_mfma_f32_16x16x32_bf16 v[20:23], v[128:131], v[96:99], v[20:23]
    s_waitcnt lgkmcnt(3)
    v_mfma_f32_16x16x32_bf16 v[16:19], v[116:119], v[100:103], v[16:19]
    ds_read_b128 v[164:167], v68 offset:3072
    v_mfma_f32_16x16x32_bf16 v[20:23], v[132:135], v[100:103], v[20:23]
    s_nop 5
    v_max3_f32 v32, v16, v17, v18
    s_nop 0
    v_max3_f32 v33, v20, v21, v22
    v_max3_f32 v32, v32, v19, v23
    s_waitcnt vmcnt(0)
    s_barrier
    ds_read_b64_tr_b16 v[136:137], v9 offset:0
    ds_read_b64_tr_b16 v[138:139], v64 offset:0
    ds_read_b64_tr_b16 v[140:141], v9 offset:512
    ds_read_b64_tr_b16 v[142:143], v64 offset:512
    ds_read_b64_tr_b16 v[144:145], v9 offset:1024
    ds_read_b64_tr_b16 v[146:147], v64 offset:1024
    ds_read_b64_tr_b16 v[148:149], v9 offset:1536
    ds_read_b64_tr_b16 v[150:151], v64 offset:1536
    ds_read_b64 v[168:169], v65 offset:0
    ds_read_b64 v[170:171], v65 offset:512
    ds_read_b64 v[172:173], v65 offset:1024
    ds_read_b64 v[174:175], v65 offset:1536
    s_waitcnt lgkmcnt(10)
    v_mfma_f32_16x16x32_bf16 v[24:27], v[136:139], v[88:91], 0
    s_waitcnt lgkmcnt(8)
    v_mfma_f32_16x16x32_bf16 v[24:27], v[140:143], v[92:95], v[24:27]
    s_waitcnt lgkmcnt(6)
    v_mfma_f32_16x16x32_bf16 v[24:27], v[144:147], v[96:99], v[24:27]
    s_waitcnt lgkmcnt(4)
    v_mfma_f32_16x16x32_bf16 v[24:27], v[148:151], v[100:103], v[24:27]
    s_nop 7
    v_max3_f32 v33, v33, v24, v25
    v_max3_f32 v32, v32, v26, v27
    v_max_f32 v34, v32, v33
    v_max_f32 v32, v32, v33
    s_nop 1
    v_permlane32_swap_b32 v32, v34
    v_max_f32 v33, v32, v34
    v_max_f32 v32, v32, v34
    s_nop 1
    v_permlane16_swap_b32 v32, v33
    v_max_f32 v32, v32, v33
    v_mul_f32 v34, 0xbe0293ee, v32
    v_pk_fma_f32 v[16:17], v[16:17], s[60:61], v[34:35] op_sel_hi:[1,0,0]
    v_pk_fma_f32 v[18:19], v[18:19], s[60:61], v[34:35] op_sel_hi:[1,0,0]
    v_pk_fma_f32 v[20:21], v[20:21], s[60:61], v[34:35] op_sel_hi:[1,0,0]
    v_pk_fma_f32 v[22:23], v[22:23], s[60:61], v[34:35] op_sel_hi:[1,0,0]
    v_pk_fma_f32 v[24:25], v[24:25], s[60:61], v[34:35] op_sel_hi:[1,0,0]
    v_pk_fma_f32 v[26:27], v[26:27], s[60:61], v[34:35] op_sel_hi:[1,0,0]
    v_exp_f32 v16, v16
    v_exp_f32 v17, v17
    v_exp_f32 v18, v18
    v_exp_f32 v19, v19
    v_exp_f32 v20, v20
    v_exp_f32 v21, v21
    v_exp_f32 v22, v22
    v_exp_f32 v23, v23
    v_exp_f32 v24, v24
    v_exp_f32 v25, v25
    v_exp_f32 v26, v26
    v_exp_f32 v27, v27
    v_cvt_pk_bf16_f32 v36, v16, v17
    v_cvt_pk_bf16_f32 v37, v18, v19
    v_cvt_pk_bf16_f32 v38, v20, v21
    v_cvt_pk_bf16_f32 v39, v22, v23
    v_cvt_pk_bf16_f32 v40, v24, v25
    v_cvt_pk_bf16_f32 v41, v26, v27
    s_waitcnt lgkmcnt(0)
    v_mfma_f32_16x16x32_bf16 v[28:31], v[80:83], v[36:39], 0
    v_mfma_f32_16x16x32_bf16 v[176:179], v[152:155], v[36:39], 0
    v_mfma_f32_16x16x32_bf16 v[180:183], v[156:159], v[36:39], 0
    v_mfma_f32_16x16x32_bf16 v[184:187], v[160:163], v[36:39], 0
    v_mfma_f32_16x16x32_bf16 v[188:191], v[164:167], v[36:39], 0
    v_mfma_f32_16x16x16_bf16 v[28:31], v[84:85], v[40:41], v[28:31]
    v_mfma_f32_16x16x16_bf16 v[176:179], v[168:169], v[40:41], v[176:179]
    v_mfma_f32_16x16x16_bf16 v[180:183], v[170:171], v[40:41], v[180:183]
    v_mfma_f32_16x16x16_bf16 v[184:187], v[172:173], v[40:41], v[184:187]
    v_mfma_f32_16x16x16_bf16 v[188:191], v[174:175], v[40:41], v[188:191]
    s_nop 3
    v_rcp_f32 v42, v28
    s_nop 0
    v_pk_mul_f32 v[176:177], v[176:177], v[42:43] op_sel_hi:[1,0]
    v_pk_mul_f32 v[178:179], v[178:179], v[42:43] op_sel_hi:[1,0]
    v_pk_mul_f32 v[180:181], v[180:181], v[42:43] op_sel_hi:[1,0]
    v_pk_mul_f32 v[182:183], v[182:183], v[42:43] op_sel_hi:[1,0]
    v_pk_mul_f32 v[184:185], v[184:185], v[42:43] op_sel_hi:[1,0]
    v_pk_mul_f32 v[186:187], v[186:187], v[42:43] op_sel_hi:[1,0]
    v_pk_mul_f32 v[188:189], v[188:189], v[42:43] op_sel_hi:[1,0]
    v_pk_mul_f32 v[190:191], v[190:191], v[42:43] op_sel_hi:[1,0]
    v_cvt_pk_bf16_f32 v176, v176, v177
    v_cvt_pk_bf16_f32 v177, v178, v179
    v_cvt_pk_bf16_f32 v178, v180, v181
    v_cvt_pk_bf16_f32 v179, v182, v183
    v_cvt_pk_bf16_f32 v180, v184, v185
    v_cvt_pk_bf16_f32 v181, v186, v187
    v_cvt_pk_bf16_f32 v182, v188, v189
    v_cvt_pk_bf16_f32 v183, v190, v191
    buffer_store_dwordx4 v[176:179], v66, s[4:7], s44 offen offset:0 sc1
    buffer_store_dwordx4 v[180:183], v66, s[4:7], s44 offen offset:2048 sc1
    s_add_u32 s44, s44, 262144
    s_add_u32 s33, s33, 1
    s_cmp_lt_u32 s33, 64
    s_waitcnt vmcnt(2)
    s_cbranch_scc1 L_Q_loop
    s_waitcnt vmcnt(0)
    v_mov_b32 v6, 64
    s_mov_b64 exec, 1
    buffer_store_dword v6, v1, s[4:7], s37 offen sc1
    s_waitcnt vmcnt(0)
    s_endpgm
L_role_fin:
    s_and_b32 s17, s20, 1
    s_mul_i32 s17, s17, 10
    s_add_u32 s17, s17, s21
    s_lshr_b32 s18, s20, 1
    s_mul_i32 s19, s20, 10
    s_add_u32 s19, s19, s21
L_aux:
    s_mov_b32 s8, s64
    s_and_b32 s9, s65, 0xffff
    s_mov_b32 s10, 0x280000
    s_mov_b32 s11, 0x20000
    v_and_b32 v10, 63, v0
    v_and_b32 v1, 7, v10
    v_lshrrev_b32 v2, 3, v10
    v_mul_u32_u24 v3, 1280, v1
    v_lshl_add_u32 v3, v2, 4, v3
    s_lshl_b32 s50, s19, 2
    s_add_u32 s50, s50, s16
    s_mul_i32 s50, s50, 10240
    buffer_load_dwordx4 v[16:19], v3, s[8:11], s50 offen offset:0
    buffer_load_dwordx4 v[20:23], v3, s[8:11], s50 offen offset:128
    buffer_load_dwordx4 v[24:27], v3, s[8:11], s50 offen offset:256
    buffer_load_dwordx4 v[28:31], v3, s[8:11], s50 offen offset:384
    buffer_load_dwordx4 v[32:35], v3, s[8:11], s50 offen offset:512
    buffer_load_dwordx4 v[36:39], v3, s[8:11], s50 offen offset:640
    buffer_load_dwordx4 v[40:43], v3, s[8:11], s50 offen offset:768
    buffer_load_dwordx4 v[44:47], v3, s[8:11], s50 offen offset:896
    buffer_load_dwordx4 v[48:51], v3, s[8:11], s50 offen offset:1024
    buffer_load_dwordx4 v[52:55], v3, s[8:11], s50 offen offset:1152
    v_mov_b32 v4, 0
    v_mov_b32 v5, 0
    v_mov_b32 v6, 0
    v_mov_b32 v7, 0
    v_lshlrev_b32 v8, 4, v0
    v_mov_b32 v9, 0x7ffffff0
    v_cmp_gt_u32 vcc, 24, v0
    s_nop 1
    v_cndmask_b32 v8, v9, v8, vcc
    s_mul_i32 s51, s19, 384
    s_add_u32 s51, s51, 6291456
    buffer_store_dwordx4 v[4:7], v8, s[4:7], s51 offen sc1
    s_nop 1
    v_lshrrev_b32 v4, 1, v2
    v_lshlrev_b32 v4, 10, v4
    v_and_b32 v5, 1, v2
    v_lshl_add_u32 v4, v5, 9, v4
    v_lshl_add_u32 v4, v1, 4, v4
    s_mul_i32 s52, s19, 40960
    s_lshl_b32 s53, s16, 7
    s_add_u32 s52, s52, s53
    s_add_u32 s52, s52, 8388608
    v_mov_b32 v56, -1
    v_mov_b32 v57, -1
    v_mov_b32 v58, -1
    v_mov_b32 v59, -1
    v_lshrrev_b32 v60, 4, v10
    v_lshlrev_b32 v60, 14, v60
    v_bfe_u32 v61, v10, 3, 1
    v_lshl_add_u32 v60, v61, 13, v60
    v_and_b32 v62, 7, v10
    v_lshl_add_u32 v60, v62, 4, v60
    s_mul_i32 s21, s16, 327680
    s_lshl_b32 s22, s19, 7
    s_add_u32 s21, s21, s22
    s_add_u32 s23, s21, 0
    buffer_store_dwordx4 v[56:59], v60, s[4:7], s23 offen sc1
    s_add_u32 s23, s21, 65536
    buffer_store_dwordx4 v[56:59], v60, s[4:7], s23 offen sc1
    s_add_u32 s23, s21, 131072
    buffer_store_dwordx4 v[56:59], v60, s[4:7], s23 offen sc1
    s_add_u32 s23, s21, 196608
    buffer_store_dwordx4 v[56:59], v60, s[4:7], s23 offen sc1
    s_add_u32 s23, s21, 262144
    buffer_store_dwordx4 v[56:59], v60, s[4:7], s23 offen sc1
    s_lshl_b32 s23, s16, 6
    s_add_u32 s23, s23, s19
    s_cmp_lt_u32 s23, 80
    s_cselect_b32 s24, 16, 0
    v_mov_b32 v61, 0x7ffffff0
    v_cmp_gt_u32 vcc, s24, v10
    s_nop 1
    v_cndmask_b32 v60, v61, v60, vcc
    s_min_u32 s23, s23, 79
    s_mul_i32 s24, s23, 3277
    s_lshr_b32 s24, s24, 16
    s_mul_i32 s25, s24, 20
    s_sub_u32 s23, s23, s25
    s_lshl_b32 s23, s23, 7
    s_lshr_b32 s25, s24, 1
    s_lshl_b32 s25, s25, 14
    s_add_u32 s23, s23, s25
    s_and_b32 s25, s24, 1
    s_lshl_b32 s25, s25, 12
    s_add_u32 s23, s23, s25
    s_add_u32 s23, s23, 1310720
    buffer_store_dwordx4 v[56:59], v60, s[4:7], s23 offen sc1
    s_cmp_eq_u32 s16, 2
    s_cselect_b32 s24, 16, 0
    v_lshlrev_b32 v60, 13, v10
    v_and_b32 v60, 0x10000, v60
    v_lshrrev_b32 v60, 3, v60
    v_lshl_add_u32 v60, v62, 4, v60
    v_cmp_gt_u32 vcc, s24, v10
    s_nop 1
    v_cndmask_b32 v60, v61, v60, vcc
    s_lshr_b32 s23, s19, 5
    s_lshl_b32 s23, s23, 14
    s_and_b32 s24, s19, 31
    s_lshl_b32 s24, s24, 8
    s_add_u32 s23, s23, s24
    s_add_u32 s23, s23, 1835008
    buffer_store_dwordx4 v[56:59], v60, s[4:7], s23 offen sc1
    s_waitcnt vmcnt(17)
    v_lshlrev_b32 v64, 16, v16
    v_and_b32 v65, 0xffff0000, v16
    v_lshlrev_b32 v66, 16, v17
    v_and_b32 v67, 0xffff0000, v17
    v_lshlrev_b32 v68, 16, v18
    v_and_b32 v69, 0xffff0000, v18
    v_lshlrev_b32 v70, 16, v19
    v_and_b32 v71, 0xffff0000, v19
    s_waitcnt vmcnt(16)
    v_lshlrev_b32 v72, 16, v20
    v_and_b32 v73, 0xffff0000, v20
    v_lshlrev_b32 v74, 16, v21
    v_and_b32 v75, 0xffff0000, v21
    v_lshlrev_b32 v76, 16, v22
    v_and_b32 v77, 0xffff0000, v22
    v_lshlrev_b32 v78, 16, v23
    v_and_b32 v79, 0xffff0000, v23
    s_waitcnt vmcnt(15)
    v_lshlrev_b32 v80, 16, v24
    v_and_b32 v81, 0xffff0000, v24
    v_lshlrev_b32 v82, 16, v25
    v_and_b32 v83, 0xffff0000, v25
    v_lshlrev_b32 v84, 16, v26
    v_and_b32 v85, 0xffff0000, v26
    v_lshlrev_b32 v86, 16, v27
    v_and_b32 v87, 0xffff0000, v27
    s_waitcnt vmcnt(14)
    v_lshlrev_b32 v88, 16, v28
    v_and_b32 v89, 0xffff0000, v28
    v_lshlrev_b32 v90, 16, v29
    v_and_b32 v91, 0xffff0000, v29
    v_lshlrev_b32 v92, 16, v30
    v_and_b32 v93, 0xffff0000, v30
    v_lshlrev_b32 v94, 16, v31
    v_and_b32 v95, 0xffff0000, v31
    s_waitcnt vmcnt(13)
    v_lshlrev_b32 v96, 16, v32
    v_and_b32 v97, 0xffff0000, v32
    v_lshlrev_b32 v98, 16, v33
    v_and_b32 v99, 0xffff0000, v33
    v_lshlrev_b32 v100, 16, v34
    v_and_b32 v101, 0xffff0000, v34
    v_lshlrev_b32 v102, 16, v35
    v_and_b32 v103, 0xffff0000, v35
    s_waitcnt vmcnt(12)
    v_lshlrev_b32 v104, 16, v36
    v_and_b32 v105, 0xffff0000, v36
    v_lshlrev_b32 v106, 16, v37
    v_and_b32 v107, 0xffff0000, v37
    v_lshlrev_b32 v108, 16, v38
    v_and_b32 v109, 0xffff0000, v38
    v_lshlrev_b32 v110, 16, v39
    v_and_b32 v111, 0xffff0000, v39
    s_waitcnt vmcnt(11)
    v_lshlrev_b32 v112, 16, v40
    v_and_b32 v113, 0xffff0000, v40
    v_lshlrev_b32 v114, 16, v41
    v_and_b32 v115, 0xffff0000, v41
    v_lshlrev_b32 v116, 16, v42
    v_and_b32 v117, 0xffff0000, v42
    v_lshlrev_b32 v118, 16, v43
    v_and_b32 v119, 0xffff0000, v43
    s_waitcnt vmcnt(10)
    v_lshlrev_b32 v120, 16, v44
    v_and_b32 v121, 0xffff0000, v44
    v_lshlrev_b32 v122, 16, v45
    v_and_b32 v123, 0xffff0000, v45
    v_lshlrev_b32 v124, 16, v46
    v_and_b32 v125, 0xffff0000, v46
    v_lshlrev_b32 v126, 16, v47
    v_and_b32 v127, 0xffff0000, v47
    s_waitcnt vmcnt(9)
    v_lshlrev_b32 v128, 16, v48
    v_and_b32 v129, 0xffff0000, v48
    v_lshlrev_b32 v130, 16, v49
    v_and_b32 v131, 0xffff0000, v49
    v_lshlrev_b32 v132, 16, v50
    v_and_b32 v133, 0xffff0000, v50
    v_lshlrev_b32 v134, 16, v51
    v_and_b32 v135, 0xffff0000, v51
    s_waitcnt vmcnt(8)
    v_lshlrev_b32 v136, 16, v52
    v_and_b32 v137, 0xffff0000, v52
    v_lshlrev_b32 v138, 16, v53
    v_and_b32 v139, 0xffff0000, v53
    v_lshlrev_b32 v140, 16, v54
    v_and_b32 v141, 0xffff0000, v54
    v_lshlrev_b32 v142, 16, v55
    v_and_b32 v143, 0xffff0000, v55
    v_pk_add_f32 v[6:7], v[64:65], v[66:67]
    v_pk_add_f32 v[6:7], v[6:7], v[68:69]
    v_pk_add_f32 v[6:7], v[6:7], v[70:71]
    v_pk_add_f32 v[6:7], v[6:7], v[72:73]
    v_pk_add_f32 v[6:7], v[6:7], v[74:75]
    v_pk_add_f32 v[6:7], v[6:7], v[76:77]
    v_pk_add_f32 v[6:7], v[6:7], v[78:79]
    v_pk_add_f32 v[6:7], v[6:7], v[80:81]
    v_pk_add_f32 v[6:7], v[6:7], v[82:83]
    v_pk_add_f32 v[6:7], v[6:7], v[84:85]
    v_pk_add_f32 v[6:7], v[6:7], v[86:87]
    v_pk_add_f32 v[6:7], v[6:7], v[88:89]
    v_pk_add_f32 v[6:7], v[6:7], v[90:91]
    v_pk_add_f32 v[6:7], v[6:7], v[92:93]
    v_pk_add_f32 v[6:7], v[6:7], v[94:95]
    v_pk_add_f32 v[6:7], v[6:7], v[96:97]
    v_pk_add_f32 v[6:7], v[6:7], v[98:99]
    v_pk_add_f32 v[6:7], v[6:7], v[100:101]
    v_pk_add_f32 v[6:7], v[6:7], v[102:103]
    v_pk_add_f32 v[6:7], v[6:7], v[104:105]
    v_pk_add_f32 v[6:7], v[6:7], v[106:107]
    v_pk_add_f32 v[6:7], v[6:7], v[108:109]
    v_pk_add_f32 v[6:7], v[6:7], v[110:111]
    v_pk_add_f32 v[6:7], v[6:7], v[112:113]
    v_pk_add_f32 v[6:7], v[6:7], v[114:115]
    v_pk_add_f32 v[6:7], v[6:7], v[116:117]
    v_pk_add_f32 v[6:7], v[6:7], v[118:119]
    v_pk_add_f32 v[6:7], v[6:7], v[120:121]
    v_pk_add_f32 v[6:7], v[6:7], v[122:123]
    v_pk_add_f32 v[6:7], v[6:7], v[124:125]
    v_pk_add_f32 v[6:7], v[6:7], v[126:127]
    v_pk_add_f32 v[6:7], v[6:7], v[128:129]
    v_pk_add_f32 v[6:7], v[6:7], v[130:131]
    v_pk_add_f32 v[6:7], v[6:7], v[132:133]
    v_pk_add_f32 v[6:7], v[6:7], v[134:135]
    v_pk_add_f32 v[6:7], v[6:7], v[136:137]
    v_pk_add_f32 v[6:7], v[6:7], v[138:139]
    v_pk_add_f32 v[6:7], v[6:7], v[140:141]
    v_pk_add_f32 v[6:7], v[6:7], v[142:143]
    v_add_f32 v6, v6, v7
    s_nop 1
    v_add_f32_dpp v6, v6, v6 row_ror:8 row_mask:0xf bank_mask:0xf
    v_mov_b32 v7, v6
    s_nop 1
    v_permlane16_swap_b32 v6, v7
    v_add_f32 v6, v6, v7
    v_mov_b32 v7, v6
    s_nop 1
    v_permlane32_swap_b32 v6, v7
    v_add_f32 v6, v6, v7
    v_mul_f32 v6, 0x3acccccd, v6
    v_pk_add_f32 v[12:13], v[64:65], v[6:7] op_sel_hi:[1,0] neg_lo:[0,1] neg_hi:[0,1]
    v_pk_mul_f32 v[8:9], v[12:13], v[12:13]
    v_pk_add_f32 v[12:13], v[66:67], v[6:7] op_sel_hi:[1,0] neg_lo:[0,1] neg_hi:[0,1]
    v_pk_fma_f32 v[8:9], v[12:13], v[12:13], v[8:9]
    v_pk_add_f32 v[12:13], v[68:69], v[6:7] op_sel_hi:[1,0] neg_lo:[0,1] neg_hi:[0,1]
    v_pk_fma_f32 v[8:9], v[12:13], v[12:13], v[8:9]
    v_pk_add_f32 v[12:13], v[70:71], v[6:7] op_sel_hi:[1,0] neg_lo:[0,1] neg_hi:[0,1]
    v_pk_fma_f32 v[8:9], v[12:13], v[12:13], v[8:9]
    v_pk_add_f32 v[12:13], v[72:73], v[6:7] op_sel_hi:[1,0] neg_lo:[0,1] neg_hi:[0,1]
    v_pk_fma_f32 v[8:9], v[12:13], v[12:13], v[8:9]
    v_pk_add_f32 v[12:13], v[74:75], v[6:7] op_sel_hi:[1,0] neg_lo:[0,1] neg_hi:[0,1]
    v_pk_fma_f32 v[8:9], v[12:13], v[12:13], v[8:9]
    v_pk_add_f32 v[12:13], v[76:77], v[6:7] op_sel_hi:[1,0] neg_lo:[0,1] neg_hi:[0,1]
    v_pk_fma_f32 v[8:9], v[12:13], v[12:13], v[8:9]
    v_pk_add_f32 v[12:13], v[78:79], v[6:7] op_sel_hi:[1,0] neg_lo:[0,1] neg_hi:[0,1]
    v_pk_fma_f32 v[8:9], v[12:13], v[12:13], v[8:9]
    v_pk_add_f32 v[12:13], v[80:81], v[6:7] op_sel_hi:[1,0] neg_lo:[0,1] neg_hi:[0,1]
    v_pk_fma_f32 v[8:9], v[12:13], v[12:13], v[8:9]
    v_pk_add_f32 v[12:13], v[82:83], v[6:7] op_sel_hi:[1,0] neg_lo:[0,1] neg_hi:[0,1]
    v_pk_fma_f32 v[8:9], v[12:13], v[12:13], v[8:9]
    v_pk_add_f32 v[12:13], v[84:85], v[6:7] op_sel_hi:[1,0] neg_lo:[0,1] neg_hi:[0,1]
    v_pk_fma_f32 v[8:9], v[12:13], v[12:13], v[8:9]
    v_pk_add_f32 v[12:13], v[86:87], v[6:7] op_sel_hi:[1,0] neg_lo:[0,1] neg_hi:[0,1]
    v_pk_fma_f32 v[8:9], v[12:13], v[12:13], v[8:9]
    v_pk_add_f32 v[12:13], v[88:89], v[6:7] op_sel_hi:[1,0] neg_lo:[0,1] neg_hi:[0,1]
    v_pk_fma_f32 v[8:9], v[12:13], v[12:13], v[8:9]
    v_pk_add_f32 v[12:13], v[90:91], v[6:7] op_sel_hi:[1,0] neg_lo:[0,1] neg_hi:[0,1]
    v_pk_fma_f32 v[8:9], v[12:13], v[12:13], v[8:9]
    v_pk_add_f32 v[12:13], v[92:93], v[6:7] op_sel_hi:[1,0] neg_lo:[0,1] neg_hi:[0,1]
    v_pk_fma_f32 v[8:9], v[12:13], v[12:13], v[8:9]
    v_pk_add_f32 v[12:13], v[94:95], v[6:7] op_sel_hi:[1,0] neg_lo:[0,1] neg_hi:[0,1]
    v_pk_fma_f32 v[8:9], v[12:13], v[12:13], v[8:9]
    v_pk_add_f32 v[12:13], v[96:97], v[6:7] op_sel_hi:[1,0] neg_lo:[0,1] neg_hi:[0,1]
    v_pk_fma_f32 v[8:9], v[12:13], v[12:13], v[8:9]
    v_pk_add_f32 v[12:13], v[98:99], v[6:7] op_sel_hi:[1,0] neg_lo:[0,1] neg_hi:[0,1]
    v_pk_fma_f32 v[8:9], v[12:13], v[12:13], v[8:9]
    v_pk_add_f32 v[12:13], v[100:101], v[6:7] op_sel_hi:[1,0] neg_lo:[0,1] neg_hi:[0,1]
    v_pk_fma_f32 v[8:9], v[12:13], v[12:13], v[8:9]
    v_pk_add_f32 v[12:13], v[102:103], v[6:7] op_sel_hi:[1,0] neg_lo:[0,1] neg_hi:[0,1]
    v_pk_fma_f32 v[8:9], v[12:13], v[12:13], v[8:9]
    v_pk_add_f32 v[12:13], v[104:105], v[6:7] op_sel_hi:[1,0] neg_lo:[0,1] neg_hi:[0,1]
    v_pk_fma_f32 v[8:9], v[12:13], v[12:13], v[8:9]
    v_pk_add_f32 v[12:13], v[106:107], v[6:7] op_sel_hi:[1,0] neg_lo:[0,1] neg_hi:[0,1]
    v_pk_fma_f32 v[8:9], v[12:13], v[12:13], v[8:9]
    v_pk_add_f32 v[12:13], v[108:109], v[6:7] op_sel_hi:[1,0] neg_lo:[0,1] neg_hi:[0,1]
    v_pk_fma_f32 v[8:9], v[12:13], v[12:13], v[8:9]
    v_pk_add_f32 v[12:13], v[110:111], v[6:7] op_sel_hi:[1,0] neg_lo:[0,1] neg_hi:[0,1]
    v_pk_fma_f32 v[8:9], v[12:13], v[12:13], v[8:9]
    v_pk_add_f32 v[12:13], v[112:113], v[6:7] op_sel_hi:[1,0] neg_lo:[0,1] neg_hi:[0,1]
    v_pk_fma_f32 v[8:9], v[12:13], v[12:13], v[8:9]
    v_pk_add_f32 v[12:13], v[114:115], v[6:7] op_sel_hi:[1,0] neg_lo:[0,1] neg_hi:[0,1]
    v_pk_fma_f32 v[8:9], v[12:13], v[12:13], v[8:9]
    v_pk_add_f32 v[12:13], v[116:117], v[6:7] op_sel_hi:[1,0] neg_lo:[0,1] neg_hi:[0,1]
    v_pk_fma_f32 v[8:9], v[12:13], v[12:13], v[8:9]
    v_pk_add_f32 v[12:13], v[118:119], v[6:7] op_sel_hi:[1,0] neg_lo:[0,1] neg_hi:[0,1]
    v_pk_fma_f32 v[8:9], v[12:13], v[12:13], v[8:9]
    v_pk_add_f32 v[12:13], v[120:121], v[6:7] op_sel_hi:[1,0] neg_lo:[0,1] neg_hi:[0,1]
    v_pk_fma_f32 v[8:9], v[12:13], v[12:13], v[8:9]
    v_pk_add_f32 v[12:13], v[122:123], v[6:7] op_sel_hi:[1,0] neg_lo:[0,1] neg_hi:[0,1]
    v_pk_fma_f32 v[8:9], v[12:13], v[12:13], v[8:9]
    v_pk_add_f32 v[12:13], v[124:125], v[6:7] op_sel_hi:[1,0] neg_lo:[0,1] neg_hi:[0,1]
    v_pk_fma_f32 v[8:9], v[12:13], v[12:13], v[8:9]
    v_pk_add_f32 v[12:13], v[126:127], v[6:7] op_sel_hi:[1,0] neg_lo:[0,1] neg_hi:[0,1]
    v_pk_fma_f32 v[8:9], v[12:13], v[12:13], v[8:9]
    v_pk_add_f32 v[12:13], v[128:129], v[6:7] op_sel_hi:[1,0] neg_lo:[0,1] neg_hi:[0,1]
    v_pk_fma_f32 v[8:9], v[12:13], v[12:13], v[8:9]
    v_pk_add_f32 v[12:13], v[130:131], v[6:7] op_sel_hi:[1,0] neg_lo:[0,1] neg_hi:[0,1]
    v_pk_fma_f32 v[8:9], v[12:13], v[12:13], v[8:9]
    v_pk_add_f32 v[12:13], v[132:133], v[6:7] op_sel_hi:[1,0] neg_lo:[0,1] neg_hi:[0,1]
    v_pk_fma_f32 v[8:9], v[12:13], v[12:13], v[8:9]
    v_pk_add_f32 v[12:13], v[134:135], v[6:7] op_sel_hi:[1,0] neg_lo:[0,1] neg_hi:[0,1]
    v_pk_fma_f32 v[8:9], v[12:13], v[12:13], v[8:9]
    v_pk_add_f32 v[12:13], v[136:137], v[6:7] op_sel_hi:[1,0] neg_lo:[0,1] neg_hi:[0,1]
    v_pk_fma_f32 v[8:9], v[12:13], v[12:13], v[8:9]
    v_pk_add_f32 v[12:13], v[138:139], v[6:7] op_sel_hi:[1,0] neg_lo:[0,1] neg_hi:[0,1]
    v_pk_fma_f32 v[8:9], v[12:13], v[12:13], v[8:9]
    v_pk_add_f32 v[12:13], v[140:141], v[6:7] op_sel_hi:[1,0] neg_lo:[0,1] neg_hi:[0,1]
    v_pk_fma_f32 v[8:9], v[12:13], v[12:13], v[8:9]
    v_pk_add_f32 v[12:13], v[142:143], v[6:7] op_sel_hi:[1,0] neg_lo:[0,1] neg_hi:[0,1]
    v_pk_fma_f32 v[8:9], v[12:13], v[12:13], v[8:9]
    v_add_f32 v8, v8, v9
    s_nop 1
    v_add_f32_dpp v8, v8, v8 row_ror:8 row_mask:0xf bank_mask:0xf
    v_mov_b32 v9, v8
    s_nop 1
    v_permlane16_swap_b32 v8, v9
    v_add_f32 v8, v8, v9
    v_mov_b32 v9, v8
    s_nop 1
    v_permlane32_swap_b32 v8, v9
    v_add_f32 v8, v8, v9
    v_mul_f32 v8, 0x3acccccd, v8
    v_cvt_pk_bf16_f32 v6, v6, v6
    v_and_b32 v6, 0xffff0000, v6
    v_cvt_pk_bf16_f32 v8, v8, v8
    v_and_b32 v8, 0xffff0000, v8
    v_add_f32 v8, 0x3727c5ac, v8
    v_cvt_pk_bf16_f32 v8, v8, v8
    v_and_b32 v8, 0xffff0000, v8
    v_sqrt_f32 v8, v8
    s_nop 0
    v_cvt_pk_bf16_f32 v8, v8, v8
    v_and_b32 v8, 0xffff0000, v8
    v_rcp_f32 v8, v8
    v_pk_add_f32 v[64:65], v[64:65], v[6:7] op_sel_hi:[1,0] neg_lo:[0,1] neg_hi:[0,1]
    v_cvt_pk_bf16_f32 v12, v64, v65
    v_lshlrev_b32 v64, 16, v12
    v_and_b32 v65, 0xffff0000, v12
    v_pk_mul_f32 v[64:65], v[64:65], v[8:9] op_sel_hi:[1,0]
    v_cvt_pk_bf16_f32 v16, v64, v65
    v_pk_add_f32 v[66:67], v[66:67], v[6:7] op_sel_hi:[1,0] neg_lo:[0,1] neg_hi:[0,1]
    v_cvt_pk_bf16_f32 v12, v66, v67
    v_lshlrev_b32 v66, 16, v12
    v_and_b32 v67, 0xffff0000, v12
    v_pk_mul_f32 v[66:67], v[66:67], v[8:9] op_sel_hi:[1,0]
    v_cvt_pk_bf16_f32 v17, v66, v67
    v_pk_add_f32 v[68:69], v[68:69], v[6:7] op_sel_hi:[1,0] neg_lo:[0,1] neg_hi:[0,1]
    v_cvt_pk_bf16_f32 v12, v68, v69
    v_lshlrev_b32 v68, 16, v12
    v_and_b32 v69, 0xffff0000, v12
    v_pk_mul_f32 v[68:69], v[68:69], v[8:9] op_sel_hi:[1,0]
    v_cvt_pk_bf16_f32 v18, v68, v69
    v_pk_add_f32 v[70:71], v[70:71], v[6:7] op_sel_hi:[1,0] neg_lo:[0,1] neg_hi:[0,1]
    v_cvt_pk_bf16_f32 v12, v70, v71
    v_lshlrev_b32 v70, 16, v12
    v_and_b32 v71, 0xffff0000, v12
    v_pk_mul_f32 v[70:71], v[70:71], v[8:9] op_sel_hi:[1,0]
    v_cvt_pk_bf16_f32 v19, v70, v71
    buffer_store_dwordx4 v[16:19], v4, s[4:7], s52 offen sc1
    s_add_u32 s52, s52, 4096
    v_pk_add_f32 v[72:73], v[72:73], v[6:7] op_sel_hi:[1,0] neg_lo:[0,1] neg_hi:[0,1]
    v_cvt_pk_bf16_f32 v12, v72, v73
    v_lshlrev_b32 v72, 16, v12
    v_and_b32 v73, 0xffff0000, v12
    v_pk_mul_f32 v[72:73], v[72:73], v[8:9] op_sel_hi:[1,0]
    v_cvt_pk_bf16_f32 v20, v72, v73
    v_pk_add_f32 v[74:75], v[74:75], v[6:7] op_sel_hi:[1,0] neg_lo:[0,1] neg_hi:[0,1]
    v_cvt_pk_bf16_f32 v12, v74, v75
    v_lshlrev_b32 v74, 16, v12
    v_and_b32 v75, 0xffff0000, v12
    v_pk_mul_f32 v[74:75], v[74:75], v[8:9] op_sel_hi:[1,0]
    v_cvt_pk_bf16_f32 v21, v74, v75
    v_pk_add_f32 v[76:77], v[76:77], v[6:7] op_sel_hi:[1,0] neg_lo:[0,1] neg_hi:[0,1]
    v_cvt_pk_bf16_f32 v12, v76, v77
    v_lshlrev_b32 v76, 16, v12
    v_and_b32 v77, 0xffff0000, v12
    v_pk_mul_f32 v[76:77], v[76:77], v[8:9] op_sel_hi:[1,0]
    v_cvt_pk_bf16_f32 v22, v76, v77
    v_pk_add_f32 v[78:79], v[78:79], v[6:7] op_sel_hi:[1,0] neg_lo:[0,1] neg_hi:[0,1]
    v_cvt_pk_bf16_f32 v12, v78, v79
    v_lshlrev_b32 v78, 16, v12
    v_and_b32 v79, 0xffff0000, v12
    v_pk_mul_f32 v[78:79], v[78:79], v[8:9] op_sel_hi:[1,0]
    v_cvt_pk_bf16_f32 v23, v78, v79
    buffer_store_dwordx4 v[20:23], v4, s[4:7], s52 offen sc1
    s_add_u32 s52, s52, 4096
    v_pk_add_f32 v[80:81], v[80:81], v[6:7] op_sel_hi:[1,0] neg_lo:[0,1] neg_hi:[0,1]
    v_cvt_pk_bf16_f32 v12, v80, v81
    v_lshlrev_b32 v80, 16, v12
    v_and_b32 v81, 0xffff0000, v12
    v_pk_mul_f32 v[80:81], v[80:81], v[8:9] op_sel_hi:[1,0]
    v_cvt_pk_bf16_f32 v24, v80, v81
    v_pk_add_f32 v[82:83], v[82:83], v[6:7] op_sel_hi:[1,0] neg_lo:[0,1] neg_hi:[0,1]
    v_cvt_pk_bf16_f32 v12, v82, v83
    v_lshlrev_b32 v82, 16, v12
    v_and_b32 v83, 0xffff0000, v12
    v_pk_mul_f32 v[82:83], v[82:83], v[8:9] op_sel_hi:[1,0]
    v_cvt_pk_bf16_f32 v25, v82, v83
    v_pk_add_f32 v[84:85], v[84:85], v[6:7] op_sel_hi:[1,0] neg_lo:[0,1] neg_hi:[0,1]
    v_cvt_pk_bf16_f32 v12, v84, v85
    v_lshlrev_b32 v84, 16, v12
    v_and_b32 v85, 0xffff0000, v12
    v_pk_mul_f32 v[84:85], v[84:85], v[8:9] op_sel_hi:[1,0]
    v_cvt_pk_bf16_f32 v26, v84, v85
    v_pk_add_f32 v[86:87], v[86:87], v[6:7] op_sel_hi:[1,0] neg_lo:[0,1] neg_hi:[0,1]
    v_cvt_pk_bf16_f32 v12, v86, v87
    v_lshlrev_b32 v86, 16, v12
    v_and_b32 v87, 0xffff0000, v12
    v_pk_mul_f32 v[86:87], v[86:87], v[8:9] op_sel_hi:[1,0]
    v_cvt_pk_bf16_f32 v27, v86, v87
    buffer_store_dwordx4 v[24:27], v4, s[4:7], s52 offen sc1
    s_add_u32 s52, s52, 4096
    v_pk_add_f32 v[88:89], v[88:89], v[6:7] op_sel_hi:[1,0] neg_lo:[0,1] neg_hi:[0,1]
    v_cvt_pk_bf16_f32 v12, v88, v89
    v_lshlrev_b32 v88, 16, v12
    v_and_b32 v89, 0xffff0000, v12
    v_pk_mul_f32 v[88:89], v[88:89], v[8:9] op_sel_hi:[1,0]
    v_cvt_pk_bf16_f32 v28, v88, v89
    v_pk_add_f32 v[90:91], v[90:91], v[6:7] op_sel_hi:[1,0] neg_lo:[0,1] neg_hi:[0,1]
    v_cvt_pk_bf16_f32 v12, v90, v91
    v_lshlrev_b32 v90, 16, v12
    v_and_b32 v91, 0xffff0000, v12
    v_pk_mul_f32 v[90:91], v[90:91], v[8:9] op_sel_hi:[1,0]
    v_cvt_pk_bf16_f32 v29, v90, v91
    v_pk_add_f32 v[92:93], v[92:93], v[6:7] op_sel_hi:[1,0] neg_lo:[0,1] neg_hi:[0,1]
    v_cvt_pk_bf16_f32 v12, v92, v93
    v_lshlrev_b32 v92, 16, v12
    v_and_b32 v93, 0xffff0000, v12
    v_pk_mul_f32 v[92:93], v[92:93], v[8:9] op_sel_hi:[1,0]
    v_cvt_pk_bf16_f32 v30, v92, v93
    v_pk_add_f32 v[94:95], v[94:95], v[6:7] op_sel_hi:[1,0] neg_lo:[0,1] neg_hi:[0,1]
    v_cvt_pk_bf16_f32 v12, v94, v95
    v_lshlrev_b32 v94, 16, v12
    v_and_b32 v95, 0xffff0000, v12
    v_pk_mul_f32 v[94:95], v[94:95], v[8:9] op_sel_hi:[1,0]
    v_cvt_pk_bf16_f32 v31, v94, v95
    buffer_store_dwordx4 v[28:31], v4, s[4:7], s52 offen sc1
    s_add_u32 s52, s52, 4096
    v_pk_add_f32 v[96:97], v[96:97], v[6:7] op_sel_hi:[1,0] neg_lo:[0,1] neg_hi:[0,1]
    v_cvt_pk_bf16_f32 v12, v96, v97
    v_lshlrev_b32 v96, 16, v12
    v_and_b32 v97, 0xffff0000, v12
    v_pk_mul_f32 v[96:97], v[96:97], v[8:9] op_sel_hi:[1,0]
    v_cvt_pk_bf16_f32 v32, v96, v97
    v_pk_add_f32 v[98:99], v[98:99], v[6:7] op_sel_hi:[1,0] neg_lo:[0,1] neg_hi:[0,1]
    v_cvt_pk_bf16_f32 v12, v98, v99
    v_lshlrev_b32 v98, 16, v12
    v_and_b32 v99, 0xffff0000, v12
    v_pk_mul_f32 v[98:99], v[98:99], v[8:9] op_sel_hi:[1,0]
    v_cvt_pk_bf16_f32 v33, v98, v99
    v_pk_add_f32 v[100:101], v[100:101], v[6:7] op_sel_hi:[1,0] neg_lo:[0,1] neg_hi:[0,1]
    v_cvt_pk_bf16_f32 v12, v100, v101
    v_lshlrev_b32 v100, 16, v12
    v_and_b32 v101, 0xffff0000, v12
    v_pk_mul_f32 v[100:101], v[100:101], v[8:9] op_sel_hi:[1,0]
    v_cvt_pk_bf16_f32 v34, v100, v101
    v_pk_add_f32 v[102:103], v[102:103], v[6:7] op_sel_hi:[1,0] neg_lo:[0,1] neg_hi:[0,1]
    v_cvt_pk_bf16_f32 v12, v102, v103
    v_lshlrev_b32 v102, 16, v12
    v_and_b32 v103, 0xffff0000, v12
    v_pk_mul_f32 v[102:103], v[102:103], v[8:9] op_sel_hi:[1,0]
    v_cvt_pk_bf16_f32 v35, v102, v103
    buffer_store_dwordx4 v[32:35], v4, s[4:7], s52 offen sc1
    s_add_u32 s52, s52, 4096
    v_pk_add_f32 v[104:105], v[104:105], v[6:7] op_sel_hi:[1,0] neg_lo:[0,1] neg_hi:[0,1]
    v_cvt_pk_bf16_f32 v12, v104, v105
    v_lshlrev_b32 v104, 16, v12
    v_and_b32 v105, 0xffff0000, v12
    v_pk_mul_f32 v[104:105], v[104:105], v[8:9] op_sel_hi:[1,0]
    v_cvt_pk_bf16_f32 v36, v104, v105
    v_pk_add_f32 v[106:107], v[106:107], v[6:7] op_sel_hi:[1,0] neg_lo:[0,1] neg_hi:[0,1]
    v_cvt_pk_bf16_f32 v12, v106, v107
    v_lshlrev_b32 v106, 16, v12
    v_and_b32 v107, 0xffff0000, v12
    v_pk_mul_f32 v[106:107], v[106:107], v[8:9] op_sel_hi:[1,0]
    v_cvt_pk_bf16_f32 v37, v106, v107
    v_pk_add_f32 v[108:109], v[108:109], v[6:7] op_sel_hi:[1,0] neg_lo:[0,1] neg_hi:[0,1]
    v_cvt_pk_bf16_f32 v12, v108, v109
    v_lshlrev_b32 v108, 16, v12
    v_and_b32 v109, 0xffff0000, v12
    v_pk_mul_f32 v[108:109], v[108:109], v[8:9] op_sel_hi:[1,0]
    v_cvt_pk_bf16_f32 v38, v108, v109
    v_pk_add_f32 v[110:111], v[110:111], v[6:7] op_sel_hi:[1,0] neg_lo:[0,1] neg_hi:[0,1]
    v_cvt_pk_bf16_f32 v12, v110, v111
    v_lshlrev_b32 v110, 16, v12
    v_and_b32 v111, 0xffff0000, v12
    v_pk_mul_f32 v[110:111], v[110:111], v[8:9] op_sel_hi:[1,0]
    v_cvt_pk_bf16_f32 v39, v110, v111
    buffer_store_dwordx4 v[36:39], v4, s[4:7], s52 offen sc1
    s_add_u32 s52, s52, 4096
    v_pk_add_f32 v[112:113], v[112:113], v[6:7] op_sel_hi:[1,0] neg_lo:[0,1] neg_hi:[0,1]
    v_cvt_pk_bf16_f32 v12, v112, v113
    v_lshlrev_b32 v112, 16, v12
    v_and_b32 v113, 0xffff0000, v12
    v_pk_mul_f32 v[112:113], v[112:113], v[8:9] op_sel_hi:[1,0]
    v_cvt_pk_bf16_f32 v40, v112, v113
    v_pk_add_f32 v[114:115], v[114:115], v[6:7] op_sel_hi:[1,0] neg_lo:[0,1] neg_hi:[0,1]
    v_cvt_pk_bf16_f32 v12, v114, v115
    v_lshlrev_b32 v114, 16, v12
    v_and_b32 v115, 0xffff0000, v12
    v_pk_mul_f32 v[114:115], v[114:115], v[8:9] op_sel_hi:[1,0]
    v_cvt_pk_bf16_f32 v41, v114, v115
    v_pk_add_f32 v[116:117], v[116:117], v[6:7] op_sel_hi:[1,0] neg_lo:[0,1] neg_hi:[0,1]
    v_cvt_pk_bf16_f32 v12, v116, v117
    v_lshlrev_b32 v116, 16, v12
    v_and_b32 v117, 0xffff0000, v12
    v_pk_mul_f32 v[116:117], v[116:117], v[8:9] op_sel_hi:[1,0]
    v_cvt_pk_bf16_f32 v42, v116, v117
    v_pk_add_f32 v[118:119], v[118:119], v[6:7] op_sel_hi:[1,0] neg_lo:[0,1] neg_hi:[0,1]
    v_cvt_pk_bf16_f32 v12, v118, v119
    v_lshlrev_b32 v118, 16, v12
    v_and_b32 v119, 0xffff0000, v12
    v_pk_mul_f32 v[118:119], v[118:119], v[8:9] op_sel_hi:[1,0]
    v_cvt_pk_bf16_f32 v43, v118, v119
    buffer_store_dwordx4 v[40:43], v4, s[4:7], s52 offen sc1
    s_add_u32 s52, s52, 4096
    v_pk_add_f32 v[120:121], v[120:121], v[6:7] op_sel_hi:[1,0] neg_lo:[0,1] neg_hi:[0,1]
    v_cvt_pk_bf16_f32 v12, v120, v121
    v_lshlrev_b32 v120, 16, v12
    v_and_b32 v121, 0xffff0000, v12
    v_pk_mul_f32 v[120:121], v[120:121], v[8:9] op_sel_hi:[1,0]
    v_cvt_pk_bf16_f32 v44, v120, v121
    v_pk_add_f32 v[122:123], v[122:123], v[6:7] op_sel_hi:[1,0] neg_lo:[0,1] neg_hi:[0,1]
    v_cvt_pk_bf16_f32 v12, v122, v123
    v_lshlrev_b32 v122, 16, v12
    v_and_b32 v123, 0xffff0000, v12
    v_pk_mul_f32 v[122:123], v[122:123], v[8:9] op_sel_hi:[1,0]
    v_cvt_pk_bf16_f32 v45, v122, v123
    v_pk_add_f32 v[124:125], v[124:125], v[6:7] op_sel_hi:[1,0] neg_lo:[0,1] neg_hi:[0,1]
    v_cvt_pk_bf16_f32 v12, v124, v125
    v_lshlrev_b32 v124, 16, v12
    v_and_b32 v125, 0xffff0000, v12
    v_pk_mul_f32 v[124:125], v[124:125], v[8:9] op_sel_hi:[1,0]
    v_cvt_pk_bf16_f32 v46, v124, v125
    v_pk_add_f32 v[126:127], v[126:127], v[6:7] op_sel_hi:[1,0] neg_lo:[0,1] neg_hi:[0,1]
    v_cvt_pk_bf16_f32 v12, v126, v127
    v_lshlrev_b32 v126, 16, v12
    v_and_b32 v127, 0xffff0000, v12
    v_pk_mul_f32 v[126:127], v[126:127], v[8:9] op_sel_hi:[1,0]
    v_cvt_pk_bf16_f32 v47, v126, v127
    buffer_store_dwordx4 v[44:47], v4, s[4:7], s52 offen sc1
    s_add_u32 s52, s52, 4096
    v_pk_add_f32 v[128:129], v[128:129], v[6:7] op_sel_hi:[1,0] neg_lo:[0,1] neg_hi:[0,1]
    v_cvt_pk_bf16_f32 v12, v128, v129
    v_lshlrev_b32 v128, 16, v12
    v_and_b32 v129, 0xffff0000, v12
    v_pk_mul_f32 v[128:129], v[128:129], v[8:9] op_sel_hi:[1,0]
    v_cvt_pk_bf16_f32 v48, v128, v129
    v_pk_add_f32 v[130:131], v[130:131], v[6:7] op_sel_hi:[1,0] neg_lo:[0,1] neg_hi:[0,1]
    v_cvt_pk_bf16_f32 v12, v130, v131
    v_lshlrev_b32 v130, 16, v12
    v_and_b32 v131, 0xffff0000, v12
    v_pk_mul_f32 v[130:131], v[130:131], v[8:9] op_sel_hi:[1,0]
    v_cvt_pk_bf16_f32 v49, v130, v131
    v_pk_add_f32 v[132:133], v[132:133], v[6:7] op_sel_hi:[1,0] neg_lo:[0,1] neg_hi:[0,1]
    v_cvt_pk_bf16_f32 v12, v132, v133
    v_lshlrev_b32 v132, 16, v12
    v_and_b32 v133, 0xffff0000, v12
    v_pk_mul_f32 v[132:133], v[132:133], v[8:9] op_sel_hi:[1,0]
    v_cvt_pk_bf16_f32 v50, v132, v133
    v_pk_add_f32 v[134:135], v[134:135], v[6:7] op_sel_hi:[1,0] neg_lo:[0,1] neg_hi:[0,1]
    v_cvt_pk_bf16_f32 v12, v134, v135
    v_lshlrev_b32 v134, 16, v12
    v_and_b32 v135, 0xffff0000, v12
    v_pk_mul_f32 v[134:135], v[134:135], v[8:9] op_sel_hi:[1,0]
    v_cvt_pk_bf16_f32 v51, v134, v135
    buffer_store_dwordx4 v[48:51], v4, s[4:7], s52 offen sc1
    s_add_u32 s52, s52, 4096
    v_pk_add_f32 v[136:137], v[136:137], v[6:7] op_sel_hi:[1,0] neg_lo:[0,1] neg_hi:[0,1]
    v_cvt_pk_bf16_f32 v12, v136, v137
    v_lshlrev_b32 v136, 16, v12
    v_and_b32 v137, 0xffff0000, v12
    v_pk_mul_f32 v[136:137], v[136:137], v[8:9] op_sel_hi:[1,0]
    v_cvt_pk_bf16_f32 v52, v136, v137
    v_pk_add_f32 v[138:139], v[138:139], v[6:7] op_sel_hi:[1,0] neg_lo:[0,1] neg_hi:[0,1]
    v_cvt_pk_bf16_f32 v12, v138, v139
    v_lshlrev_b32 v138, 16, v12
    v_and_b32 v139, 0xffff0000, v12
    v_pk_mul_f32 v[138:139], v[138:139], v[8:9] op_sel_hi:[1,0]
    v_cvt_pk_bf16_f32 v53, v138, v139
    v_pk_add_f32 v[140:141], v[140:141], v[6:7] op_sel_hi:[1,0] neg_lo:[0,1] neg_hi:[0,1]
    v_cvt_pk_bf16_f32 v12, v140, v141
    v_lshlrev_b32 v140, 16, v12
    v_and_b32 v141, 0xffff0000, v12
    v_pk_mul_f32 v[140:141], v[140:141], v[8:9] op_sel_hi:[1,0]
    v_cvt_pk_bf16_f32 v54, v140, v141
    v_pk_add_f32 v[142:143], v[142:143], v[6:7] op_sel_hi:[1,0] neg_lo:[0,1] neg_hi:[0,1]
    v_cvt_pk_bf16_f32 v12, v142, v143
    v_lshlrev_b32 v142, 16, v12
    v_and_b32 v143, 0xffff0000, v12
    v_pk_mul_f32 v[142:143], v[142:143], v[8:9] op_sel_hi:[1,0]
    v_cvt_pk_bf16_f32 v55, v142, v143
    buffer_store_dwordx4 v[52:55], v4, s[4:7], s52 offen sc1
    s_waitcnt vmcnt(0)
    s_barrier
    s_cmp_lg_u32 s16, 0
    s_cbranch_scc1 L_aux1
    v_mov_b32 v4, 1
    v_mov_b32 v5, 0
    s_mov_b64 exec, 1
    buffer_atomic_add v4, v5, s[12:15], 0 offen sc1
    s_mov_b64 exec, -1
L_aux1:
    s_cmp_eq_u32 s18, 3
    s_cbranch_scc1 L_exit
    v_and_b32 v10, 63, v0
    v_lshlrev_b32 v1, 4, v10
    s_mul_i32 s32, s16, 40960
    v_lshrrev_b32 v11, 5, v10
    v_lshlrev_b32 v11, 8, v11
    v_bfe_u32 v12, v10, 2, 2
    v_lshl_add_u32 v11, v12, 6, v11
    v_bfe_u32 v12, v10, 4, 1
    v_lshl_add_u32 v11, v12, 5, v11
    v_and_b32 v12, 3, v10
    v_lshl_add_u32 v11, v12, 3, v11
    v_add_u32 v2, s32, v11
    s_mov_b32 s8, s74
    s_and_b32 s9, s75, 0xffff
    s_mov_b32 s10, 0x500000
    s_mov_b32 s11, 0x20000
    s_mov_b32 s20, s84
    s_and_b32 s21, s85, 0xffff
    s_mov_b32 s22, 0x21c000
    s_mov_b32 s23, 0x20000
    v_lshrrev_b32 v11, 2, v10
    v_and_b32 v12, 3, v10
    v_mul_u32_u24 v14, 1280, v11
    v_lshl_add_u32 v14, v12, 4, v14
    v_lshrrev_b32 v13, 3, v11
    v_lshlrev_b32 v13, 4, v13
    v_and_b32 v11, 7, v11
    v_add_u32 v13, v13, v11
    v_mul_u32_u24 v13, 1280, v13
    v_lshl_add_u32 v13, v12, 4, v13
    s_lshl_b32 s50, s17, 6
    s_mul_i32 s51, s16, 1310720
    s_add_u32 s51, s51, s50
    s_mul_i32 s52, s16, 552960
    s_add_u32 s52, s52, s50
    s_add_u32 m0, s32, 0
    s_add_u32 s53, s51, 0
    buffer_load_dwordx4 v13, s[8:11], s53 offen lds
    s_add_u32 m0, s32, 1024
    s_add_u32 s53, s51, 10240
    buffer_load_dwordx4 v13, s[8:11], s53 offen lds
    s_add_u32 m0, s32, 2048
    s_add_u32 s53, s51, 40960
    buffer_load_dwordx4 v13, s[8:11], s53 offen lds
    s_add_u32 m0, s32, 3072
    s_add_u32 s53, s51, 51200
    buffer_load_dwordx4 v13, s[8:11], s53 offen lds
    s_add_u32 m0, s32, 4096
    s_add_u32 s53, s51, 81920
    buffer_load_dwordx4 v13, s[8:11], s53 offen lds
    s_add_u32 m0, s32, 5120
    s_add_u32 s53, s51, 92160
    buffer_load_dwordx4 v13, s[8:11], s53 offen lds
    s_add_u32 m0, s32, 6144
    s_add_u32 s53, s51, 122880
    buffer_load_dwordx4 v13, s[8:11], s53 offen lds
    s_add_u32 m0, s32, 7168
    s_add_u32 s53, s51, 133120
    buffer_load_dwordx4 v13, s[8:11], s53 offen lds
    s_add_u32 m0, s32, 8192
    s_add_u32 s53, s51, 163840
    buffer_load_dwordx4 v13, s[8:11], s53 offen lds
    s_add_u32 m0, s32, 9216
    s_add_u32 s53, s51, 174080
    buffer_load_dwordx4 v13, s[8:11], s53 offen lds
    s_add_u32 m0, s32, 10240
    s_add_u32 s53, s51, 204800
    buffer_load_dwordx4 v13, s[8:11], s53 offen lds
    s_add_u32 m0, s32, 11264
    s_add_u32 s53, s51, 215040
    buffer_load_dwordx4 v13, s[8:11], s53 offen lds
    s_add_u32 m0, s32, 12288
    s_add_u32 s53, s51, 245760
    buffer_load_dwordx4 v13, s[8:11], s53 offen lds
    s_add_u32 m0, s32, 13312
    s_add_u32 s53, s51, 256000
    buffer_load_dwordx4 v13, s[8:11], s53 offen lds
    s_add_u32 m0, s32, 14336
    s_add_u32 s53, s51, 286720
    buffer_load_dwordx4 v13, s[8:11], s53 offen lds
    s_add_u32 m0, s32, 15360
    s_add_u32 s53, s51, 296960
    buffer_load_dwordx4 v13, s[8:11], s53 offen lds
    s_add_u32 m0, s32, 16384
    s_add_u32 s53, s51, 327680
    buffer_load_dwordx4 v13, s[8:11], s53 offen lds
    s_add_u32 m0, s32, 17408
    s_add_u32 s53, s51, 337920
    buffer_load_dwordx4 v13, s[8:11], s53 offen lds
    s_add_u32 m0, s32, 18432
    s_add_u32 s53, s51, 368640
    buffer_load_dwordx4 v13, s[8:11], s53 offen lds
    s_add_u32 m0, s32, 19456
    s_add_u32 s53, s51, 378880
    buffer_load_dwordx4 v13, s[8:11], s53 offen lds
    s_add_u32 m0, s32, 20480
    s_add_u32 s53, s51, 409600
    buffer_load_dwordx4 v13, s[8:11], s53 offen lds
    s_add_u32 m0, s32, 21504
    s_add_u32 s53, s51, 419840
    buffer_load_dwordx4 v13, s[8:11], s53 offen lds
    s_add_u32 m0, s32, 22528
    s_add_u32 s53, s51, 450560
    buffer_load_dwordx4 v13, s[8:11], s53 offen lds
    s_add_u32 m0, s32, 23552
    s_add_u32 s53, s51, 460800
    buffer_load_dwordx4 v13, s[8:11], s53 offen lds
    s_add_u32 m0, s32, 24576
    s_add_u32 s53, s51, 491520
    buffer_load_dwordx4 v13, s[8:11], s53 offen lds
    s_add_u32 m0, s32, 25600
    s_add_u32 s53, s51, 501760
    buffer_load_dwordx4 v13, s[8:11], s53 offen lds
    s_add_u32 m0, s32, 26624
    s_add_u32 s53, s51, 532480
    buffer_load_dwordx4 v13, s[8:11], s53 offen lds
    s_add_u32 m0, s32, 27648
    s_add_u32 s53, s51, 542720
    buffer_load_dwordx4 v13, s[8:11], s53 offen lds
    s_add_u32 m0, s32, 28672
    s_add_u32 s53, s51, 573440
    buffer_load_dwordx4 v13, s[8:11], s53 offen lds
    s_add_u32 m0, s32, 29696
    s_add_u32 s53, s51, 583680
    buffer_load_dwordx4 v13, s[8:11], s53 offen lds
    s_add_u32 m0, s32, 30720
    s_add_u32 s53, s51, 614400
    buffer_load_dwordx4 v13, s[8:11], s53 offen lds
    s_add_u32 m0, s32, 31744
    s_add_u32 s53, s51, 624640
    buffer_load_dwordx4 v13, s[8:11], s53 offen lds
    s_add_u32 m0, s32, 32768
    s_add_u32 s53, s51, 655360
    buffer_load_dwordx4 v13, s[8:11], s53 offen lds
    s_add_u32 m0, s32, 33792
    s_add_u32 s53, s51, 665600
    buffer_load_dwordx4 v13, s[8:11], s53 offen lds
    s_add_u32 m0, s32, 34816
    s_add_u32 s53, s51, 696320
    buffer_load_dwordx4 v13, s[8:11], s53 offen lds
    s_add_u32 m0, s32, 35840
    s_add_u32 s53, s51, 706560
    buffer_load_dwordx4 v13, s[8:11], s53 offen lds
    s_add_u32 m0, s32, 36864
    s_add_u32 s53, s51, 737280
    buffer_load_dwordx4 v13, s[8:11], s53 offen lds
    s_add_u32 m0, s32, 37888
    s_add_u32 s53, s51, 747520
    buffer_load_dwordx4 v13, s[8:11], s53 offen lds
    s_add_u32 m0, s32, 38912
    s_add_u32 s53, s51, 778240
    buffer_load_dwordx4 v13, s[8:11], s53 offen lds
    s_add_u32 m0, s32, 39936
    s_add_u32 s53, s51, 788480
    buffer_load_dwordx4 v13, s[8:11], s53 offen lds
    s_waitcnt vmcnt(39)
    ds_read_b64_tr_b16 a[0:1], v2 offset:0
    ds_read_b64_tr_b16 a[2:3], v2 offset:512
    s_waitcnt vmcnt(38)
    ds_read_b64_tr_b16 a[4:5], v2 offset:1024
    ds_read_b64_tr_b16 a[6:7], v2 offset:1536
    s_waitcnt lgkmcnt(2)
    s_add_u32 m0, s32, 0
    s_add_u32 s53, s51, 819200
    buffer_load_dwordx4 v13, s[8:11], s53 offen lds
    s_waitcnt vmcnt(38)
    ds_read_b64_tr_b16 a[8:9], v2 offset:2048
    ds_read_b64_tr_b16 a[10:11], v2 offset:2560
    s_waitcnt lgkmcnt(2)
    s_add_u32 m0, s32, 1024
    s_add_u32 s53, s51, 829440
    buffer_load_dwordx4 v13, s[8:11], s53 offen lds
    s_waitcnt vmcnt(38)
    ds_read_b64_tr_b16 a[12:13], v2 offset:3072
    ds_read_b64_tr_b16 a[14:15], v2 offset:3584
    s_waitcnt lgkmcnt(2)
    s_add_u32 m0, s32, 2048
    s_add_u32 s53, s51, 860160
    buffer_load_dwordx4 v13, s[8:11], s53 offen lds
    s_waitcnt vmcnt(38)
    ds_read_b64_tr_b16 a[16:17], v2 offset:4096
    ds_read_b64_tr_b16 a[18:19], v2 offset:4608
    s_waitcnt lgkmcnt(2)
    s_add_u32 m0, s32, 3072
    s_add_u32 s53, s51, 870400
    buffer_load_dwordx4 v13, s[8:11], s53 offen lds
    s_waitcnt vmcnt(38)
    ds_read_b64_tr_b16 a[20:21], v2 offset:5120
    ds_read_b64_tr_b16 a[22:23], v2 offset:5632
    s_waitcnt lgkmcnt(2)
    s_add_u32 m0, s32, 4096
    s_add_u32 s53, s51, 901120
    buffer_load_dwordx4 v13, s[8:11], s53 offen lds
    s_waitcnt vmcnt(38)
    ds_read_b64_tr_b16 a[24:25], v2 offset:6144
    ds_read_b64_tr_b16 a[26:27], v2 offset:6656
    s_waitcnt lgkmcnt(2)
    s_add_u32 m0, s32, 5120
    s_add_u32 s53, s51, 911360
    buffer_load_dwordx4 v13, s[8:11], s53 offen lds
    s_waitcnt vmcnt(38)
    ds_read_b64_tr_b16 a[28:29], v2 offset:7168
    ds_read_b64_tr_b16 a[30:31], v2 offset:7680
    s_waitcnt lgkmcnt(2)
    s_add_u32 m0, s32, 6144
    s_add_u32 s53, s51, 942080
    buffer_load_dwordx4 v13, s[8:11], s53 offen lds
    s_waitcnt vmcnt(38)
    ds_read_b64_tr_b16 a[32:33], v2 offset:8192
    ds_read_b64_tr_b16 a[34:35], v2 offset:8704
    s_waitcnt lgkmcnt(2)
    s_add_u32 m0, s32, 7168
    s_add_u32 s53, s51, 952320
    buffer_load_dwordx4 v13, s[8:11], s53 offen lds
    s_waitcnt vmcnt(38)
    ds_read_b64_tr_b16 a[36:37], v2 offset:9216
    ds_read_b64_tr_b16 a[38:39], v2 offset:9728
    s_waitcnt lgkmcnt(2)
    s_add_u32 m0, s32, 8192
    s_add_u32 s53, s51, 983040
    buffer_load_dwordx4 v13, s[8:11], s53 offen lds
    s_waitcnt vmcnt(38)
    ds_read_b64_tr_b16 a[40:41], v2 offset:10240
    ds_read_b64_tr_b16 a[42:43], v2 offset:10752
    s_waitcnt lgkmcnt(2)
    s_add_u32 m0, s32, 9216
    s_add_u32 s53, s51, 993280
    buffer_load_dwordx4 v13, s[8:11], s53 offen lds
    s_waitcnt vmcnt(38)
    ds_read_b64_tr_b16 a[44:45], v2 offset:11264
    ds_read_b64_tr_b16 a[46:47], v2 offset:11776
    s_waitcnt lgkmcnt(2)
    s_add_u32 m0, s32, 10240
    s_add_u32 s53, s51, 1024000
    buffer_load_dwordx4 v13, s[8:11], s53 offen lds
    s_waitcnt vmcnt(38)
    ds_read_b64_tr_b16 a[48:49], v2 offset:12288
    ds_read_b64_tr_b16 a[50:51], v2 offset:12800
    s_waitcnt lgkmcnt(2)
    s_add_u32 m0, s32, 11264
    s_add_u32 s53, s51, 1034240
    buffer_load_dwordx4 v13, s[8:11], s53 offen lds
    s_waitcnt vmcnt(38)
    ds_read_b64_tr_b16 a[52:53], v2 offset:13312
    ds_read_b64_tr_b16 a[54:55], v2 offset:13824
    s_waitcnt lgkmcnt(2)
    s_add_u32 m0, s32, 12288
    s_add_u32 s53, s51, 1064960
    buffer_load_dwordx4 v13, s[8:11], s53 offen lds
    s_waitcnt vmcnt(38)
    ds_read_b64_tr_b16 a[56:57], v2 offset:14336
    ds_read_b64_tr_b16 a[58:59], v2 offset:14848
    s_waitcnt lgkmcnt(2)
    s_add_u32 m0, s32, 13312
    s_add_u32 s53, s51, 1075200
    buffer_load_dwordx4 v13, s[8:11], s53 offen lds
    s_waitcnt vmcnt(38)
    ds_read_b64_tr_b16 a[60:61], v2 offset:15360
    ds_read_b64_tr_b16 a[62:63], v2 offset:15872
    s_waitcnt lgkmcnt(2)
    s_add_u32 m0, s32, 14336
    s_add_u32 s53, s51, 1105920
    buffer_load_dwordx4 v13, s[8:11], s53 offen lds
    s_waitcnt vmcnt(38)
    ds_read_b64_tr_b16 a[64:65], v2 offset:16384
    ds_read_b64_tr_b16 a[66:67], v2 offset:16896
    s_waitcnt lgkmcnt(2)
    s_add_u32 m0, s32, 15360
    s_add_u32 s53, s51, 1116160
    buffer_load_dwordx4 v13, s[8:11], s53 offen lds
    s_waitcnt vmcnt(38)
    ds_read_b64_tr_b16 a[68:69], v2 offset:17408
    ds_read_b64_tr_b16 a[70:71], v2 offset:17920
    s_waitcnt lgkmcnt(2)
    s_add_u32 m0, s32, 16384
    s_add_u32 s53, s51, 1146880
    buffer_load_dwordx4 v13, s[8:11], s53 offen lds
    s_waitcnt vmcnt(38)
    ds_read_b64_tr_b16 a[72:73], v2 offset:18432
    ds_read_b64_tr_b16 a[74:75], v2 offset:18944
    s_waitcnt lgkmcnt(2)
    s_add_u32 m0, s32, 17408
    s_add_u32 s53, s51, 1157120
    buffer_load_dwordx4 v13, s[8:11], s53 offen lds
    s_waitcnt vmcnt(38)
    ds_read_b64_tr_b16 a[76:77], v2 offset:19456
    ds_read_b64_tr_b16 a[78:79], v2 offset:19968
    s_waitcnt lgkmcnt(2)
    s_add_u32 m0, s32, 18432
    s_add_u32 s53, s51, 1187840
    buffer_load_dwordx4 v13, s[8:11], s53 offen lds
    s_waitcnt vmcnt(38)
    ds_read_b64_tr_b16 a[80:81], v2 offset:20480
    ds_read_b64_tr_b16 a[82:83], v2 offset:20992
    s_waitcnt lgkmcnt(2)
    s_add_u32 m0, s32, 19456
    s_add_u32 s53, s51, 1198080
    buffer_load_dwordx4 v13, s[8:11], s53 offen lds
    s_waitcnt vmcnt(38)
    ds_read_b64_tr_b16 a[84:85], v2 offset:21504
    ds_read_b64_tr_b16 a[86:87], v2 offset:22016
    s_waitcnt lgkmcnt(2)
    s_add_u32 m0, s32, 20480
    s_add_u32 s53, s51, 1228800
    buffer_load_dwordx4 v13, s[8:11], s53 offen lds
    s_waitcnt vmcnt(38)
    ds_read_b64_tr_b16 a[88:89], v2 offset:22528
    ds_read_b64_tr_b16 a[90:91], v2 offset:23040
    s_waitcnt lgkmcnt(2)
    s_add_u32 m0, s32, 21504
    s_add_u32 s53, s51, 1239040
    buffer_load_dwordx4 v13, s[8:11], s53 offen lds
    s_waitcnt vmcnt(38)
    ds_read_b64_tr_b16 a[92:93], v2 offset:23552
    ds_read_b64_tr_b16 a[94:95], v2 offset:24064
    s_waitcnt lgkmcnt(2)
    s_add_u32 m0, s32, 22528
    s_add_u32 s53, s51, 1269760
    buffer_load_dwordx4 v13, s[8:11], s53 offen lds
    s_waitcnt vmcnt(38)
    ds_read_b64_tr_b16 a[96:97], v2 offset:24576
    ds_read_b64_tr_b16 a[98:99], v2 offset:25088
    s_waitcnt lgkmcnt(2)
    s_add_u32 m0, s32, 23552
    s_add_u32 s53, s51, 1280000
    buffer_load_dwordx4 v13, s[8:11], s53 offen lds
    s_waitcnt vmcnt(38)
    ds_read_b64_tr_b16 a[100:101], v2 offset:25600
    ds_read_b64_tr_b16 a[102:103], v2 offset:26112
    s_waitcnt lgkmcnt(2)
    s_add_u32 m0, s32, 24576
    s_add_u32 s53, s52, 0
    buffer_load_dwordx4 v14, s[20:23], s53 offen lds
    s_waitcnt vmcnt(38)
    ds_read_b64_tr_b16 a[104:105], v2 offset:26624
    ds_read_b64_tr_b16 a[106:107], v2 offset:27136
    s_waitcnt lgkmcnt(2)
    s_add_u32 m0, s32, 25600
    s_add_u32 s53, s52, 20480
    buffer_load_dwordx4 v14, s[20:23], s53 offen lds
    s_waitcnt vmcnt(38)
    ds_read_b64_tr_b16 a[108:109], v2 offset:27648
    ds_read_b64_tr_b16 a[110:111], v2 offset:28160
    s_waitcnt lgkmcnt(2)
    s_add_u32 m0, s32, 26624
    s_add_u32 s53, s52, 40960
    buffer_load_dwordx4 v14, s[20:23], s53 offen lds
    s_waitcnt vmcnt(38)
    ds_read_b64_tr_b16 a[112:113], v2 offset:28672
    ds_read_b64_tr_b16 a[114:115], v2 offset:29184
    s_waitcnt lgkmcnt(2)
    s_add_u32 m0, s32, 27648
    s_add_u32 s53, s52, 61440
    buffer_load_dwordx4 v14, s[20:23], s53 offen lds
    s_waitcnt vmcnt(38)
    ds_read_b64_tr_b16 a[116:117], v2 offset:29696
    ds_read_b64_tr_b16 a[118:119], v2 offset:30208
    s_waitcnt lgkmcnt(2)
    s_add_u32 m0, s32, 28672
    s_add_u32 s53, s52, 81920
    buffer_load_dwordx4 v14, s[20:23], s53 offen lds
    s_waitcnt vmcnt(38)
    ds_read_b64_tr_b16 a[120:121], v2 offset:30720
    ds_read_b64_tr_b16 a[122:123], v2 offset:31232
    s_waitcnt lgkmcnt(2)
    s_add_u32 m0, s32, 29696
    s_add_u32 s53, s52, 102400
    buffer_load_dwordx4 v14, s[20:23], s53 offen lds
    s_waitcnt vmcnt(38)
    ds_read_b64_tr_b16 a[124:125], v2 offset:31744
    ds_read_b64_tr_b16 a[126:127], v2 offset:32256
    s_waitcnt lgkmcnt(2)
    s_add_u32 m0, s32, 30720
    s_add_u32 s53, s52, 122880
    buffer_load_dwordx4 v14, s[20:23], s53 offen lds
    s_waitcnt vmcnt(38)
    ds_read_b64_tr_b16 a[128:129], v2 offset:32768
    ds_read_b64_tr_b16 a[130:131], v2 offset:33280
    s_waitcnt lgkmcnt(2)
    s_add_u32 m0, s32, 31744
    s_add_u32 s53, s52, 143360
    buffer_load_dwordx4 v14, s[20:23], s53 offen lds
    s_waitcnt vmcnt(38)
    ds_read_b64_tr_b16 a[132:133], v2 offset:33792
    ds_read_b64_tr_b16 a[134:135], v2 offset:34304
    s_waitcnt lgkmcnt(2)
    s_add_u32 m0, s32, 32768
    s_add_u32 s53, s52, 163840
    buffer_load_dwordx4 v14, s[20:23], s53 offen lds
    s_waitcnt vmcnt(38)
    ds_read_b64_tr_b16 a[136:137], v2 offset:34816
    ds_read_b64_tr_b16 a[138:139], v2 offset:35328
    s_waitcnt lgkmcnt(2)
    s_add_u32 m0, s32, 33792
    s_add_u32 s53, s52, 184320
    buffer_load_dwordx4 v14, s[20:23], s53 offen lds
    s_waitcnt vmcnt(38)
    ds_read_b64_tr_b16 a[140:141], v2 offset:35840
    ds_read_b64_tr_b16 a[142:143], v2 offset:36352
    s_waitcnt lgkmcnt(2)
    s_add_u32 m0, s32, 34816
    s_add_u32 s53, s52, 204800
    buffer_load_dwordx4 v14, s[20:23], s53 offen lds
    s_waitcnt vmcnt(38)
    ds_read_b64_tr_b16 a[144:145], v2 offset:36864
    ds_read_b64_tr_b16 a[146:147], v2 offset:37376
    s_waitcnt lgkmcnt(2)
    s_add_u32 m0, s32, 35840
    s_add_u32 s53, s52, 225280
    buffer_load_dwordx4 v14, s[20:23], s53 offen lds
    s_waitcnt vmcnt(38)
    ds_read_b64_tr_b16 a[148:149], v2 offset:37888
    ds_read_b64_tr_b16 a[150:151], v2 offset:38400
    s_waitcnt lgkmcnt(2)
    s_add_u32 m0, s32, 36864
    s_add_u32 s53, s52, 245760
    buffer_load_dwordx4 v14, s[20:23], s53 offen lds
    s_waitcnt vmcnt(38)
    ds_read_b64_tr_b16 a[152:153], v2 offset:38912
    ds_read_b64_tr_b16 a[154:155], v2 offset:39424
    s_waitcnt lgkmcnt(2)
    s_add_u32 m0, s32, 37888
    s_add_u32 s53, s52, 266240
    buffer_load_dwordx4 v14, s[20:23], s53 offen lds
    s_waitcnt vmcnt(38)
    ds_read_b64_tr_b16 a[156:157], v2 offset:39936
    ds_read_b64_tr_b16 a[158:159], v2 offset:40448
    s_waitcnt lgkmcnt(2)
    s_add_u32 m0, s32, 38912
    s_add_u32 s53, s52, 286720
    buffer_load_dwordx4 v14, s[20:23], s53 offen lds
    s_waitcnt vmcnt(38)
    ds_read_b64_tr_b16 a[160:161], v2 offset:0
    ds_read_b64_tr_b16 a[162:163], v2 offset:512
    s_waitcnt lgkmcnt(2)
    s_add_u32 m0, s32, 39936
    s_add_u32 s53, s52, 307200
    buffer_load_dwordx4 v14, s[20:23], s53 offen lds
    s_waitcnt vmcnt(38)
    ds_read_b64_tr_b16 a[164:165], v2 offset:1024
    ds_read_b64_tr_b16 a[166:167], v2 offset:1536
    s_waitcnt lgkmcnt(2)
    s_add_u32 m0, s32, 0
    s_add_u32 s53, s52, 327680
    buffer_load_dwordx4 v14, s[20:23], s53 offen lds
    s_waitcnt vmcnt(38)
    ds_read_b64_tr_b16 a[168:169], v2 offset:2048
    ds_read_b64_tr_b16 a[170:171], v2 offset:2560
    s_waitcnt lgkmcnt(2)
    s_add_u32 m0, s32, 1024
    s_add_u32 s53, s52, 348160
    buffer_load_dwordx4 v14, s[20:23], s53 offen lds
    s_waitcnt vmcnt(38)
    ds_read_b64_tr_b16 a[172:173], v2 offset:3072
    ds_read_b64_tr_b16 a[174:175], v2 offset:3584
    s_waitcnt lgkmcnt(2)
    s_add_u32 m0, s32, 2048
    s_add_u32 s53, s52, 368640
    buffer_load_dwordx4 v14, s[20:23], s53 offen lds
    s_waitcnt vmcnt(38)
    ds_read_b64_tr_b16 a[176:177], v2 offset:4096
    ds_read_b64_tr_b16 a[178:179], v2 offset:4608
    s_waitcnt lgkmcnt(2)
    s_add_u32 m0, s32, 3072
    s_add_u32 s53, s52, 389120
    buffer_load_dwordx4 v14, s[20:23], s53 offen lds
    s_waitcnt vmcnt(38)
    ds_read_b64_tr_b16 a[180:181], v2 offset:5120
    ds_read_b64_tr_b16 a[182:183], v2 offset:5632
    s_waitcnt lgkmcnt(2)
    s_add_u32 m0, s32, 4096
    s_add_u32 s53, s52, 409600
    buffer_load_dwordx4 v14, s[20:23], s53 offen lds
    s_waitcnt vmcnt(38)
    ds_read_b64_tr_b16 a[184:185], v2 offset:6144
    ds_read_b64_tr_b16 a[186:187], v2 offset:6656
    s_waitcnt lgkmcnt(2)
    s_add_u32 m0, s32, 5120
    s_add_u32 s53, s52, 430080
    buffer_load_dwordx4 v14, s[20:23], s53 offen lds
    s_waitcnt vmcnt(38)
    ds_read_b64_tr_b16 a[188:189], v2 offset:7168
    ds_read_b64_tr_b16 a[190:191], v2 offset:7680
    s_waitcnt lgkmcnt(2)
    s_add_u32 m0, s32, 6144
    s_add_u32 s53, s52, 450560
    buffer_load_dwordx4 v14, s[20:23], s53 offen lds
    s_waitcnt vmcnt(38)
    ds_read_b64_tr_b16 a[192:193], v2 offset:8192
    ds_read_b64_tr_b16 a[194:195], v2 offset:8704
    s_waitcnt lgkmcnt(2)
    s_add_u32 m0, s32, 7168
    s_add_u32 s53, s52, 471040
    buffer_load_dwordx4 v14, s[20:23], s53 offen lds
    s_waitcnt vmcnt(38)
    ds_read_b64_tr_b16 a[196:197], v2 offset:9216
    ds_read_b64_tr_b16 a[198:199], v2 offset:9728
    s_waitcnt lgkmcnt(2)
    s_add_u32 m0, s32, 8192
    s_add_u32 s53, s52, 491520
    buffer_load_dwordx4 v14, s[20:23], s53 offen lds
    s_waitcnt vmcnt(38)
    ds_read_b64_tr_b16 a[200:201], v2 offset:10240
    ds_read_b64_tr_b16 a[202:203], v2 offset:10752
    s_waitcnt lgkmcnt(2)
    s_add_u32 m0, s32, 9216
    s_add_u32 s53, s52, 512000
    buffer_load_dwordx4 v14, s[20:23], s53 offen lds
    s_waitcnt vmcnt(38)
    ds_read_b64_tr_b16 a[204:205], v2 offset:11264
    ds_read_b64_tr_b16 a[206:207], v2 offset:11776
    s_waitcnt lgkmcnt(2)
    s_add_u32 m0, s32, 10240
    s_add_u32 s53, s52, 532480
    buffer_load_dwordx4 v14, s[20:23], s53 offen lds
    s_waitcnt vmcnt(38)
    ds_read_b64_tr_b16 a[208:209], v2 offset:12288
    ds_read_b64_tr_b16 a[210:211], v2 offset:12800
    s_waitcnt vmcnt(37)
    ds_read_b64_tr_b16 a[212:213], v2 offset:13312
    ds_read_b64_tr_b16 a[214:215], v2 offset:13824
    s_waitcnt vmcnt(36)
    ds_read_b64_tr_b16 a[216:217], v2 offset:14336
    ds_read_b64_tr_b16 a[218:219], v2 offset:14848
    s_waitcnt vmcnt(35)
    ds_read_b64_tr_b16 a[220:221], v2 offset:15360
    ds_read_b64_tr_b16 a[222:223], v2 offset:15872
    s_waitcnt vmcnt(34)
    ds_read_b64_tr_b16 a[224:225], v2 offset:16384
    ds_read_b64_tr_b16 a[226:227], v2 offset:16896
    s_waitcnt vmcnt(33)
    ds_read_b64_tr_b16 a[228:229], v2 offset:17408
    ds_read_b64_tr_b16 a[230:231], v2 offset:17920
    s_waitcnt vmcnt(32)
    ds_read_b64_tr_b16 a[232:233], v2 offset:18432
    ds_read_b64_tr_b16 a[234:235], v2 offset:18944
    s_waitcnt vmcnt(31)
    ds_read_b64_tr_b16 a[236:237], v2 offset:19456
    ds_read_b64_tr_b16 a[238:239], v2 offset:19968
    s_waitcnt vmcnt(30)
    ds_read_b64_tr_b16 a[240:241], v2 offset:20480
    ds_read_b64_tr_b16 a[242:243], v2 offset:20992
    s_waitcnt vmcnt(29)
    ds_read_b64_tr_b16 a[244:245], v2 offset:21504
    ds_read_b64_tr_b16 a[246:247], v2 offset:22016
    s_waitcnt vmcnt(28)
    ds_read_b64_tr_b16 a[248:249], v2 offset:22528
    ds_read_b64_tr_b16 a[250:251], v2 offset:23040
    s_waitcnt vmcnt(27)
    ds_read_b64_tr_b16 a[252:253], v2 offset:23552
    ds_read_b64_tr_b16 a[254:255], v2 offset:24064
    s_waitcnt vmcnt(26)
    ds_read_b64_tr_b16 v[128:129], v2 offset:24576
    ds_read_b64_tr_b16 v[130:131], v2 offset:25088
    s_waitcnt vmcnt(25)
    ds_read_b64_tr_b16 v[132:133], v2 offset:25600
    ds_read_b64_tr_b16 v[134:135], v2 offset:26112
    s_waitcnt vmcnt(24)
    ds_read_b64_tr_b16 v[136:137], v2 offset:26624
    ds_read_b64_tr_b16 v[138:139], v2 offset:27136
    s_waitcnt vmcnt(23)
    ds_read_b64_tr_b16 v[140:141], v2 offset:27648
    ds_read_b64_tr_b16 v[142:143], v2 offset:28160
    s_waitcnt vmcnt(22)
    ds_read_b64_tr_b16 v[144:145], v2 offset:28672
    ds_read_b64_tr_b16 v[146:147], v2 offset:29184
    s_waitcnt vmcnt(21)
    ds_read_b64_tr_b16 v[148:149], v2 offset:29696
    ds_read_b64_tr_b16 v[150:151], v2 offset:30208
    s_waitcnt vmcnt(20)
    ds_read_b64_tr_b16 v[152:153], v2 offset:30720
    ds_read_b64_tr_b16 v[154:155], v2 offset:31232
    s_waitcnt vmcnt(19)
    ds_read_b64_tr_b16 v[156:157], v2 offset:31744
    ds_read_b64_tr_b16 v[158:159], v2 offset:32256
    s_waitcnt vmcnt(18)
    ds_read_b64_tr_b16 v[160:161], v2 offset:32768
    ds_read_b64_tr_b16 v[162:163], v2 offset:33280
    s_waitcnt vmcnt(17)
    ds_read_b64_tr_b16 v[164:165], v2 offset:33792
    ds_read_b64_tr_b16 v[166:167], v2 offset:34304
    s_waitcnt vmcnt(16)
    ds_read_b64_tr_b16 v[168:169], v2 offset:34816
    ds_read_b64_tr_b16 v[170:171], v2 offset:35328
    s_waitcnt vmcnt(15)
    ds_read_b64_tr_b16 v[172:173], v2 offset:35840
    ds_read_b64_tr_b16 v[174:175], v2 offset:36352
    s_waitcnt vmcnt(14)
    ds_read_b64_tr_b16 v[176:177], v2 offset:36864
    ds_read_b64_tr_b16 v[178:179], v2 offset:37376
    s_waitcnt vmcnt(13)
    ds_read_b64_tr_b16 v[180:181], v2 offset:37888
    ds_read_b64_tr_b16 v[182:183], v2 offset:38400
    s_waitcnt vmcnt(12)
    ds_read_b64_tr_b16 v[184:185], v2 offset:38912
    ds_read_b64_tr_b16 v[186:187], v2 offset:39424
    s_waitcnt vmcnt(11)
    ds_read_b64_tr_b16 v[188:189], v2 offset:39936
    ds_read_b64_tr_b16 v[190:191], v2 offset:40448
    s_waitcnt vmcnt(10)
    ds_read_b64_tr_b16 v[192:193], v2 offset:0
    ds_read_b64_tr_b16 v[194:195], v2 offset:512
    s_waitcnt vmcnt(9)
    ds_read_b64_tr_b16 v[196:197], v2 offset:1024
    ds_read_b64_tr_b16 v[198:199], v2 offset:1536
    s_waitcnt vmcnt(8)
    ds_read_b64_tr_b16 v[200:201], v2 offset:2048
    ds_read_b64_tr_b16 v[202:203], v2 offset:2560
    s_waitcnt vmcnt(7)
    ds_read_b64_tr_b16 v[204:205], v2 offset:3072
    ds_read_b64_tr_b16 v[206:207], v2 offset:3584
    s_waitcnt vmcnt(6)
    ds_read_b64_tr_b16 v[208:209], v2 offset:4096
    ds_read_b64_tr_b16 v[210:211], v2 offset:4608
    s_waitcnt vmcnt(5)
    ds_read_b64_tr_b16 v[212:213], v2 offset:5120
    ds_read_b64_tr_b16 v[214:215], v2 offset:5632
    s_waitcnt vmcnt(4)
    ds_read_b64_tr_b16 v[216:217], v2 offset:6144
    ds_read_b64_tr_b16 v[218:219], v2 offset:6656
    s_waitcnt vmcnt(3)
    ds_read_b64_tr_b16 v[220:221], v2 offset:7168
    ds_read_b64_tr_b16 v[222:223], v2 offset:7680
    s_waitcnt vmcnt(2)
    ds_read_b64_tr_b16 v[224:225], v2 offset:8192
    ds_read_b64_tr_b16 v[226:227], v2 offset:8704
    s_waitcnt vmcnt(1)
    ds_read_b64_tr_b16 v[228:229], v2 offset:9216
    ds_read_b64_tr_b16 v[230:231], v2 offset:9728
    s_waitcnt vmcnt(0)
    ds_read_b64_tr_b16 v[232:233], v2 offset:10240
    ds_read_b64_tr_b16 v[234:235], v2 offset:10752
    s_mov_b32 s8, s64
    s_and_b32 s9, s65, 0xffff
    s_mov_b32 s10, 0x280000
    s_mov_b32 s11, 0x20000
    s_mov_b32 s20, s86
    s_and_b32 s21, s87, 0xffff
    s_mov_b32 s22, 0x280000
    s_mov_b32 s23, 0x20000
    s_waitcnt lgkmcnt(0)
    s_barrier
    v_and_b32 v11, 31, v10
    v_lshrrev_b32 v12, 2, v11
    v_and_b32 v11, 3, v11
    v_lshlrev_b32 v11, 2, v11
    v_lshl_add_u32 v11, v12, 7, v11
    s_lshl_b32 s50, s16, 10
    s_add_u32 s50, s50, 6299648
    v_add_u32 v3, s50, v11
    v_min_u32 v11, 26, v10
    s_mul_i32 s50, s16, 27
    v_add_u32 v11, s50, v11
    v_lshrrev_b32 v12, 2, v11
    v_and_b32 v11, 3, v11
    v_lshlrev_b32 v11, 2, v11
    v_lshl_add_u32 v11, v12, 7, v11
    v_add_u32 v4, 6303744, v11
    v_and_b32 v11, 31, v10
    v_mul_u32_u24 v11, 144, v11
    v_lshrrev_b32 v12, 5, v10
    v_lshl_add_u32 v11, v12, 4, v11
    s_mul_i32 s50, s16, 4608
    s_add_u32 s50, s50, 131072
    v_add_u32 v5, s50, v11
    v_lshrrev_b32 v11, 3, v0
    v_and_b32 v12, 7, v0
    v_mul_u32_u24 v13, 144, v11
    v_lshl_add_u32 v13, v12, 4, v13
    v_add_u32 v6, 131072, v13
    v_mul_u32_u24 v13, 1280, v11
    v_lshl_add_u32 v13, v12, 3, v13
    s_lshl_b32 s50, s17, 6
    v_add_u32 v7, s50, v13
    s_lshl_b32 s32, s16, 15
    v_add_u32 v8, s32, v1
    s_mov_b32 s33, s18
    s_mul_i32 s35, s33, 110592
    s_mul_i32 s50, s16, 27648
    s_add_u32 s35, s35, s50
    s_add_u32 s35, s35, 61865984
    s_add_u32 s46, s33, 1
    v_mov_b32 v9, 0
    s_cmp_lg_u32 s16, 0
    s_cbranch_scc1 L_ww_20
    s_mov_b32 s62, 0
L_pw_21:
    buffer_load_dword v11, v9, s[12:15], 0 offen sc1
    s_waitcnt vmcnt(0)
    v_cmp_gt_u32 vcc, 64, v11
    s_cbranch_vccz L_pok_22
    s_sleep 12
    s_add_u32 s62, s62, 1
    s_cmp_lt_u32 s62, 2000000
    s_cbranch_scc1 L_pw_21
    v_mov_b32 v1, 565
    v_mov_b32 v2, 192
    buffer_store_dword v1, v2, s[12:15], 0 offen sc1
    s_waitcnt vmcnt(0)
    s_endpgm
L_pok_22:
L_ww_20:
    s_barrier
    s_mov_b32 s47, 0
    s_cmp_ge_u32 s47, s46
    s_cbranch_scc1 L_fh_23
    s_mov_b32 s62, 0
L_pw_24:
    buffer_load_dword v9, v4, s[4:7], 0 offen sc1
    s_waitcnt vmcnt(0)
    v_cmp_gt_u32 vcc, s46, v9
    s_cbranch_vccz L_pok_25
    s_sleep 8
    s_add_u32 s62, s62, 1
    s_cmp_lt_u32 s62, 2000000
    s_cbranch_scc1 L_pw_24
    v_mov_b32 v1, 560
    v_mov_b32 v2, 192
    buffer_store_dword v1, v2, s[12:15], 0 offen sc1
    s_waitcnt vmcnt(0)
    s_endpgm
L_pok_25:
    v_readlane_b32 s47, v9, 0
    v_readlane_b32 s48, v9, 1
    s_min_u32 s47, s47, s48
    v_readlane_b32 s48, v9, 2
    s_min_u32 s47, s47, s48
    v_readlane_b32 s48, v9, 3
    s_min_u32 s47, s47, s48
    v_readlane_b32 s48, v9, 4
    s_min_u32 s47, s47, s48
    v_readlane_b32 s48, v9, 5
    s_min_u32 s47, s47, s48
    v_readlane_b32 s48, v9, 6
    s_min_u32 s47, s47, s48
    v_readlane_b32 s48, v9, 7
    s_min_u32 s47, s47, s48
    v_readlane_b32 s48, v9, 8
    s_min_u32 s47, s47, s48
    v_readlane_b32 s48, v9, 9
    s_min_u32 s47, s47, s48
    v_readlane_b32 s48, v9, 10
    s_min_u32 s47, s47, s48
    v_readlane_b32 s48, v9, 11
    s_min_u32 s47, s47, s48
    v_readlane_b32 s48, v9, 12
    s_min_u32 s47, s47, s48
    v_readlane_b32 s48, v9, 13
    s_min_u32 s47, s47, s48
    v_readlane_b32 s48, v9, 14
    s_min_u32 s47, s47, s48
    v_readlane_b32 s48, v9, 15
    s_min_u32 s47, s47, s48
    v_readlane_b32 s48, v9, 16
    s_min_u32 s47, s47, s48
    v_readlane_b32 s48, v9, 17
    s_min_u32 s47, s47, s48
    v_readlane_b32 s48, v9, 18
    s_min_u32 s47, s47, s48
    v_readlane_b32 s48, v9, 19
    s_min_u32 s47, s47, s48
    v_readlane_b32 s48, v9, 20
    s_min_u32 s47, s47, s48
    v_readlane_b32 s48, v9, 21
    s_min_u32 s47, s47, s48
    v_readlane_b32 s48, v9, 22
    s_min_u32 s47, s47, s48
    v_readlane_b32 s48, v9, 23
    s_min_u32 s47, s47, s48
    v_readlane_b32 s48, v9, 24
    s_min_u32 s47, s47, s48
    v_readlane_b32 s48, v9, 25
    s_min_u32 s47, s47, s48
    v_readlane_b32 s48, v9, 26
    s_min_u32 s47, s47, s48
L_fh_23:
    s_mul_i32 s37, s33, 40960
    buffer_load_dword v9, v3, s[4:7], 0 offen sc1
    buffer_load_dwordx2 v[14:15], v7, s[8:11], s37 offen
    s_add_u32 m0, s32, 5120
    s_add_u32 s50, s35, 0
    buffer_load_dwordx4 v1, s[4:7], s50 offen lds
    s_add_u32 m0, s32, 6144
    s_add_u32 s50, s35, 1024
    buffer_load_dwordx4 v1, s[4:7], s50 offen lds
    s_add_u32 m0, s32, 7168
    s_add_u32 s50, s35, 2048
    buffer_load_dwordx4 v1, s[4:7], s50 offen lds
    s_add_u32 m0, s32, 8192
    s_add_u32 s50, s35, 3072
    buffer_load_dwordx4 v1, s[4:7], s50 offen lds
    s_add_u32 m0, s32, 9216
    s_add_u32 s50, s35, 4096
    buffer_load_dwordx4 v1, s[4:7], s50 offen lds
    s_add_u32 m0, s32, 10240
    s_add_u32 s50, s35, 5120
    buffer_load_dwordx4 v1, s[4:7], s50 offen lds
    s_add_u32 m0, s32, 11264
    s_add_u32 s50, s35, 6144
    buffer_load_dwordx4 v1, s[4:7], s50 offen lds
    s_add_u32 m0, s32, 12288
    s_add_u32 s50, s35, 7168
    buffer_load_dwordx4 v1, s[4:7], s50 offen lds
    s_add_u32 m0, s32, 13312
    s_add_u32 s50, s35, 8192
    buffer_load_dwordx4 v1, s[4:7], s50 offen lds
    s_add_u32 m0, s32, 14336
    s_add_u32 s50, s35, 9216
    buffer_load_dwordx4 v1, s[4:7], s50 offen lds
    s_add_u32 m0, s32, 15360
    s_add_u32 s50, s35, 10240
    buffer_load_dwordx4 v1, s[4:7], s50 offen lds
    s_add_u32 m0, s32, 16384
    s_add_u32 s50, s35, 11264
    buffer_load_dwordx4 v1, s[4:7], s50 offen lds
    s_add_u32 m0, s32, 17408
    s_add_u32 s50, s35, 12288
    buffer_load_dwordx4 v1, s[4:7], s50 offen lds
    s_add_u32 m0, s32, 18432
    s_add_u32 s50, s35, 13312
    buffer_load_dwordx4 v1, s[4:7], s50 offen lds
    s_add_u32 m0, s32, 19456
    s_add_u32 s50, s35, 14336
    buffer_load_dwordx4 v1, s[4:7], s50 offen lds
    s_add_u32 m0, s32, 20480
    s_add_u32 s50, s35, 15360
    buffer_load_dwordx4 v1, s[4:7], s50 offen lds
    s_add_u32 m0, s32, 21504
    s_add_u32 s50, s35, 16384
    buffer_load_dwordx4 v1, s[4:7], s50 offen lds
    s_add_u32 m0, s32, 22528
    s_add_u32 s50, s35, 17408
    buffer_load_dwordx4 v1, s[4:7], s50 offen lds
    s_add_u32 m0, s32, 23552
    s_add_u32 s50, s35, 18432
    buffer_load_dwordx4 v1, s[4:7], s50 offen lds
    s_add_u32 m0, s32, 24576
    s_add_u32 s50, s35, 19456
    buffer_load_dwordx4 v1, s[4:7], s50 offen lds
    s_add_u32 m0, s32, 25600
    s_add_u32 s50, s35, 20480
    buffer_load_dwordx4 v1, s[4:7], s50 offen lds
    s_add_u32 m0, s32, 26624
    s_add_u32 s50, s35, 21504
    buffer_load_dwordx4 v1, s[4:7], s50 offen lds
    s_add_u32 m0, s32, 27648
    s_add_u32 s50, s35, 22528
    buffer_load_dwordx4 v1, s[4:7], s50 offen lds
    s_add_u32 m0, s32, 28672
    s_add_u32 s50, s35, 23552
    buffer_load_dwordx4 v1, s[4:7], s50 offen lds
    s_add_u32 m0, s32, 29696
    s_add_u32 s50, s35, 24576
    buffer_load_dwordx4 v1, s[4:7], s50 offen lds
    s_add_u32 m0, s32, 30720
    s_add_u32 s50, s35, 25600
    buffer_load_dwordx4 v1, s[4:7], s50 offen lds
    s_add_u32 m0, s32, 31744
    s_add_u32 s50, s35, 26624
    buffer_load_dwordx4 v1, s[4:7], s50 offen lds
    s_waitcnt vmcnt(0)
L_fin_loop:
    s_mov_b32 s36, s37
    s_lshl_b32 s34, s33, 18
    s_lshl_b32 s50, s16, 16
    s_add_u32 s34, s34, s50
    s_add_u32 s34, s34, 45088768
    s_add_u32 s35, s35, 221184
    s_add_u32 s49, s33, 3
    s_min_u32 s49, s49, 64
    s_and_b32 s45, s33, -2
    s_waitcnt vmcnt(28)
    v_mov_b32 v12, v14
    v_mov_b32 v13, v15
    v_cmp_gt_u32 vcc, s46, v9
    s_cbranch_vccnz L_fin_late
    s_waitcnt vmcnt(27)
    ds_read_b128 v[32:35], v8 offset:5120
    s_add_u32 m0, s32, 0
    s_add_u32 s50, s34, 0
    buffer_load_dwordx4 v1, s[4:7], s50 offen lds
    s_add_u32 m0, s32, 1024
    s_add_u32 s50, s34, 1024
    buffer_load_dwordx4 v1, s[4:7], s50 offen lds
    s_waitcnt vmcnt(28)
    ds_read_b128 v[36:39], v8 offset:6144
    s_add_u32 m0, s32, 2048
    s_add_u32 s50, s34, 2048
    buffer_load_dwordx4 v1, s[4:7], s50 offen lds
    s_add_u32 m0, s32, 3072
    s_add_u32 s50, s34, 3072
    buffer_load_dwordx4 v1, s[4:7], s50 offen lds
    s_waitcnt vmcnt(29)
    ds_read_b128 v[40:43], v8 offset:7168
    s_add_u32 m0, s32, 4096
    s_add_u32 s50, s34, 4096
    buffer_load_dwordx4 v1, s[4:7], s50 offen lds
    s_waitcnt vmcnt(29)
    ds_read_b128 v[44:47], v8 offset:8192
    s_waitcnt lgkmcnt(3)
    v_mfma_f32_32x32x16_bf16 v[16:31], v[128:131], v[32:35], 0
    s_add_u32 m0, s32, 5120
    s_add_u32 s50, s34, 5120
    buffer_load_dwordx4 v1, s[4:7], s50 offen lds
    s_waitcnt vmcnt(29)
    ds_read_b128 v[32:35], v8 offset:9216
    s_waitcnt lgkmcnt(3)
    v_mfma_f32_32x32x16_bf16 v[16:31], v[132:135], v[36:39], v[16:31]
    s_add_u32 m0, s32, 6144
    s_add_u32 s50, s34, 6144
    buffer_load_dwordx4 v1, s[4:7], s50 offen lds
    s_waitcnt vmcnt(29)
    ds_read_b128 v[36:39], v8 offset:10240
    s_waitcnt lgkmcnt(3)
    v_mfma_f32_32x32x16_bf16 v[16:31], v[136:139], v[40:43], v[16:31]
    s_add_u32 m0, s32, 7168
    s_add_u32 s50, s34, 7168
    buffer_load_dwordx4 v1, s[4:7], s50 offen lds
    s_waitcnt vmcnt(29)
    ds_read_b128 v[40:43], v8 offset:11264
    s_waitcnt lgkmcnt(3)
    v_mfma_f32_32x32x16_bf16 v[16:31], v[140:143], v[44:47], v[16:31]
    s_add_u32 m0, s32, 8192
    s_add_u32 s50, s34, 8192
    buffer_load_dwordx4 v1, s[4:7], s50 offen lds
    s_waitcnt vmcnt(29)
    ds_read_b128 v[44:47], v8 offset:12288
    s_waitcnt lgkmcnt(3)
    v_mfma_f32_32x32x16_bf16 v[16:31], v[144:147], v[32:35], v[16:31]
    s_add_u32 m0, s32, 9216
    s_add_u32 s50, s34, 9216
    buffer_load_dwordx4 v1, s[4:7], s50 offen lds
    s_waitcnt vmcnt(29)
    ds_read_b128 v[32:35], v8 offset:13312
    s_waitcnt lgkmcnt(3)
    v_mfma_f32_32x32x16_bf16 v[16:31], v[148:151], v[36:39], v[16:31]
    s_add_u32 m0, s32, 10240
    s_add_u32 s50, s34, 10240
    buffer_load_dwordx4 v1, s[4:7], s50 offen lds
    s_waitcnt vmcnt(29)
    ds_read_b128 v[36:39], v8 offset:14336
    s_waitcnt lgkmcnt(3)
    v_mfma_f32_32x32x16_bf16 v[16:31], v[152:155], v[40:43], v[16:31]
    s_add_u32 m0, s32, 11264
    s_add_u32 s50, s34, 11264
    buffer_load_dwordx4 v1, s[4:7], s50 offen lds
    s_waitcnt vmcnt(29)
    ds_read_b128 v[40:43], v8 offset:15360
    s_waitcnt lgkmcnt(3)
    v_mfma_f32_32x32x16_bf16 v[16:31], v[156:159], v[44:47], v[16:31]
    s_add_u32 m0, s32, 12288
    s_add_u32 s50, s34, 12288
    buffer_load_dwordx4 v1, s[4:7], s50 offen lds
    s_waitcnt vmcnt(29)
    ds_read_b128 v[44:47], v8 offset:16384
    s_waitcnt lgkmcnt(3)
    v_mfma_f32_32x32x16_bf16 v[16:31], v[160:163], v[32:35], v[16:31]
    s_add_u32 m0, s32, 13312
    s_add_u32 s50, s34, 13312
    buffer_load_dwordx4 v1, s[4:7], s50 offen lds
    s_waitcnt vmcnt(29)
    ds_read_b128 v[32:35], v8 offset:17408
    s_waitcnt lgkmcnt(3)
    v_mfma_f32_32x32x16_bf16 v[16:31], v[164:167], v[36:39], v[16:31]
    s_add_u32 m0, s32, 14336
    s_add_u32 s50, s34, 14336
    buffer_load_dwordx4 v1, s[4:7], s50 offen lds
    s_waitcnt vmcnt(29)
    ds_read_b128 v[36:39], v8 offset:18432
    s_waitcnt lgkmcnt(3)
    v_mfma_f32_32x32x16_bf16 v[16:31], v[168:171], v[40:43], v[16:31]
    s_add_u32 m0, s32, 15360
    s_add_u32 s50, s34, 15360
    buffer_load_dwordx4 v1, s[4:7], s50 offen lds
    s_waitcnt vmcnt(29)
    ds_read_b128 v[40:43], v8 offset:19456
    s_waitcnt lgkmcnt(3)
    v_mfma_f32_32x32x16_bf16 v[16:31], v[172:175], v[44:47], v[16:31]
    s_add_u32 m0, s32, 16384
    s_add_u32 s50, s34, 16384
    buffer_load_dwordx4 v1, s[4:7], s50 offen lds
    s_waitcnt vmcnt(29)
    ds_read_b128 v[44:47], v8 offset:20480
    s_waitcnt lgkmcnt(3)
    v_mfma_f32_32x32x16_bf16 v[16:31], v[176:179], v[32:35], v[16:31]
    s_add_u32 m0, s32, 17408
    s_add_u32 s50, s34, 17408
    buffer_load_dwordx4 v1, s[4:7], s50 offen lds
    s_waitcnt vmcnt(29)
    ds_read_b128 v[32:35], v8 offset:21504
    s_waitcnt lgkmcnt(3)
    v_mfma_f32_32x32x16_bf16 v[16:31], v[180:183], v[36:39], v[16:31]
    s_add_u32 m0, s32, 18432
    s_add_u32 s50, s34, 18432
    buffer_load_dwordx4 v1, s[4:7], s50 offen lds
    s_waitcnt vmcnt(29)
    ds_read_b128 v[36:39], v8 offset:22528
    s_waitcnt lgkmcnt(3)
    v_mfma_f32_32x32x16_bf16 v[16:31], v[184:187], v[40:43], v[16:31]
    s_add_u32 m0, s32, 19456
    s_add_u32 s50, s34, 19456
    buffer_load_dwordx4 v1, s[4:7], s50 offen lds
    s_waitcnt vmcnt(29)
    ds_read_b128 v[40:43], v8 offset:23552
    s_waitcnt lgkmcnt(3)
    v_mfma_f32_32x32x16_bf16 v[16:31], v[188:191], v[44:47], v[16:31]
    s_add_u32 m0, s32, 20480
    s_add_u32 s50, s34, 20480
    buffer_load_dwordx4 v1, s[4:7], s50 offen lds
    s_waitcnt vmcnt(29)
    ds_read_b128 v[44:47], v8 offset:24576
    s_waitcnt lgkmcnt(3)
    v_mfma_f32_32x32x16_bf16 v[16:31], v[192:195], v[32:35], v[16:31]
    s_add_u32 m0, s32, 21504
    s_add_u32 s50, s34, 21504
    buffer_load_dwordx4 v1, s[4:7], s50 offen lds
    s_waitcnt vmcnt(29)
    ds_read_b128 v[32:35], v8 offset:25600
    s_waitcnt lgkmcnt(3)
    v_mfma_f32_32x32x16_bf16 v[16:31], v[196:199], v[36:39], v[16:31]
    s_add_u32 m0, s32, 22528
    s_add_u32 s50, s34, 22528
    buffer_load_dwordx4 v1, s[4:7], s50 offen lds
    s_waitcnt vmcnt(29)
    ds_read_b128 v[36:39], v8 offset:26624
    s_waitcnt lgkmcnt(3)
    v_mfma_f32_32x32x16_bf16 v[16:31], v[200:203], v[40:43], v[16:31]
    s_add_u32 m0, s32, 23552
    s_add_u32 s50, s34, 23552
    buffer_load_dwordx4 v1, s[4:7], s50 offen lds
    s_waitcnt vmcnt(28)
    ds_read_b128 v[40:43], v8 offset:27648
    s_waitcnt lgkmcnt(3)
    v_mfma_f32_32x32x16_bf16 v[16:31], v[204:207], v[44:47], v[16:31]
    s_add_u32 m0, s32, 24576
    s_add_u32 s50, s34, 24576
    buffer_load_dwordx4 v1, s[4:7], s50 offen lds
    s_waitcnt vmcnt(28)
    ds_read_b128 v[44:47], v8 offset:28672
    s_waitcnt lgkmcnt(3)
    v_mfma_f32_32x32x16_bf16 v[16:31], v[208:211], v[32:35], v[16:31]
    s_add_u32 m0, s32, 25600
    s_add_u32 s50, s34, 25600
    buffer_load_dwordx4 v1, s[4:7], s50 offen lds
    s_waitcnt vmcnt(28)
    ds_read_b128 v[32:35], v8 offset:29696
    s_waitcnt lgkmcnt(3)
    v_mfma_f32_32x32x16_bf16 v[16:31], v[212:215], v[36:39], v[16:31]
    s_add_u32 m0, s32, 26624
    s_add_u32 s50, s34, 26624
    buffer_load_dwordx4 v1, s[4:7], s50 offen lds
    s_waitcnt vmcnt(28)
    ds_read_b128 v[36:39], v8 offset:30720
    s_waitcnt lgkmcnt(3)
    v_mfma_f32_32x32x16_bf16 v[16:31], v[216:219], v[40:43], v[16:31]
    s_add_u32 m0, s32, 27648
    s_add_u32 s50, s34, 27648
    buffer_load_dwordx4 v1, s[4:7], s50 offen lds
    s_waitcnt vmcnt(28)
    ds_read_b128 v[40:43], v8 offset:31744
    s_waitcnt lgkmcnt(3)
    v_mfma_f32_32x32x16_bf16 v[16:31], v[220:223], v[44:47], v[16:31]
    s_add_u32 m0, s32, 28672
    s_add_u32 s50, s34, 28672
    buffer_load_dwordx4 v1, s[4:7], s50 offen lds
    s_waitcnt lgkmcnt(2)
    v_mfma_f32_32x32x16_bf16 v[16:31], v[224:227], v[32:35], v[16:31]
    s_add_u32 m0, s32, 29696
    s_add_u32 s50, s34, 29696
    buffer_load_dwordx4 v1, s[4:7], s50 offen lds
    s_waitcnt lgkmcnt(1)
    v_mfma_f32_32x32x16_bf16 v[16:31], v[228:231], v[36:39], v[16:31]
    s_add_u32 m0, s32, 30720
    s_add_u32 s50, s34, 30720
    buffer_load_dwordx4 v1, s[4:7], s50 offen lds
    s_waitcnt lgkmcnt(0)
    v_mfma_f32_32x32x16_bf16 v[16:31], v[232:235], v[40:43], v[16:31]
    s_add_u32 m0, s32, 31744
    s_add_u32 s50, s34, 31744
    buffer_load_dwordx4 v1, s[4:7], s50 offen lds
L_fin_go:
    s_waitcnt vmcnt(31)
    ds_read_b128 v[44:47], v8 offset:0
    s_waitcnt vmcnt(30)
    ds_read_b128 v[32:35], v8 offset:1024
    s_waitcnt vmcnt(29)
    ds_read_b128 v[36:39], v8 offset:2048
    s_waitcnt vmcnt(28)
    ds_read_b128 v[40:43], v8 offset:3072
    s_waitcnt lgkmcnt(3)
    v_mfma_f32_32x32x16_bf16 v[16:31], a[0:3], v[44:47], v[16:31]
    s_add_u32 m0, s32, 0
    s_add_u32 s50, s34, 32768
    buffer_load_dwordx4 v1, s[4:7], s50 offen lds
    s_waitcnt vmcnt(28)
    ds_read_b128 v[44:47], v8 offset:4096
    s_waitcnt lgkmcnt(3)
    v_mfma_f32_32x32x16_bf16 v[16:31], a[4:7], v[32:35], v[16:31]
    s_add_u32 m0, s32, 1024
    s_add_u32 s50, s34, 33792
    buffer_load_dwordx4 v1, s[4:7], s50 offen lds
    s_waitcnt vmcnt(28)
    ds_read_b128 v[32:35], v8 offset:5120
    s_waitcnt lgkmcnt(3)
    v_mfma_f32_32x32x16_bf16 v[16:31], a[8:11], v[36:39], v[16:31]
    s_add_u32 m0, s32, 2048
    s_add_u32 s50, s34, 34816
    buffer_load_dwordx4 v1, s[4:7], s50 offen lds
    s_waitcnt vmcnt(28)
    ds_read_b128 v[36:39], v8 offset:6144
    s_waitcnt lgkmcnt(3)
    v_mfma_f32_32x32x16_bf16 v[16:31], a[12:15], v[40:43], v[16:31]
    s_add_u32 m0, s32, 3072
    s_add_u32 s50, s34, 35840
    buffer_load_dwordx4 v1, s[4:7], s50 offen lds
    s_waitcnt vmcnt(28)
    ds_read_b128 v[40:43], v8 offset:7168
    s_waitcnt lgkmcnt(3)
    v_mfma_f32_32x32x16_bf16 v[16:31], a[16:19], v[44:47], v[16:31]
    s_add_u32 m0, s32, 4096
    s_add_u32 s50, s34, 36864
    buffer_load_dwordx4 v1, s[4:7], s50 offen lds
    s_waitcnt vmcnt(28)
    ds_read_b128 v[44:47], v8 offset:8192
    s_waitcnt lgkmcnt(3)
    v_mfma_f32_32x32x16_bf16 v[16:31], a[20:23], v[32:35], v[16:31]
    s_add_u32 m0, s32, 5120
    s_add_u32 s50, s34, 37888
    buffer_load_dwordx4 v1, s[4:7], s50 offen lds
    s_waitcnt vmcnt(28)
    ds_read_b128 v[32:35], v8 offset:9216
    s_waitcnt lgkmcnt(3)
    v_mfma_f32_32x32x16_bf16 v[16:31], a[24:27], v[36:39], v[16:31]
    s_add_u32 m0, s32, 6144
    s_add_u32 s50, s34, 38912
    buffer_load_dwordx4 v1, s[4:7], s50 offen lds
    s_waitcnt vmcnt(28)
    ds_read_b128 v[36:39], v8 offset:10240
    s_waitcnt lgkmcnt(3)
    v_mfma_f32_32x32x16_bf16 v[16:31], a[28:31], v[40:43], v[16:31]
    s_add_u32 m0, s32, 7168
    s_add_u32 s50, s34, 39936
    buffer_load_dwordx4 v1, s[4:7], s50 offen lds
    s_waitcnt vmcnt(28)
    ds_read_b128 v[40:43], v8 offset:11264
    s_waitcnt lgkmcnt(3)
    v_mfma_f32_32x32x16_bf16 v[16:31], a[32:35], v[44:47], v[16:31]
    s_add_u32 m0, s32, 8192
    s_add_u32 s50, s34, 40960
    buffer_load_dwordx4 v1, s[4:7], s50 offen lds
    s_waitcnt vmcnt(28)
    ds_read_b128 v[44:47], v8 offset:12288
    s_waitcnt lgkmcnt(3)
    v_mfma_f32_32x32x16_bf16 v[16:31], a[36:39], v[32:35], v[16:31]
    s_add_u32 m0, s32, 9216
    s_add_u32 s50, s34, 41984
    buffer_load_dwordx4 v1, s[4:7], s50 offen lds
    s_waitcnt vmcnt(28)
    ds_read_b128 v[32:35], v8 offset:13312
    s_waitcnt lgkmcnt(3)
    v_mfma_f32_32x32x16_bf16 v[16:31], a[40:43], v[36:39], v[16:31]
    s_add_u32 m0, s32, 10240
    s_add_u32 s50, s34, 43008
    buffer_load_dwordx4 v1, s[4:7], s50 offen lds
    s_waitcnt vmcnt(28)
    ds_read_b128 v[36:39], v8 offset:14336
    s_waitcnt lgkmcnt(3)
    v_mfma_f32_32x32x16_bf16 v[16:31], a[44:47], v[40:43], v[16:31]
    s_add_u32 m0, s32, 11264
    s_add_u32 s50, s34, 44032
    buffer_load_dwordx4 v1, s[4:7], s50 offen lds
    s_waitcnt vmcnt(28)
    ds_read_b128 v[40:43], v8 offset:15360
    s_waitcnt lgkmcnt(3)
    v_mfma_f32_32x32x16_bf16 v[16:31], a[48:51], v[44:47], v[16:31]
    s_add_u32 m0, s32, 12288
    s_add_u32 s50, s34, 45056
    buffer_load_dwordx4 v1, s[4:7], s50 offen lds
    s_waitcnt vmcnt(28)
    ds_read_b128 v[44:47], v8 offset:16384
    s_waitcnt lgkmcnt(3)
    v_mfma_f32_32x32x16_bf16 v[16:31], a[52:55], v[32:35], v[16:31]
    s_add_u32 m0, s32, 13312
    s_add_u32 s50, s34, 46080
    buffer_load_dwordx4 v1, s[4:7], s50 offen lds
    s_waitcnt vmcnt(28)
    ds_read_b128 v[32:35], v8 offset:17408
    s_waitcnt lgkmcnt(3)
    v_mfma_f32_32x32x16_bf16 v[16:31], a[56:59], v[36:39], v[16:31]
    s_add_u32 m0, s32, 14336
    s_add_u32 s50, s34, 47104
    buffer_load_dwordx4 v1, s[4:7], s50 offen lds
    s_waitcnt vmcnt(28)
    ds_read_b128 v[36:39], v8 offset:18432
    s_waitcnt lgkmcnt(3)
    v_mfma_f32_32x32x16_bf16 v[16:31], a[60:63], v[40:43], v[16:31]
    s_add_u32 m0, s32, 15360
    s_add_u32 s50, s34, 48128
    buffer_load_dwordx4 v1, s[4:7], s50 offen lds
    s_waitcnt vmcnt(28)
    ds_read_b128 v[40:43], v8 offset:19456
    s_waitcnt lgkmcnt(3)
    v_mfma_f32_32x32x16_bf16 v[16:31], a[64:67], v[44:47], v[16:31]
    s_add_u32 m0, s32, 16384
    s_add_u32 s50, s34, 49152
    buffer_load_dwordx4 v1, s[4:7], s50 offen lds
    s_waitcnt vmcnt(28)
    ds_read_b128 v[44:47], v8 offset:20480
    s_waitcnt lgkmcnt(3)
    v_mfma_f32_32x32x16_bf16 v[16:31], a[68:71], v[32:35], v[16:31]
    s_add_u32 m0, s32, 17408
    s_add_u32 s50, s34, 50176
    buffer_load_dwordx4 v1, s[4:7], s50 offen lds
    s_waitcnt vmcnt(28)
    ds_read_b128 v[32:35], v8 offset:21504
    s_waitcnt lgkmcnt(3)
    v_mfma_f32_32x32x16_bf16 v[16:31], a[72:75], v[36:39], v[16:31]
    s_add_u32 m0, s32, 18432
    s_add_u32 s50, s34, 51200
    buffer_load_dwordx4 v1, s[4:7], s50 offen lds
    s_waitcnt vmcnt(28)
    ds_read_b128 v[36:39], v8 offset:22528
    s_waitcnt lgkmcnt(3)
    v_mfma_f32_32x32x16_bf16 v[16:31], a[76:79], v[40:43], v[16:31]
    s_add_u32 m0, s32, 19456
    s_add_u32 s50, s34, 52224
    buffer_load_dwordx4 v1, s[4:7], s50 offen lds
    s_waitcnt vmcnt(28)
    ds_read_b128 v[40:43], v8 offset:23552
    s_waitcnt lgkmcnt(3)
    v_mfma_f32_32x32x16_bf16 v[16:31], a[80:83], v[44:47], v[16:31]
    s_add_u32 m0, s32, 20480
    s_add_u32 s50, s34, 53248
    buffer_load_dwordx4 v1, s[4:7], s50 offen lds
    s_waitcnt vmcnt(28)
    ds_read_b128 v[44:47], v8 offset:24576
    s_waitcnt lgkmcnt(3)
    v_mfma_f32_32x32x16_bf16 v[16:31], a[84:87], v[32:35], v[16:31]
    s_add_u32 m0, s32, 21504
    s_add_u32 s50, s34, 54272
    buffer_load_dwordx4 v1, s[4:7], s50 offen lds
    s_waitcnt vmcnt(28)
    ds_read_b128 v[32:35], v8 offset:25600
    s_waitcnt lgkmcnt(3)
    v_mfma_f32_32x32x16_bf16 v[16:31], a[88:91], v[36:39], v[16:31]
    s_add_u32 m0, s32, 22528
    s_add_u32 s50, s34, 55296
    buffer_load_dwordx4 v1, s[4:7], s50 offen lds
    s_waitcnt vmcnt(28)
    ds_read_b128 v[36:39], v8 offset:26624
    s_waitcnt lgkmcnt(3)
    v_mfma_f32_32x32x16_bf16 v[16:31], a[92:95], v[40:43], v[16:31]
    s_add_u32 m0, s32, 23552
    s_add_u32 s50, s34, 56320
    buffer_load_dwordx4 v1, s[4:7], s50 offen lds
    s_waitcnt vmcnt(28)
    ds_read_b128 v[40:43], v8 offset:27648
    s_waitcnt lgkmcnt(3)
    v_mfma_f32_32x32x16_bf16 v[16:31], a[96:99], v[44:47], v[16:31]
    s_add_u32 m0, s32, 24576
    s_add_u32 s50, s34, 57344
    buffer_load_dwordx4 v1, s[4:7], s50 offen lds
    s_waitcnt vmcnt(28)
    ds_read_b128 v[44:47], v8 offset:28672
    s_waitcnt lgkmcnt(3)
    v_mfma_f32_32x32x16_bf16 v[16:31], a[100:103], v[32:35], v[16:31]
    s_add_u32 m0, s32, 25600
    s_add_u32 s50, s34, 58368
    buffer_load_dwordx4 v1, s[4:7], s50 offen lds
    s_waitcnt vmcnt(28)
    ds_read_b128 v[32:35], v8 offset:29696
    s_waitcnt lgkmcnt(3)
    v_mfma_f32_32x32x16_bf16 v[16:31], a[104:107], v[36:39], v[16:31]
    s_add_u32 m0, s32, 26624
    s_add_u32 s50, s34, 59392
    buffer_load_dwordx4 v1, s[4:7], s50 offen lds
    s_waitcnt vmcnt(28)
    ds_read_b128 v[36:39], v8 offset:30720
    s_waitcnt lgkmcnt(3)
    v_mfma_f32_32x32x16_bf16 v[16:31], a[108:111], v[40:43], v[16:31]
    s_add_u32 m0, s32, 27648
    s_add_u32 s50, s34, 60416
    buffer_load_dwordx4 v1, s[4:7], s50 offen lds
    s_waitcnt vmcnt(28)
    ds_read_b128 v[40:43], v8 offset:31744
    s_waitcnt lgkmcnt(3)
    v_mfma_f32_32x32x16_bf16 v[16:31], a[112:115], v[44:47], v[16:31]
    s_add_u32 m0, s32, 28672
    s_add_u32 s50, s34, 61440
    buffer_load_dwordx4 v1, s[4:7], s50 offen lds
    s_waitcnt vmcnt(28)
    ds_read_b128 v[44:47], v8 offset:0
    s_waitcnt lgkmcnt(3)
    v_mfma_f32_32x32x16_bf16 v[16:31], a[116:119], v[32:35], v[16:31]
    s_add_u32 m0, s32, 29696
    s_add_u32 s50, s34, 62464
    buffer_load_dwordx4 v1, s[4:7], s50 offen lds
    s_waitcnt vmcnt(28)
    ds_read_b128 v[32:35], v8 offset:1024
    s_waitcnt lgkmcnt(3)
    v_mfma_f32_32x32x16_bf16 v[16:31], a[120:123], v[36:39], v[16:31]
    s_add_u32 m0, s32, 30720
    s_add_u32 s50, s34, 63488
    buffer_load_dwordx4 v1, s[4:7], s50 offen lds
    s_waitcnt vmcnt(28)
    ds_read_b128 v[36:39], v8 offset:2048
    s_waitcnt lgkmcnt(3)
    v_mfma_f32_32x32x16_bf16 v[16:31], a[124:127], v[40:43], v[16:31]
    s_add_u32 m0, s32, 31744
    s_add_u32 s50, s34, 64512
    buffer_load_dwordx4 v1, s[4:7], s50 offen lds
    s_waitcnt vmcnt(28)
    ds_read_b128 v[40:43], v8 offset:3072
    s_waitcnt lgkmcnt(3)
    v_mfma_f32_32x32x16_bf16 v[16:31], a[128:131], v[44:47], v[16:31]
    s_waitcnt vmcnt(27)
    ds_read_b128 v[44:47], v8 offset:4096
    s_waitcnt lgkmcnt(3)
    v_mfma_f32_32x32x16_bf16 v[16:31], a[132:135], v[32:35], v[16:31]
    s_waitcnt vmcnt(26)
    ds_read_b128 v[32:35], v8 offset:5120
    s_waitcnt lgkmcnt(3)
    v_mfma_f32_32x32x16_bf16 v[16:31], a[136:139], v[36:39], v[16:31]
    s_waitcnt vmcnt(25)
    ds_read_b128 v[36:39], v8 offset:6144
    s_waitcnt lgkmcnt(3)
    v_mfma_f32_32x32x16_bf16 v[16:31], a[140:143], v[40:43], v[16:31]
    s_waitcnt vmcnt(24)
    ds_read_b128 v[40:43], v8 offset:7168
    s_waitcnt lgkmcnt(3)
    v_mfma_f32_32x32x16_bf16 v[16:31], a[144:147], v[44:47], v[16:31]
    s_cmp_ge_u32 s33, 62
    s_cbranch_scc1 L_fin_last
    s_cmp_ge_u32 s47, s49
    s_cbranch_scc1 L_fh_26
    s_mov_b32 s62, 0
L_pw_27:
    buffer_load_dword v9, v4, s[4:7], 0 offen sc1
    s_waitcnt vmcnt(0)
    v_cmp_gt_u32 vcc, s49, v9
    s_cbranch_vccz L_pok_28
    s_sleep 8
    s_add_u32 s62, s62, 1
    s_cmp_lt_u32 s62, 2000000
    s_cbranch_scc1 L_pw_27
    v_mov_b32 v1, 564
    v_mov_b32 v2, 192
    buffer_store_dword v1, v2, s[12:15], 0 offen sc1
    s_waitcnt vmcnt(0)
    s_endpgm
L_pok_28:
    v_readlane_b32 s47, v9, 0
    v_readlane_b32 s48, v9, 1
    s_min_u32 s47, s47, s48
    v_readlane_b32 s48, v9, 2
    s_min_u32 s47, s47, s48
    v_readlane_b32 s48, v9, 3
    s_min_u32 s47, s47, s48
    v_readlane_b32 s48, v9, 4
    s_min_u32 s47, s47, s48
    v_readlane_b32 s48, v9, 5
    s_min_u32 s47, s47, s48
    v_readlane_b32 s48, v9, 6
    s_min_u32 s47, s47, s48
    v_readlane_b32 s48, v9, 7
    s_min_u32 s47, s47, s48
    v_readlane_b32 s48, v9, 8
    s_min_u32 s47, s47, s48
    v_readlane_b32 s48, v9, 9
    s_min_u32 s47, s47, s48
    v_readlane_b32 s48, v9, 10
    s_min_u32 s47, s47, s48
    v_readlane_b32 s48, v9, 11
    s_min_u32 s47, s47, s48
    v_readlane_b32 s48, v9, 12
    s_min_u32 s47, s47, s48
    v_readlane_b32 s48, v9, 13
    s_min_u32 s47, s47, s48
    v_readlane_b32 s48, v9, 14
    s_min_u32 s47, s47, s48
    v_readlane_b32 s48, v9, 15
    s_min_u32 s47, s47, s48
    v_readlane_b32 s48, v9, 16
    s_min_u32 s47, s47, s48
    v_readlane_b32 s48, v9, 17
    s_min_u32 s47, s47, s48
    v_readlane_b32 s48, v9, 18
    s_min_u32 s47, s47, s48
    v_readlane_b32 s48, v9, 19
    s_min_u32 s47, s47, s48
    v_readlane_b32 s48, v9, 20
    s_min_u32 s47, s47, s48
    v_readlane_b32 s48, v9, 21
    s_min_u32 s47, s47, s48
    v_readlane_b32 s48, v9, 22
    s_min_u32 s47, s47, s48
    v_readlane_b32 s48, v9, 23
    s_min_u32 s47, s47, s48
    v_readlane_b32 s48, v9, 24
    s_min_u32 s47, s47, s48
    v_readlane_b32 s48, v9, 25
    s_min_u32 s47, s47, s48
    v_readlane_b32 s48, v9, 26
    s_min_u32 s47, s47, s48
L_fh_26:
    s_add_u32 s33, s33, 2
    s_add_u32 s46, s33, 1
    s_mul_i32 s37, s33, 40960
    buffer_load_dword v9, v3, s[4:7], 0 offen sc1
    buffer_load_dwordx2 v[14:15], v7, s[8:11], s37 offen
    s_waitcnt vmcnt(25)
    ds_read_b128 v[44:47], v8 offset:8192
    s_waitcnt lgkmcnt(3)
    v_mfma_f32_32x32x16_bf16 v[16:31], a[148:151], v[32:35], v[16:31]
    s_add_u32 m0, s32, 5120
    s_add_u32 s50, s35, 0
    buffer_load_dwordx4 v1, s[4:7], s50 offen lds
    s_waitcnt vmcnt(25)
    ds_read_b128 v[32:35], v8 offset:9216
    s_waitcnt lgkmcnt(3)
    v_mfma_f32_32x32x16_bf16 v[16:31], a[152:155], v[36:39], v[16:31]
    s_waitcnt vmcnt(24)
    ds_read_b128 v[36:39], v8 offset:10240
    s_waitcnt lgkmcnt(3)
    v_mfma_f32_32x32x16_bf16 v[16:31], a[156:159], v[40:43], v[16:31]
    s_add_u32 m0, s32, 6144
    s_add_u32 s50, s35, 1024
    buffer_load_dwordx4 v1, s[4:7], s50 offen lds
    s_waitcnt vmcnt(24)
    ds_read_b128 v[40:43], v8 offset:11264
    s_waitcnt lgkmcnt(3)
    v_mfma_f32_32x32x16_bf16 v[16:31], a[160:163], v[44:47], v[16:31]
    s_waitcnt vmcnt(23)
    ds_read_b128 v[44:47], v8 offset:12288
    s_waitcnt lgkmcnt(3)
    v_mfma_f32_32x32x16_bf16 v[16:31], a[164:167], v[32:35], v[16:31]
    s_add_u32 m0, s32, 7168
    s_add_u32 s50, s35, 2048
    buffer_load_dwordx4 v1, s[4:7], s50 offen lds
    s_waitcnt vmcnt(23)
    ds_read_b128 v[32:35], v8 offset:13312
    s_waitcnt lgkmcnt(3)
    v_mfma_f32_32x32x16_bf16 v[16:31], a[168:171], v[36:39], v[16:31]
    s_waitcnt vmcnt(22)
    ds_read_b128 v[36:39], v8 offset:14336
    s_waitcnt lgkmcnt(3)
    v_mfma_f32_32x32x16_bf16 v[16:31], a[172:175], v[40:43], v[16:31]
    s_add_u32 m0, s32, 8192
    s_add_u32 s50, s35, 3072
    buffer_load_dwordx4 v1, s[4:7], s50 offen lds
    s_waitcnt vmcnt(22)
    ds_read_b128 v[40:43], v8 offset:15360
    s_waitcnt lgkmcnt(3)
    v_mfma_f32_32x32x16_bf16 v[16:31], a[176:179], v[44:47], v[16:31]
    s_waitcnt vmcnt(21)
    ds_read_b128 v[44:47], v8 offset:16384
    s_waitcnt lgkmcnt(3)
    v_mfma_f32_32x32x16_bf16 v[16:31], a[180:183], v[32:35], v[16:31]
    s_add_u32 m0, s32, 9216
    s_add_u32 s50, s35, 4096
    buffer_load_dwordx4 v1, s[4:7], s50 offen lds
    s_waitcnt vmcnt(21)
    ds_read_b128 v[32:35], v8 offset:17408
    s_waitcnt lgkmcnt(3)
    v_mfma_f32_32x32x16_bf16 v[16:31], a[184:187], v[36:39], v[16:31]
    s_waitcnt vmcnt(20)
    ds_read_b128 v[36:39], v8 offset:18432
    s_waitcnt lgkmcnt(3)
    v_mfma_f32_32x32x16_bf16 v[16:31], a[188:191], v[40:43], v[16:31]
    s_add_u32 m0, s32, 10240
    s_add_u32 s50, s35, 5120
    buffer_load_dwordx4 v1, s[4:7], s50 offen lds
    s_waitcnt vmcnt(20)
    ds_read_b128 v[40:43], v8 offset:19456
    s_waitcnt lgkmcnt(3)
    v_mfma_f32_32x32x16_bf16 v[16:31], a[192:195], v[44:47], v[16:31]
    s_waitcnt vmcnt(19)
    ds_read_b128 v[44:47], v8 offset:20480
    s_waitcnt lgkmcnt(3)
    v_mfma_f32_32x32x16_bf16 v[16:31], a[196:199], v[32:35], v[16:31]
    s_add_u32 m0, s32, 11264
    s_add_u32 s50, s35, 6144
    buffer_load_dwordx4 v1, s[4:7], s50 offen lds
    s_waitcnt vmcnt(19)
    ds_read_b128 v[32:35], v8 offset:21504
    s_waitcnt lgkmcnt(3)
    v_mfma_f32_32x32x16_bf16 v[16:31], a[200:203], v[36:39], v[16:31]
    s_waitcnt vmcnt(18)
    ds_read_b128 v[36:39], v8 offset:22528
    s_waitcnt lgkmcnt(3)
    v_mfma_f32_32x32x16_bf16 v[16:31], a[204:207], v[40:43], v[16:31]
    s_add_u32 m0, s32, 12288
    s_add_u32 s50, s35, 7168
    buffer_load_dwordx4 v1, s[4:7], s50 offen lds
    s_waitcnt vmcnt(18)
    ds_read_b128 v[40:43], v8 offset:23552
    s_waitcnt lgkmcnt(3)
    v_mfma_f32_32x32x16_bf16 v[16:31], a[208:211], v[44:47], v[16:31]
    s_waitcnt vmcnt(17)
    ds_read_b128 v[44:47], v8 offset:24576
    s_waitcnt lgkmcnt(3)
    v_mfma_f32_32x32x16_bf16 v[16:31], a[212:215], v[32:35], v[16:31]
    s_add_u32 m0, s32, 13312
    s_add_u32 s50, s35, 8192
    buffer_load_dwordx4 v1, s[4:7], s50 offen lds
    s_waitcnt vmcnt(17)
    ds_read_b128 v[32:35], v8 offset:25600
    s_waitcnt lgkmcnt(3)
    v_mfma_f32_32x32x16_bf16 v[16:31], a[216:219], v[36:39], v[16:31]
    s_waitcnt vmcnt(16)
    ds_read_b128 v[36:39], v8 offset:26624
    s_waitcnt lgkmcnt(3)
    v_mfma_f32_32x32x16_bf16 v[16:31], a[220:223], v[40:43], v[16:31]
    s_add_u32 m0, s32, 14336
    s_add_u32 s50, s35, 9216
    buffer_load_dwordx4 v1, s[4:7], s50 offen lds
    s_waitcnt vmcnt(16)
    ds_read_b128 v[40:43], v8 offset:27648
    s_waitcnt lgkmcnt(3)
    v_mfma_f32_32x32x16_bf16 v[16:31], a[224:227], v[44:47], v[16:31]
    s_waitcnt vmcnt(15)
    ds_read_b128 v[44:47], v8 offset:28672
    s_waitcnt lgkmcnt(3)
    v_mfma_f32_32x32x16_bf16 v[16:31], a[228:231], v[32:35], v[16:31]
    s_add_u32 m0, s32, 15360
    s_add_u32 s50, s35, 10240
    buffer_load_dwordx4 v1, s[4:7], s50 offen lds
    s_waitcnt vmcnt(15)
    ds_read_b128 v[32:35], v8 offset:29696
    s_waitcnt lgkmcnt(3)
    v_mfma_f32_32x32x16_bf16 v[16:31], a[232:235], v[36:39], v[16:31]
    s_waitcnt vmcnt(14)
    ds_read_b128 v[36:39], v8 offset:30720
    s_waitcnt lgkmcnt(3)
    v_mfma_f32_32x32x16_bf16 v[16:31], a[236:239], v[40:43], v[16:31]
    s_add_u32 m0, s32, 16384
    s_add_u32 s50, s35, 11264
    buffer_load_dwordx4 v1, s[4:7], s50 offen lds
    s_waitcnt vmcnt(14)
    ds_read_b128 v[40:43], v8 offset:31744
    s_waitcnt lgkmcnt(3)
    v_mfma_f32_32x32x16_bf16 v[16:31], a[240:243], v[44:47], v[16:31]
    s_waitcnt lgkmcnt(2)
    v_mfma_f32_32x32x16_bf16 v[16:31], a[244:247], v[32:35], v[16:31]
    s_add_u32 m0, s32, 17408
    s_add_u32 s50, s35, 12288
    buffer_load_dwordx4 v1, s[4:7], s50 offen lds
    s_waitcnt lgkmcnt(1)
    v_mfma_f32_32x32x16_bf16 v[16:31], a[248:251], v[36:39], v[16:31]
    s_waitcnt lgkmcnt(0)
    v_mfma_f32_32x32x16_bf16 v[16:31], a[252:255], v[40:43], v[16:31]
    s_add_u32 m0, s32, 18432
    s_add_u32 s50, s35, 13312
    buffer_load_dwordx4 v1, s[4:7], s50 offen lds
    s_barrier
    s_nop 7
    ds_write_b128 v5, v[16:19] offset:0
    ds_write_b128 v5, v[20:23] offset:32
    ds_write_b128 v5, v[24:27] offset:64
    ds_write_b128 v5, v[28:31] offset:96
    s_add_u32 m0, s32, 19456
    s_add_u32 s50, s35, 14336
    buffer_load_dwordx4 v1, s[4:7], s50 offen lds
    s_add_u32 m0, s32, 20480
    s_add_u32 s50, s35, 15360
    buffer_load_dwordx4 v1, s[4:7], s50 offen lds
    s_add_u32 m0, s32, 21504
    s_add_u32 s50, s35, 16384
    buffer_load_dwordx4 v1, s[4:7], s50 offen lds
    s_add_u32 m0, s32, 22528
    s_add_u32 s50, s35, 17408
    buffer_load_dwordx4 v1, s[4:7], s50 offen lds
    s_waitcnt lgkmcnt(0)
    s_barrier
    ds_read_b128 v[32:35], v6 offset:0
    ds_read_b128 v[36:39], v6 offset:4608
    ds_read_b128 v[40:43], v6 offset:9216
    ds_read_b128 v[44:47], v6 offset:13824
    s_add_u32 m0, s32, 23552
    s_add_u32 s50, s35, 18432
    buffer_load_dwordx4 v1, s[4:7], s50 offen lds
    s_add_u32 m0, s32, 24576
    s_add_u32 s50, s35, 19456
    buffer_load_dwordx4 v1, s[4:7], s50 offen lds
    s_add_u32 m0, s32, 25600
    s_add_u32 s50, s35, 20480
    buffer_load_dwordx4 v1, s[4:7], s50 offen lds
    s_add_u32 m0, s32, 26624
    s_add_u32 s50, s35, 21504
    buffer_load_dwordx4 v1, s[4:7], s50 offen lds
    v_lshlrev_b32 v48, 16, v12
    v_and_b32 v49, 0xffff0000, v12
    v_lshlrev_b32 v50, 16, v13
    v_and_b32 v51, 0xffff0000, v13
    s_waitcnt lgkmcnt(2)
    v_pk_add_f32 v[32:33], v[32:33], v[36:37]
    v_pk_add_f32 v[34:35], v[34:35], v[38:39]
    s_waitcnt lgkmcnt(0)
    v_pk_add_f32 v[40:41], v[40:41], v[44:45]
    v_pk_add_f32 v[42:43], v[42:43], v[46:47]
    v_pk_add_f32 v[32:33], v[32:33], v[40:41]
    v_pk_add_f32 v[34:35], v[34:35], v[42:43]
    v_pk_add_f32 v[32:33], v[32:33], v[48:49]
    v_pk_add_f32 v[34:35], v[34:35], v[50:51]
    v_cvt_pk_bf16_f32 v32, v32, v33
    v_cvt_pk_bf16_f32 v33, v34, v35
    buffer_store_dwordx2 v[32:33], v7, s[20:23], s36 offen
    s_add_u32 m0, s32, 27648
    s_add_u32 s50, s35, 22528
    buffer_load_dwordx4 v1, s[4:7], s50 offen lds
    s_add_u32 m0, s32, 28672
    s_add_u32 s50, s35, 23552
    buffer_load_dwordx4 v1, s[4:7], s50 offen lds
    s_add_u32 m0, s32, 29696
    s_add_u32 s50, s35, 24576
    buffer_load_dwordx4 v1, s[4:7], s50 offen lds
    s_add_u32 m0, s32, 30720
    s_add_u32 s50, s35, 25600
    buffer_load_dwordx4 v1, s[4:7], s50 offen lds
    s_add_u32 m0, s32, 31744
    s_add_u32 s50, s35, 26624
    buffer_load_dwordx4 v1, s[4:7], s50 offen lds
    s_branch L_fin_loop
L_fin_last:
    s_waitcnt vmcnt(23)
    ds_read_b128 v[44:47], v8 offset:8192
    s_waitcnt lgkmcnt(3)
    v_mfma_f32_32x32x16_bf16 v[16:31], a[148:151], v[32:35], v[16:31]
    s_waitcnt vmcnt(22)
    ds_read_b128 v[32:35], v8 offset:9216
    s_waitcnt lgkmcnt(3)
    v_mfma_f32_32x32x16_bf16 v[16:31], a[152:155], v[36:39], v[16:31]
    s_waitcnt vmcnt(21)
    ds_read_b128 v[36:39], v8 offset:10240
    s_waitcnt lgkmcnt(3)
    v_mfma_f32_32x32x16_bf16 v[16:31], a[156:159], v[40:43], v[16:31]
    s_waitcnt vmcnt(20)
    ds_read_b128 v[40:43], v8 offset:11264
    s_waitcnt lgkmcnt(3)
    v_mfma_f32_32x32x16_bf16 v[16:31], a[160:163], v[44:47], v[16:31]
    s_waitcnt vmcnt(19)
    ds_read_b128 v[44:47], v8 offset:12288
    s_waitcnt lgkmcnt(3)
    v_mfma_f32_32x32x16_bf16 v[16:31], a[164:167], v[32:35], v[16:31]
    s_waitcnt vmcnt(18)
    ds_read_b128 v[32:35], v8 offset:13312
    s_waitcnt lgkmcnt(3)
    v_mfma_f32_32x32x16_bf16 v[16:31], a[168:171], v[36:39], v[16:31]
    s_waitcnt vmcnt(17)
    ds_read_b128 v[36:39], v8 offset:14336
    s_waitcnt lgkmcnt(3)
    v_mfma_f32_32x32x16_bf16 v[16:31], a[172:175], v[40:43], v[16:31]
    s_waitcnt vmcnt(16)
    ds_read_b128 v[40:43], v8 offset:15360
    s_waitcnt lgkmcnt(3)
    v_mfma_f32_32x32x16_bf16 v[16:31], a[176:179], v[44:47], v[16:31]
    s_waitcnt vmcnt(15)
    ds_read_b128 v[44:47], v8 offset:16384
    s_waitcnt lgkmcnt(3)
    v_mfma_f32_32x32x16_bf16 v[16:31], a[180:183], v[32:35], v[16:31]
    s_waitcnt vmcnt(14)
    ds_read_b128 v[32:35], v8 offset:17408
    s_waitcnt lgkmcnt(3)
    v_mfma_f32_32x32x16_bf16 v[16:31], a[184:187], v[36:39], v[16:31]
    s_waitcnt vmcnt(13)
    ds_read_b128 v[36:39], v8 offset:18432
    s_waitcnt lgkmcnt(3)
    v_mfma_f32_32x32x16_bf16 v[16:31], a[188:191], v[40:43], v[16:31]
    s_waitcnt vmcnt(12)
    ds_read_b128 v[40:43], v8 offset:19456
    s_waitcnt lgkmcnt(3)
    v_mfma_f32_32x32x16_bf16 v[16:31], a[192:195], v[44:47], v[16:31]
    s_waitcnt vmcnt(11)
    ds_read_b128 v[44:47], v8 offset:20480
    s_waitcnt lgkmcnt(3)
    v_mfma_f32_32x32x16_bf16 v[16:31], a[196:199], v[32:35], v[16:31]
    s_waitcnt vmcnt(10)
    ds_read_b128 v[32:35], v8 offset:21504
    s_waitcnt lgkmcnt(3)
    v_mfma_f32_32x32x16_bf16 v[16:31], a[200:203], v[36:39], v[16:31]
    s_waitcnt vmcnt(9)
    ds_read_b128 v[36:39], v8 offset:22528
    s_waitcnt lgkmcnt(3)
    v_mfma_f32_32x32x16_bf16 v[16:31], a[204:207], v[40:43], v[16:31]
    s_waitcnt vmcnt(8)
    ds_read_b128 v[40:43], v8 offset:23552
    s_waitcnt lgkmcnt(3)
    v_mfma_f32_32x32x16_bf16 v[16:31], a[208:211], v[44:47], v[16:31]
    s_waitcnt vmcnt(7)
    ds_read_b128 v[44:47], v8 offset:24576
    s_waitcnt lgkmcnt(3)
    v_mfma_f32_32x32x16_bf16 v[16:31], a[212:215], v[32:35], v[16:31]
    s_waitcnt vmcnt(6)
    ds_read_b128 v[32:35], v8 offset:25600
    s_waitcnt lgkmcnt(3)
    v_mfma_f32_32x32x16_bf16 v[16:31], a[216:219], v[36:39], v[16:31]
    s_waitcnt vmcnt(5)
    ds_read_b128 v[36:39], v8 offset:26624
    s_waitcnt lgkmcnt(3)
    v_mfma_f32_32x32x16_bf16 v[16:31], a[220:223], v[40:43], v[16:31]
    s_waitcnt vmcnt(4)
    ds_read_b128 v[40:43], v8 offset:27648
    s_waitcnt lgkmcnt(3)
    v_mfma_f32_32x32x16_bf16 v[16:31], a[224:227], v[44:47], v[16:31]
    s_waitcnt vmcnt(3)
    ds_read_b128 v[44:47], v8 offset:28672
    s_waitcnt lgkmcnt(3)
    v_mfma_f32_32x32x16_bf16 v[16:31], a[228:231], v[32:35], v[16:31]
    s_waitcnt vmcnt(2)
    ds_read_b128 v[32:35], v8 offset:29696
    s_waitcnt lgkmcnt(3)
    v_mfma_f32_32x32x16_bf16 v[16:31], a[232:235], v[36:39], v[16:31]
    s_waitcnt vmcnt(1)
    ds_read_b128 v[36:39], v8 offset:30720
    s_waitcnt lgkmcnt(3)
    v_mfma_f32_32x32x16_bf16 v[16:31], a[236:239], v[40:43], v[16:31]
    s_waitcnt vmcnt(0)
    ds_read_b128 v[40:43], v8 offset:31744
    s_waitcnt lgkmcnt(3)
    v_mfma_f32_32x32x16_bf16 v[16:31], a[240:243], v[44:47], v[16:31]
    s_waitcnt lgkmcnt(2)
    v_mfma_f32_32x32x16_bf16 v[16:31], a[244:247], v[32:35], v[16:31]
    s_waitcnt lgkmcnt(1)
    v_mfma_f32_32x32x16_bf16 v[16:31], a[248:251], v[36:39], v[16:31]
    s_waitcnt lgkmcnt(0)
    v_mfma_f32_32x32x16_bf16 v[16:31], a[252:255], v[40:43], v[16:31]
    s_barrier
    s_nop 10
    ds_write_b128 v5, v[16:19] offset:0
    ds_write_b128 v5, v[20:23] offset:32
    ds_write_b128 v5, v[24:27] offset:64
    ds_write_b128 v5, v[28:31] offset:96
    s_waitcnt lgkmcnt(0)
    s_barrier
    ds_read_b128 v[32:35], v6 offset:0
    ds_read_b128 v[36:39], v6 offset:4608
    ds_read_b128 v[40:43], v6 offset:9216
    ds_read_b128 v[44:47], v6 offset:13824
    v_lshlrev_b32 v48, 16, v12
    v_and_b32 v49, 0xffff0000, v12
    v_lshlrev_b32 v50, 16, v13
    v_and_b32 v51, 0xffff0000, v13
    s_waitcnt lgkmcnt(2)
    v_pk_add_f32 v[32:33], v[32:33], v[36:37]
    v_pk_add_f32 v[34:35], v[34:35], v[38:39]
    s_waitcnt lgkmcnt(0)
    v_pk_add_f32 v[40:41], v[40:41], v[44:45]
    v_pk_add_f32 v[42:43], v[42:43], v[46:47]
    v_pk_add_f32 v[32:33], v[32:33], v[40:41]
    v_pk_add_f32 v[34:35], v[34:35], v[42:43]
    v_pk_add_f32 v[32:33], v[32:33], v[48:49]
    v_pk_add_f32 v[34:35], v[34:35], v[50:51]
    v_cvt_pk_bf16_f32 v32, v32, v33
    v_cvt_pk_bf16_f32 v33, v34, v35
    buffer_store_dwordx2 v[32:33], v7, s[20:23], s36 offen
    s_waitcnt vmcnt(0)
    s_endpgm
L_fin_late:
    s_waitcnt vmcnt(27)
    ds_read_b128 v[32:35], v8 offset:5120
    s_waitcnt vmcnt(26)
    ds_read_b128 v[36:39], v8 offset:6144
    s_waitcnt vmcnt(25)
    ds_read_b128 v[40:43], v8 offset:7168
    s_waitcnt vmcnt(24)
    ds_read_b128 v[44:47], v8 offset:8192
    s_waitcnt lgkmcnt(3)
    v_mfma_f32_32x32x16_bf16 v[16:31], v[128:131], v[32:35], 0
    s_waitcnt vmcnt(23)
    ds_read_b128 v[32:35], v8 offset:9216
    s_waitcnt lgkmcnt(3)
    v_mfma_f32_32x32x16_bf16 v[16:31], v[132:135], v[36:39], v[16:31]
    s_waitcnt vmcnt(22)
    ds_read_b128 v[36:39], v8 offset:10240
    s_waitcnt lgkmcnt(3)
    v_mfma_f32_32x32x16_bf16 v[16:31], v[136:139], v[40:43], v[16:31]
    s_waitcnt vmcnt(21)
    ds_read_b128 v[40:43], v8 offset:11264
    s_waitcnt lgkmcnt(3)
    v_mfma_f32_32x32x16_bf16 v[16:31], v[140:143], v[44:47], v[16:31]
    s_waitcnt vmcnt(20)
    ds_read_b128 v[44:47], v8 offset:12288
    s_waitcnt lgkmcnt(3)
    v_mfma_f32_32x32x16_bf16 v[16:31], v[144:147], v[32:35], v[16:31]
    s_waitcnt vmcnt(19)
    ds_read_b128 v[32:35], v8 offset:13312
    s_waitcnt lgkmcnt(3)
    v_mfma_f32_32x32x16_bf16 v[16:31], v[148:151], v[36:39], v[16:31]
    s_waitcnt vmcnt(18)
    ds_read_b128 v[36:39], v8 offset:14336
    s_waitcnt lgkmcnt(3)
    v_mfma_f32_32x32x16_bf16 v[16:31], v[152:155], v[40:43], v[16:31]
    s_waitcnt vmcnt(17)
    ds_read_b128 v[40:43], v8 offset:15360
    s_waitcnt lgkmcnt(3)
    v_mfma_f32_32x32x16_bf16 v[16:31], v[156:159], v[44:47], v[16:31]
    s_waitcnt vmcnt(16)
    ds_read_b128 v[44:47], v8 offset:16384
    s_waitcnt lgkmcnt(3)
    v_mfma_f32_32x32x16_bf16 v[16:31], v[160:163], v[32:35], v[16:31]
    s_waitcnt vmcnt(15)
    ds_read_b128 v[32:35], v8 offset:17408
    s_waitcnt lgkmcnt(3)
    v_mfma_f32_32x32x16_bf16 v[16:31], v[164:167], v[36:39], v[16:31]
    s_waitcnt vmcnt(14)
    ds_read_b128 v[36:39], v8 offset:18432
    s_waitcnt lgkmcnt(3)
    v_mfma_f32_32x32x16_bf16 v[16:31], v[168:171], v[40:43], v[16:31]
    s_waitcnt vmcnt(13)
    ds_read_b128 v[40:43], v8 offset:19456
    s_waitcnt lgkmcnt(3)
    v_mfma_f32_32x32x16_bf16 v[16:31], v[172:175], v[44:47], v[16:31]
    s_waitcnt vmcnt(12)
    ds_read_b128 v[44:47], v8 offset:20480
    s_waitcnt lgkmcnt(3)
    v_mfma_f32_32x32x16_bf16 v[16:31], v[176:179], v[32:35], v[16:31]
    s_waitcnt vmcnt(11)
    ds_read_b128 v[32:35], v8 offset:21504
    s_waitcnt lgkmcnt(3)
    v_mfma_f32_32x32x16_bf16 v[16:31], v[180:183], v[36:39], v[16:31]
    s_waitcnt vmcnt(10)
    ds_read_b128 v[36:39], v8 offset:22528
    s_waitcnt lgkmcnt(3)
    v_mfma_f32_32x32x16_bf16 v[16:31], v[184:187], v[40:43], v[16:31]
    s_waitcnt vmcnt(9)
    ds_read_b128 v[40:43], v8 offset:23552
    s_waitcnt lgkmcnt(3)
    v_mfma_f32_32x32x16_bf16 v[16:31], v[188:191], v[44:47], v[16:31]
    s_waitcnt vmcnt(8)
    ds_read_b128 v[44:47], v8 offset:24576
    s_waitcnt lgkmcnt(3)
    v_mfma_f32_32x32x16_bf16 v[16:31], v[192:195], v[32:35], v[16:31]
    s_waitcnt vmcnt(7)
    ds_read_b128 v[32:35], v8 offset:25600
    s_waitcnt lgkmcnt(3)
    v_mfma_f32_32x32x16_bf16 v[16:31], v[196:199], v[36:39], v[16:31]
    s_waitcnt vmcnt(6)
    ds_read_b128 v[36:39], v8 offset:26624
    s_waitcnt lgkmcnt(3)
    v_mfma_f32_32x32x16_bf16 v[16:31], v[200:203], v[40:43], v[16:31]
    s_waitcnt vmcnt(4)
    ds_read_b128 v[40:43], v8 offset:27648
    s_waitcnt lgkmcnt(3)
    v_mfma_f32_32x32x16_bf16 v[16:31], v[204:207], v[44:47], v[16:31]
    s_waitcnt vmcnt(3)
    ds_read_b128 v[44:47], v8 offset:28672
    s_waitcnt lgkmcnt(3)
    v_mfma_f32_32x32x16_bf16 v[16:31], v[208:211], v[32:35], v[16:31]
    s_waitcnt vmcnt(2)
    ds_read_b128 v[32:35], v8 offset:29696
    s_waitcnt lgkmcnt(3)
    v_mfma_f32_32x32x16_bf16 v[16:31], v[212:215], v[36:39], v[16:31]
    s_waitcnt vmcnt(1)
    ds_read_b128 v[36:39], v8 offset:30720
    s_waitcnt lgkmcnt(3)
    v_mfma_f32_32x32x16_bf16 v[16:31], v[216:219], v[40:43], v[16:31]
    s_waitcnt vmcnt(0)
    ds_read_b128 v[40:43], v8 offset:31744
    s_waitcnt lgkmcnt(3)
    v_mfma_f32_32x32x16_bf16 v[16:31], v[220:223], v[44:47], v[16:31]
    s_waitcnt lgkmcnt(2)
    v_mfma_f32_32x32x16_bf16 v[16:31], v[224:227], v[32:35], v[16:31]
    s_waitcnt lgkmcnt(1)
    v_mfma_f32_32x32x16_bf16 v[16:31], v[228:231], v[36:39], v[16:31]
    s_waitcnt lgkmcnt(0)
    v_mfma_f32_32x32x16_bf16 v[16:31], v[232:235], v[40:43], v[16:31]
    s_mov_b32 s62, 0
L_pw_29:
    buffer_load_dword v9, v3, s[4:7], 0 offen sc1
    s_waitcnt vmcnt(0)
    v_cmp_gt_u32 vcc, s46, v9
    s_cbranch_vccz L_pok_30
    s_sleep 2
    s_add_u32 s62, s62, 1
    s_cmp_lt_u32 s62, 2000000
    s_cbranch_scc1 L_pw_29
    v_mov_b32 v1, 561
    v_mov_b32 v2, 192
    buffer_store_dword v1, v2, s[12:15], 0 offen sc1
    s_waitcnt vmcnt(0)
    s_endpgm
L_pok_30:
    s_add_u32 m0, s32, 0
    s_add_u32 s50, s34, 0
    buffer_load_dwordx4 v1, s[4:7], s50 offen lds
    s_add_u32 m0, s32, 1024
    s_add_u32 s50, s34, 1024
    buffer_load_dwordx4 v1, s[4:7], s50 offen lds
    s_add_u32 m0, s32, 2048
    s_add_u32 s50, s34, 2048
    buffer_load_dwordx4 v1, s[4:7], s50 offen lds
    s_add_u32 m0, s32, 3072
    s_add_u32 s50, s34, 3072
    buffer_load_dwordx4 v1, s[4:7], s50 offen lds
    s_add_u32 m0, s32, 4096
    s_add_u32 s50, s34, 4096
    buffer_load_dwordx4 v1, s[4:7], s50 offen lds
    s_add_u32 m0, s32, 5120
    s_add_u32 s50, s34, 5120
    buffer_load_dwordx4 v1, s[4:7], s50 offen lds
    s_add_u32 m0, s32, 6144
    s_add_u32 s50, s34, 6144
    buffer_load_dwordx4 v1, s[4:7], s50 offen lds
    s_add_u32 m0, s32, 7168
    s_add_u32 s50, s34, 7168
    buffer_load_dwordx4 v1, s[4:7], s50 offen lds
    s_add_u32 m0, s32, 8192
    s_add_u32 s50, s34, 8192
    buffer_load_dwordx4 v1, s[4:7], s50 offen lds
    s_add_u32 m0, s32, 9216
    s_add_u32 s50, s34, 9216
    buffer_load_dwordx4 v1, s[4:7], s50 offen lds
    s_add_u32 m0, s32, 10240
    s_add_u32 s50, s34, 10240
    buffer_load_dwordx4 v1, s[4:7], s50 offen lds
    s_add_u32 m0, s32, 11264
    s_add_u32 s50, s34, 11264
    buffer_load_dwordx4 v1, s[4:7], s50 offen lds
    s_add_u32 m0, s32, 12288
    s_add_u32 s50, s34, 12288
    buffer_load_dwordx4 v1, s[4:7], s50 offen lds
    s_add_u32 m0, s32, 13312
    s_add_u32 s50, s34, 13312
    buffer_load_dwordx4 v1, s[4:7], s50 offen lds
    s_add_u32 m0, s32, 14336
    s_add_u32 s50, s34, 14336
    buffer_load_dwordx4 v1, s[4:7], s50 offen lds
    s_add_u32 m0, s32, 15360
    s_add_u32 s50, s34, 15360
    buffer_load_dwordx4 v1, s[4:7], s50 offen lds
    s_add_u32 m0, s32, 16384
    s_add_u32 s50, s34, 16384
    buffer_load_dwordx4 v1, s[4:7], s50 offen lds
    s_add_u32 m0, s32, 17408
    s_add_u32 s50, s34, 17408
    buffer_load_dwordx4 v1, s[4:7], s50 offen lds
    s_add_u32 m0, s32, 18432
    s_add_u32 s50, s34, 18432
    buffer_load_dwordx4 v1, s[4:7], s50 offen lds
    s_add_u32 m0, s32, 19456
    s_add_u32 s50, s34, 19456
    buffer_load_dwordx4 v1, s[4:7], s50 offen lds
    s_add_u32 m0, s32, 20480
    s_add_u32 s50, s34, 20480
    buffer_load_dwordx4 v1, s[4:7], s50 offen lds
    s_add_u32 m0, s32, 21504
    s_add_u32 s50, s34, 21504
    buffer_load_dwordx4 v1, s[4:7], s50 offen lds
    s_add_u32 m0, s32, 22528
    s_add_u32 s50, s34, 22528
    buffer_load_dwordx4 v1, s[4:7], s50 offen lds
    s_add_u32 m0, s32, 23552
    s_add_u32 s50, s34, 23552
    buffer_load_dwordx4 v1, s[4:7], s50 offen lds
    s_add_u32 m0, s32, 24576
    s_add_u32 s50, s34, 24576
    buffer_load_dwordx4 v1, s[4:7], s50 offen lds
    s_add_u32 m0, s32, 25600
    s_add_u32 s50, s34, 25600
    buffer_load_dwordx4 v1, s[4:7], s50 offen lds
    s_add_u32 m0, s32, 26624
    s_add_u32 s50, s34, 26624
    buffer_load_dwordx4 v1, s[4:7], s50 offen lds
    s_add_u32 m0, s32, 27648
    s_add_u32 s50, s34, 27648
    buffer_load_dwordx4 v1, s[4:7], s50 offen lds
    s_add_u32 m0, s32, 28672
    s_add_u32 s50, s34, 28672
    buffer_load_dwordx4 v1, s[4:7], s50 offen lds
    s_add_u32 m0, s32, 29696
    s_add_u32 s50, s34, 29696
    buffer_load_dwordx4 v1, s[4:7], s50 offen lds
    s_add_u32 m0, s32, 30720
    s_add_u32 s50, s34, 30720
    buffer_load_dwordx4 v1, s[4:7], s50 offen lds
    s_add_u32 m0, s32, 31744
    s_add_u32 s50, s34, 31744
    buffer_load_dwordx4 v1, s[4:7], s50 offen lds
    s_branch L_fin_go
L_role_V:
    v_and_b32 v10, 63, v0
    v_lshlrev_b32 v1, 4, v10
    s_mov_b32 s8, s70
    s_and_b32 s9, s71, 0xffff
    s_mov_b32 s10, 0x500000
    s_mov_b32 s11, 0x20000
    s_mov_b32 s20, s72
    s_and_b32 s21, s73, 0xffff
    s_mov_b32 s22, 0x500000
    s_mov_b32 s23, 0x20000
    v_lshrrev_b32 v11, 4, v10
    v_lshlrev_b32 v12, 2, v11
    v_sub_u32 v12, v10, v12
    v_and_b32 v12, 15, v12
    s_lshl_b32 s50, s16, 2
    v_add_u32 v11, s50, v11
    s_lshl_b32 s32, s16, 10
    v_lshlrev_b32 v11, 13, v11
    v_lshl_add_u32 v13, v12, 4, v11
    s_lshl_b32 s50, s17, 8
    s_add_u32 m0, s32, 0
    s_add_u32 s51, s50, 0
    buffer_load_dwordx4 v13, s[8:11], s51 offen lds
    s_add_u32 m0, s32, 4096
    s_add_u32 s51, s50, 131072
    buffer_load_dwordx4 v13, s[8:11], s51 offen lds
    s_add_u32 m0, s32, 8192
    s_add_u32 s51, s50, 262144
    buffer_load_dwordx4 v13, s[8:11], s51 offen lds
    s_add_u32 m0, s32, 12288
    s_add_u32 s51, s50, 393216
    buffer_load_dwordx4 v13, s[8:11], s51 offen lds
    s_add_u32 m0, s32, 16384
    s_add_u32 s51, s50, 524288
    buffer_load_dwordx4 v13, s[8:11], s51 offen lds
    s_add_u32 m0, s32, 20480
    s_add_u32 s51, s50, 655360
    buffer_load_dwordx4 v13, s[8:11], s51 offen lds
    s_add_u32 m0, s32, 24576
    s_add_u32 s51, s50, 786432
    buffer_load_dwordx4 v13, s[8:11], s51 offen lds
    s_add_u32 m0, s32, 28672
    s_add_u32 s51, s50, 917504
    buffer_load_dwordx4 v13, s[8:11], s51 offen lds
    s_add_u32 m0, s32, 32768
    s_add_u32 s51, s50, 0
    buffer_load_dwordx4 v13, s[20:23], s51 offen lds
    s_add_u32 m0, s32, 36864
    s_add_u32 s51, s50, 131072
    buffer_load_dwordx4 v13, s[20:23], s51 offen lds
    s_add_u32 m0, s32, 40960
    s_add_u32 s51, s50, 262144
    buffer_load_dwordx4 v13, s[20:23], s51 offen lds
    s_add_u32 m0, s32, 45056
    s_add_u32 s51, s50, 393216
    buffer_load_dwordx4 v13, s[20:23], s51 offen lds
    s_add_u32 m0, s32, 49152
    s_add_u32 s51, s50, 524288
    buffer_load_dwordx4 v13, s[20:23], s51 offen lds
    s_add_u32 m0, s32, 53248
    s_add_u32 s51, s50, 655360
    buffer_load_dwordx4 v13, s[20:23], s51 offen lds
    s_add_u32 m0, s32, 57344
    s_add_u32 s51, s50, 786432
    buffer_load_dwordx4 v13, s[20:23], s51 offen lds
    s_add_u32 m0, s32, 61440
    s_add_u32 s51, s50, 917504
    buffer_load_dwordx4 v13, s[20:23], s51 offen lds
    s_add_u32 m0, s32, 65536
    s_add_u32 s51, s50, 1048576
    buffer_load_dwordx4 v13, s[8:11], s51 offen lds
    s_add_u32 m0, s32, 69632
    s_add_u32 s51, s50, 1179648
    buffer_load_dwordx4 v13, s[8:11], s51 offen lds
    s_add_u32 m0, s32, 73728
    s_add_u32 s51, s50, 1310720
    buffer_load_dwordx4 v13, s[8:11], s51 offen lds
    s_add_u32 m0, s32, 77824
    s_add_u32 s51, s50, 1441792
    buffer_load_dwordx4 v13, s[8:11], s51 offen lds
    s_add_u32 m0, s32, 81920
    s_add_u32 s51, s50, 1572864
    buffer_load_dwordx4 v13, s[8:11], s51 offen lds
    s_add_u32 m0, s32, 86016
    s_add_u32 s51, s50, 1703936
    buffer_load_dwordx4 v13, s[8:11], s51 offen lds
    s_add_u32 m0, s32, 90112
    s_add_u32 s51, s50, 1835008
    buffer_load_dwordx4 v13, s[8:11], s51 offen lds
    s_add_u32 m0, s32, 94208
    s_add_u32 s51, s50, 1966080
    buffer_load_dwordx4 v13, s[8:11], s51 offen lds
    s_add_u32 m0, s32, 98304
    s_add_u32 s51, s50, 1048576
    buffer_load_dwordx4 v13, s[20:23], s51 offen lds
    s_add_u32 m0, s32, 102400
    s_add_u32 s51, s50, 1179648
    buffer_load_dwordx4 v13, s[20:23], s51 offen lds
    s_add_u32 m0, s32, 106496
    s_add_u32 s51, s50, 1310720
    buffer_load_dwordx4 v13, s[20:23], s51 offen lds
    s_add_u32 m0, s32, 110592
    s_add_u32 s51, s50, 1441792
    buffer_load_dwordx4 v13, s[20:23], s51 offen lds
    s_add_u32 m0, s32, 114688
    s_add_u32 s51, s50, 1572864
    buffer_load_dwordx4 v13, s[20:23], s51 offen lds
    s_add_u32 m0, s32, 118784
    s_add_u32 s51, s50, 1703936
    buffer_load_dwordx4 v13, s[20:23], s51 offen lds
    s_add_u32 m0, s32, 122880
    s_add_u32 s51, s50, 1835008
    buffer_load_dwordx4 v13, s[20:23], s51 offen lds
    s_add_u32 m0, s32, 126976
    s_add_u32 s51, s50, 1966080
    buffer_load_dwordx4 v13, s[20:23], s51 offen lds
    s_add_u32 m0, s32, 131072
    s_add_u32 s51, s50, 2097152
    buffer_load_dwordx4 v13, s[8:11], s51 offen lds
    s_add_u32 m0, s32, 135168
    s_add_u32 s51, s50, 2228224
    buffer_load_dwordx4 v13, s[8:11], s51 offen lds
    s_add_u32 m0, s32, 139264
    s_add_u32 s51, s50, 2359296
    buffer_load_dwordx4 v13, s[8:11], s51 offen lds
    s_add_u32 m0, s32, 143360
    s_add_u32 s51, s50, 2490368
    buffer_load_dwordx4 v13, s[8:11], s51 offen lds
    s_add_u32 m0, s32, 147456
    s_add_u32 s51, s50, 2621440
    buffer_load_dwordx4 v13, s[8:11], s51 offen lds
    s_add_u32 m0, s32, 151552
    s_add_u32 s51, s50, 2752512
    buffer_load_dwordx4 v13, s[8:11], s51 offen lds
    s_add_u32 m0, s32, 155648
    s_add_u32 s51, s50, 2883584
    buffer_load_dwordx4 v13, s[8:11], s51 offen lds
    s_add_u32 m0, s32, 159744
    s_add_u32 s51, s50, 3014656
    buffer_load_dwordx4 v13, s[8:11], s51 offen lds
    v_bfe_u32 v11, v10, 2, 2
    v_bfe_u32 v88, v10, 4, 1
    v_lshlrev_b32 v88, 1, v88
    v_lshl_add_u32 v88, v11, 2, v88
    v_bfe_u32 v14, v10, 1, 1
    v_add_u32 v88, v88, v14
    s_lshl_b32 s52, s16, 2
    v_add_u32 v88, s52, v88
    v_and_b32 v88, 15, v88
    v_lshlrev_b32 v88, 4, v88
    v_lshl_add_u32 v88, v11, 8, v88
    v_lshrrev_b32 v11, 5, v10
    v_lshl_add_u32 v88, v11, 11, v88
    v_and_b32 v11, 1, v10
    v_lshl_add_u32 v2, v11, 3, v88
    v_add_u32 v15, 65536, v2
    v_add_u32 v14, 131072, v2
    v_bfe_u32 v11, v10, 4, 1
    v_lshrrev_b32 v12, 5, v10
    v_lshlrev_b32 v12, 8, v12
    v_and_b32 v5, 15, v10
    v_lshl_add_u32 v12, v5, 4, v12
    v_lshl_add_u32 v3, v11, 12, v12
    v_lshl_add_u32 v4, v11, 10, v12
    v_lshlrev_b32 v7, 12, v10
    s_lshl_b32 s36, s17, 19
    s_lshl_b32 s52, s16, 10
    s_add_u32 s39, s36, s52
    s_add_u32 s36, s39, 11534336
    s_add_u32 s39, s39, s52
    s_add_u32 s39, s39, 28311552
    s_lshl_b32 s37, s17, 7
    s_lshl_b32 s52, s16, 2
    s_add_u32 s37, s37, s52
    s_add_u32 s37, s37, 6291456
    s_waitcnt vmcnt(32)
    s_barrier
    ds_read_b64_tr_b16 a[0:1], v2 offset:0
    ds_read_b64_tr_b16 a[2:3], v2 offset:1024
    ds_read_b64_tr_b16 a[4:5], v2 offset:4096
    ds_read_b64_tr_b16 a[6:7], v2 offset:5120
    ds_read_b64_tr_b16 a[8:9], v2 offset:8192
    ds_read_b64_tr_b16 a[10:11], v2 offset:9216
    ds_read_b64_tr_b16 a[12:13], v2 offset:12288
    ds_read_b64_tr_b16 a[14:15], v2 offset:13312
    ds_read_b64_tr_b16 a[16:17], v2 offset:16384
    ds_read_b64_tr_b16 a[18:19], v2 offset:17408
    ds_read_b64_tr_b16 a[20:21], v2 offset:20480
    ds_read_b64_tr_b16 a[22:23], v2 offset:21504
    ds_read_b64_tr_b16 a[24:25], v2 offset:24576
    ds_read_b64_tr_b16 a[26:27], v2 offset:25600
    ds_read_b64_tr_b16 a[28:29], v2 offset:28672
    ds_read_b64_tr_b16 a[30:31], v2 offset:29696
    s_waitcnt lgkmcnt(0)
    s_waitcnt vmcnt(24)
    s_barrier
    s_add_u32 m0, s32, 0
    s_add_u32 s51, s50, 2097152
    buffer_load_dwordx4 v13, s[20:23], s51 offen lds
    s_add_u32 m0, s32, 4096
    s_add_u32 s51, s50, 2228224
    buffer_load_dwordx4 v13, s[20:23], s51 offen lds
    s_add_u32 m0, s32, 8192
    s_add_u32 s51, s50, 2359296
    buffer_load_dwordx4 v13, s[20:23], s51 offen lds
    s_add_u32 m0, s32, 12288
    s_add_u32 s51, s50, 2490368
    buffer_load_dwordx4 v13, s[20:23], s51 offen lds
    s_add_u32 m0, s32, 16384
    s_add_u32 s51, s50, 2621440
    buffer_load_dwordx4 v13, s[20:23], s51 offen lds
    s_add_u32 m0, s32, 20480
    s_add_u32 s51, s50, 2752512
    buffer_load_dwordx4 v13, s[20:23], s51 offen lds
    s_add_u32 m0, s32, 24576
    s_add_u32 s51, s50, 2883584
    buffer_load_dwordx4 v13, s[20:23], s51 offen lds
    s_add_u32 m0, s32, 28672
    s_add_u32 s51, s50, 3014656
    buffer_load_dwordx4 v13, s[20:23], s51 offen lds
    ds_read_b64_tr_b16 a[160:161], v2 offset:32768
    ds_read_b64_tr_b16 a[162:163], v2 offset:33792
    ds_read_b64_tr_b16 a[164:165], v2 offset:36864
    ds_read_b64_tr_b16 a[166:167], v2 offset:37888
    ds_read_b64_tr_b16 a[168:169], v2 offset:40960
    ds_read_b64_tr_b16 a[170:171], v2 offset:41984
    ds_read_b64_tr_b16 a[172:173], v2 offset:45056
    ds_read_b64_tr_b16 a[174:175], v2 offset:46080
    ds_read_b64_tr_b16 a[176:177], v2 offset:49152
    ds_read_b64_tr_b16 a[178:179], v2 offset:50176
    ds_read_b64_tr_b16 a[180:181], v2 offset:53248
    ds_read_b64_tr_b16 a[182:183], v2 offset:54272
    ds_read_b64_tr_b16 a[184:185], v2 offset:57344
    ds_read_b64_tr_b16 a[186:187], v2 offset:58368
    ds_read_b64_tr_b16 a[188:189], v2 offset:61440
    ds_read_b64_tr_b16 a[190:191], v2 offset:62464
    s_waitcnt lgkmcnt(0)
    s_waitcnt vmcnt(24)
    s_barrier
    s_add_u32 m0, s32, 32768
    s_add_u32 s51, s50, 3145728
    buffer_load_dwordx4 v13, s[8:11], s51 offen lds
    s_add_u32 m0, s32, 36864
    s_add_u32 s51, s50, 3276800
    buffer_load_dwordx4 v13, s[8:11], s51 offen lds
    s_add_u32 m0, s32, 40960
    s_add_u32 s51, s50, 3407872
    buffer_load_dwordx4 v13, s[8:11], s51 offen lds
    s_add_u32 m0, s32, 45056
    s_add_u32 s51, s50, 3538944
    buffer_load_dwordx4 v13, s[8:11], s51 offen lds
    s_add_u32 m0, s32, 49152
    s_add_u32 s51, s50, 3670016
    buffer_load_dwordx4 v13, s[8:11], s51 offen lds
    s_add_u32 m0, s32, 53248
    s_add_u32 s51, s50, 3801088
    buffer_load_dwordx4 v13, s[8:11], s51 offen lds
    s_add_u32 m0, s32, 57344
    s_add_u32 s51, s50, 3932160
    buffer_load_dwordx4 v13, s[8:11], s51 offen lds
    s_add_u32 m0, s32, 61440
    s_add_u32 s51, s50, 4063232
    buffer_load_dwordx4 v13, s[8:11], s51 offen lds
    ds_read_b64_tr_b16 a[32:33], v15 offset:0
    ds_read_b64_tr_b16 a[34:35], v15 offset:1024
    ds_read_b64_tr_b16 a[36:37], v15 offset:4096
    ds_read_b64_tr_b16 a[38:39], v15 offset:5120
    ds_read_b64_tr_b16 a[40:41], v15 offset:8192
    ds_read_b64_tr_b16 a[42:43], v15 offset:9216
    ds_read_b64_tr_b16 a[44:45], v15 offset:12288
    ds_read_b64_tr_b16 a[46:47], v15 offset:13312
    ds_read_b64_tr_b16 a[48:49], v15 offset:16384
    ds_read_b64_tr_b16 a[50:51], v15 offset:17408
    ds_read_b64_tr_b16 a[52:53], v15 offset:20480
    ds_read_b64_tr_b16 a[54:55], v15 offset:21504
    ds_read_b64_tr_b16 a[56:57], v15 offset:24576
    ds_read_b64_tr_b16 a[58:59], v15 offset:25600
    ds_read_b64_tr_b16 a[60:61], v15 offset:28672
    ds_read_b64_tr_b16 a[62:63], v15 offset:29696
    s_waitcnt lgkmcnt(0)
    s_waitcnt vmcnt(24)
    s_barrier
    s_add_u32 m0, s32, 65536
    s_add_u32 s51, s50, 3145728
    buffer_load_dwordx4 v13, s[20:23], s51 offen lds
    s_add_u32 m0, s32, 69632
    s_add_u32 s51, s50, 3276800
    buffer_load_dwordx4 v13, s[20:23], s51 offen lds
    s_add_u32 m0, s32, 73728
    s_add_u32 s51, s50, 3407872
    buffer_load_dwordx4 v13, s[20:23], s51 offen lds
    s_add_u32 m0, s32, 77824
    s_add_u32 s51, s50, 3538944
    buffer_load_dwordx4 v13, s[20:23], s51 offen lds
    s_add_u32 m0, s32, 81920
    s_add_u32 s51, s50, 3670016
    buffer_load_dwordx4 v13, s[20:23], s51 offen lds
    s_add_u32 m0, s32, 86016
    s_add_u32 s51, s50, 3801088
    buffer_load_dwordx4 v13, s[20:23], s51 offen lds
    s_add_u32 m0, s32, 90112
    s_add_u32 s51, s50, 3932160
    buffer_load_dwordx4 v13, s[20:23], s51 offen lds
    s_add_u32 m0, s32, 94208
    s_add_u32 s51, s50, 4063232
    buffer_load_dwordx4 v13, s[20:23], s51 offen lds
    ds_read_b64_tr_b16 a[192:193], v15 offset:32768
    ds_read_b64_tr_b16 a[194:195], v15 offset:33792
    ds_read_b64_tr_b16 a[196:197], v15 offset:36864
    ds_read_b64_tr_b16 a[198:199], v15 offset:37888
    ds_read_b64_tr_b16 a[200:201], v15 offset:40960
    ds_read_b64_tr_b16 a[202:203], v15 offset:41984
    ds_read_b64_tr_b16 a[204:205], v15 offset:45056
    ds_read_b64_tr_b16 a[206:207], v15 offset:46080
    ds_read_b64_tr_b16 a[208:209], v15 offset:49152
    ds_read_b64_tr_b16 a[210:211], v15 offset:50176
    ds_read_b64_tr_b16 a[212:213], v15 offset:53248
    ds_read_b64_tr_b16 a[214:215], v15 offset:54272
    ds_read_b64_tr_b16 a[216:217], v15 offset:57344
    ds_read_b64_tr_b16 a[218:219], v15 offset:58368
    ds_read_b64_tr_b16 a[220:221], v15 offset:61440
    ds_read_b64_tr_b16 a[222:223], v15 offset:62464
    s_waitcnt lgkmcnt(0)
    s_waitcnt vmcnt(24)
    s_barrier
    s_add_u32 m0, s32, 98304
    s_add_u32 s51, s50, 4194304
    buffer_load_dwordx4 v13, s[8:11], s51 offen lds
    s_add_u32 m0, s32, 102400
    s_add_u32 s51, s50, 4325376
    buffer_load_dwordx4 v13, s[8:11], s51 offen lds
    s_add_u32 m0, s32, 106496
    s_add_u32 s51, s50, 4456448
    buffer_load_dwordx4 v13, s[8:11], s51 offen lds
    s_add_u32 m0, s32, 110592
    s_add_u32 s51, s50, 4587520
    buffer_load_dwordx4 v13, s[8:11], s51 offen lds
    s_add_u32 m0, s32, 114688
    s_add_u32 s51, s50, 4718592
    buffer_load_dwordx4 v13, s[8:11], s51 offen lds
    s_add_u32 m0, s32, 118784
    s_add_u32 s51, s50, 4849664
    buffer_load_dwordx4 v13, s[8:11], s51 offen lds
    s_add_u32 m0, s32, 122880
    s_add_u32 s51, s50, 4980736
    buffer_load_dwordx4 v13, s[8:11], s51 offen lds
    s_add_u32 m0, s32, 126976
    s_add_u32 s51, s50, 5111808
    buffer_load_dwordx4 v13, s[8:11], s51 offen lds
    ds_read_b64_tr_b16 a[64:65], v14 offset:0
    ds_read_b64_tr_b16 a[66:67], v14 offset:1024
    ds_read_b64_tr_b16 a[68:69], v14 offset:4096
    ds_read_b64_tr_b16 a[70:71], v14 offset:5120
    ds_read_b64_tr_b16 a[72:73], v14 offset:8192
    ds_read_b64_tr_b16 a[74:75], v14 offset:9216
    ds_read_b64_tr_b16 a[76:77], v14 offset:12288
    ds_read_b64_tr_b16 a[78:79], v14 offset:13312
    ds_read_b64_tr_b16 a[80:81], v14 offset:16384
    ds_read_b64_tr_b16 a[82:83], v14 offset:17408
    ds_read_b64_tr_b16 a[84:85], v14 offset:20480
    ds_read_b64_tr_b16 a[86:87], v14 offset:21504
    ds_read_b64_tr_b16 a[88:89], v14 offset:24576
    ds_read_b64_tr_b16 a[90:91], v14 offset:25600
    ds_read_b64_tr_b16 a[92:93], v14 offset:28672
    ds_read_b64_tr_b16 a[94:95], v14 offset:29696
    s_waitcnt lgkmcnt(0)
    s_waitcnt vmcnt(24)
    s_barrier
    s_add_u32 m0, s32, 131072
    s_add_u32 s51, s50, 4194304
    buffer_load_dwordx4 v13, s[20:23], s51 offen lds
    s_add_u32 m0, s32, 135168
    s_add_u32 s51, s50, 4325376
    buffer_load_dwordx4 v13, s[20:23], s51 offen lds
    s_add_u32 m0, s32, 139264
    s_add_u32 s51, s50, 4456448
    buffer_load_dwordx4 v13, s[20:23], s51 offen lds
    s_add_u32 m0, s32, 143360
    s_add_u32 s51, s50, 4587520
    buffer_load_dwordx4 v13, s[20:23], s51 offen lds
    s_add_u32 m0, s32, 147456
    s_add_u32 s51, s50, 4718592
    buffer_load_dwordx4 v13, s[20:23], s51 offen lds
    s_add_u32 m0, s32, 151552
    s_add_u32 s51, s50, 4849664
    buffer_load_dwordx4 v13, s[20:23], s51 offen lds
    s_add_u32 m0, s32, 155648
    s_add_u32 s51, s50, 4980736
    buffer_load_dwordx4 v13, s[20:23], s51 offen lds
    s_add_u32 m0, s32, 159744
    s_add_u32 s51, s50, 5111808
    buffer_load_dwordx4 v13, s[20:23], s51 offen lds
    ds_read_b64_tr_b16 a[224:225], v2 offset:0
    ds_read_b64_tr_b16 a[226:227], v2 offset:1024
    ds_read_b64_tr_b16 a[228:229], v2 offset:4096
    ds_read_b64_tr_b16 a[230:231], v2 offset:5120
    ds_read_b64_tr_b16 a[232:233], v2 offset:8192
    ds_read_b64_tr_b16 a[234:235], v2 offset:9216
    ds_read_b64_tr_b16 a[236:237], v2 offset:12288
    ds_read_b64_tr_b16 a[238:239], v2 offset:13312
    ds_read_b64_tr_b16 a[240:241], v2 offset:16384
    ds_read_b64_tr_b16 a[242:243], v2 offset:17408
    ds_read_b64_tr_b16 a[244:245], v2 offset:20480
    ds_read_b64_tr_b16 a[246:247], v2 offset:21504
    ds_read_b64_tr_b16 a[248:249], v2 offset:24576
    ds_read_b64_tr_b16 a[250:251], v2 offset:25600
    ds_read_b64_tr_b16 a[252:253], v2 offset:28672
    ds_read_b64_tr_b16 a[254:255], v2 offset:29696
    s_waitcnt lgkmcnt(0)
    s_waitcnt vmcnt(24)
    s_barrier
    ds_read_b64_tr_b16 a[96:97], v2 offset:32768
    ds_read_b64_tr_b16 a[98:99], v2 offset:33792
    ds_read_b64_tr_b16 a[100:101], v2 offset:36864
    ds_read_b64_tr_b16 a[102:103], v2 offset:37888
    ds_read_b64_tr_b16 a[104:105], v2 offset:40960
    ds_read_b64_tr_b16 a[106:107], v2 offset:41984
    ds_read_b64_tr_b16 a[108:109], v2 offset:45056
    ds_read_b64_tr_b16 a[110:111], v2 offset:46080
    ds_read_b64_tr_b16 a[112:113], v2 offset:49152
    ds_read_b64_tr_b16 a[114:115], v2 offset:50176
    ds_read_b64_tr_b16 a[116:117], v2 offset:53248
    ds_read_b64_tr_b16 a[118:119], v2 offset:54272
    ds_read_b64_tr_b16 a[120:121], v2 offset:57344
    ds_read_b64_tr_b16 a[122:123], v2 offset:58368
    ds_read_b64_tr_b16 a[124:125], v2 offset:61440
    ds_read_b64_tr_b16 a[126:127], v2 offset:62464
    s_waitcnt lgkmcnt(0)
    s_waitcnt vmcnt(16)
    s_barrier
    ds_read_b64_tr_b16 v[192:193], v15 offset:0
    ds_read_b64_tr_b16 v[194:195], v15 offset:1024
    ds_read_b64_tr_b16 v[196:197], v15 offset:4096
    ds_read_b64_tr_b16 v[198:199], v15 offset:5120
    ds_read_b64_tr_b16 v[200:201], v15 offset:8192
    ds_read_b64_tr_b16 v[202:203], v15 offset:9216
    ds_read_b64_tr_b16 v[204:205], v15 offset:12288
    ds_read_b64_tr_b16 v[206:207], v15 offset:13312
    ds_read_b64_tr_b16 v[208:209], v15 offset:16384
    ds_read_b64_tr_b16 v[210:211], v15 offset:17408
    ds_read_b64_tr_b16 v[212:213], v15 offset:20480
    ds_read_b64_tr_b16 v[214:215], v15 offset:21504
    ds_read_b64_tr_b16 v[216:217], v15 offset:24576
    ds_read_b64_tr_b16 v[218:219], v15 offset:25600
    ds_read_b64_tr_b16 v[220:221], v15 offset:28672
    ds_read_b64_tr_b16 v[222:223], v15 offset:29696
    s_waitcnt lgkmcnt(0)
    s_waitcnt vmcnt(8)
    s_barrier
    ds_read_b64_tr_b16 a[128:129], v15 offset:32768
    ds_read_b64_tr_b16 a[130:131], v15 offset:33792
    ds_read_b64_tr_b16 a[132:133], v15 offset:36864
    ds_read_b64_tr_b16 a[134:135], v15 offset:37888
    ds_read_b64_tr_b16 a[136:137], v15 offset:40960
    ds_read_b64_tr_b16 a[138:139], v15 offset:41984
    ds_read_b64_tr_b16 a[140:141], v15 offset:45056
    ds_read_b64_tr_b16 a[142:143], v15 offset:46080
    ds_read_b64_tr_b16 a[144:145], v15 offset:49152
    ds_read_b64_tr_b16 a[146:147], v15 offset:50176
    ds_read_b64_tr_b16 a[148:149], v15 offset:53248
    ds_read_b64_tr_b16 a[150:151], v15 offset:54272
    ds_read_b64_tr_b16 a[152:153], v15 offset:57344
    ds_read_b64_tr_b16 a[154:155], v15 offset:58368
    ds_read_b64_tr_b16 a[156:157], v15 offset:61440
    ds_read_b64_tr_b16 a[158:159], v15 offset:62464
    s_waitcnt lgkmcnt(0)
    s_waitcnt vmcnt(0)
    s_barrier
    ds_read_b64_tr_b16 v[224:225], v14 offset:0
    ds_read_b64_tr_b16 v[226:227], v14 offset:1024
    ds_read_b64_tr_b16 v[228:229], v14 offset:4096
    ds_read_b64_tr_b16 v[230:231], v14 offset:5120
    ds_read_b64_tr_b16 v[232:233], v14 offset:8192
    ds_read_b64_tr_b16 v[234:235], v14 offset:9216
    ds_read_b64_tr_b16 v[236:237], v14 offset:12288
    ds_read_b64_tr_b16 v[238:239], v14 offset:13312
    ds_read_b64_tr_b16 v[240:241], v14 offset:16384
    ds_read_b64_tr_b16 v[242:243], v14 offset:17408
    ds_read_b64_tr_b16 v[244:245], v14 offset:20480
    ds_read_b64_tr_b16 v[246:247], v14 offset:21504
    ds_read_b64_tr_b16 v[248:249], v14 offset:24576
    ds_read_b64_tr_b16 v[250:251], v14 offset:25600
    ds_read_b64_tr_b16 v[252:253], v14 offset:28672
    ds_read_b64_tr_b16 v[254:255], v14 offset:29696
    s_waitcnt lgkmcnt(0)
    v_mov_b32 v5, 0
    s_cmp_lg_u32 s16, 0
    s_cbranch_scc1 L_ww_31
    s_mov_b32 s62, 0
L_pw_32:
    buffer_load_dword v6, v5, s[12:15], 0 offen sc1
    s_waitcnt vmcnt(0)
    v_cmp_gt_u32 vcc, 64, v6
    s_cbranch_vccz L_pok_33
    s_sleep 12
    s_add_u32 s62, s62, 1
    s_cmp_lt_u32 s62, 2000000
    s_cbranch_scc1 L_pw_32
    v_mov_b32 v1, 528
    v_mov_b32 v2, 192
    buffer_store_dword v1, v2, s[12:15], 0 offen sc1
    s_waitcnt vmcnt(0)
    s_endpgm
L_pok_33:
L_ww_31:
    s_barrier
    s_mul_i32 s34, s16, 10240
    s_add_u32 s34, s34, 8388608
    s_mul_i32 s38, s16, 10240
    s_mov_b32 s35, 0
    s_mov_b32 s33, 0
    s_add_u32 m0, s38, 0
    s_add_u32 s53, s34, 0
    buffer_load_dwordx4 v1, s[4:7], s53 offen offset:0 lds
    buffer_load_dwordx4 v1, s[4:7], s53 offen offset:1024 lds
    buffer_load_dwordx4 v1, s[4:7], s53 offen offset:2048 lds
    buffer_load_dwordx4 v1, s[4:7], s53 offen offset:3072 lds
    s_add_u32 m0, s38, 4096
    s_add_u32 s53, s34, 4096
    buffer_load_dwordx4 v1, s[4:7], s53 offen offset:0 lds
    buffer_load_dwordx4 v1, s[4:7], s53 offen offset:1024 lds
    buffer_load_dwordx4 v1, s[4:7], s53 offen offset:2048 lds
    buffer_load_dwordx4 v1, s[4:7], s53 offen offset:3072 lds
    s_add_u32 m0, s38, 8192
    s_add_u32 s53, s34, 8192
    buffer_load_dwordx4 v1, s[4:7], s53 offen offset:0 lds
    buffer_load_dwordx4 v1, s[4:7], s53 offen offset:1024 lds
    s_add_u32 s34, s34, 40960
    s_add_u32 s38, s38, 40960
    s_cmp_ge_u32 s38, 122880
    s_cselect_b32 s54, 122880, 0
    s_sub_u32 s38, s38, s54
    s_add_u32 m0, s38, 0
    s_add_u32 s53, s34, 0
    buffer_load_dwordx4 v1, s[4:7], s53 offen offset:0 lds
    buffer_load_dwordx4 v1, s[4:7], s53 offen offset:1024 lds
    buffer_load_dwordx4 v1, s[4:7], s53 offen offset:2048 lds
    buffer_load_dwordx4 v1, s[4:7], s53 offen offset:3072 lds
    s_add_u32 m0, s38, 4096
    s_add_u32 s53, s34, 4096
    buffer_load_dwordx4 v1, s[4:7], s53 offen offset:0 lds
    buffer_load_dwordx4 v1, s[4:7], s53 offen offset:1024 lds
    buffer_load_dwordx4 v1, s[4:7], s53 offen offset:2048 lds
    buffer_load_dwordx4 v1, s[4:7], s53 offen offset:3072 lds
    s_add_u32 m0, s38, 8192
    s_add_u32 s53, s34, 8192
    buffer_load_dwordx4 v1, s[4:7], s53 offen offset:0 lds
    buffer_load_dwordx4 v1, s[4:7], s53 offen offset:1024 lds
    s_add_u32 s34, s34, 40960
    s_add_u32 s38, s38, 40960
    s_cmp_ge_u32 s38, 122880
    s_cselect_b32 s54, 122880, 0
    s_sub_u32 s38, s38, s54
    s_waitcnt vmcnt(10)
L_KV_loop:
    s_barrier
    v_add_u32 v5, s35, v1
    ds_read_b128 v[48:51], v5 offset:0
    ds_read_b128 v[52:55], v5 offset:1024
    ds_read_b128 v[56:59], v5 offset:2048
    ds_read_b128 v[60:63], v5 offset:3072
    ds_read_b128 v[64:67], v5 offset:4096
    s_waitcnt lgkmcnt(4)
    v_mfma_f32_32x32x16_bf16 v[16:31], a[0:3], v[48:51], 0
    ds_read_b128 v[68:71], v5 offset:5120
    v_mfma_f32_32x32x16_bf16 v[32:47], v[48:51], a[160:163], 0
    s_add_u32 m0, s38, 0
    s_add_u32 s53, s34, 0
    buffer_load_dwordx4 v1, s[4:7], s53 offen offset:0 lds
    s_waitcnt lgkmcnt(4)
    v_mfma_f32_32x32x16_bf16 v[16:31], a[4:7], v[52:55], v[16:31]
    ds_read_b128 v[48:51], v5 offset:6144
    v_mfma_f32_32x32x16_bf16 v[32:47], v[52:55], a[164:167], v[32:47]
    buffer_load_dwordx4 v1, s[4:7], s53 offen offset:1024 lds
    s_waitcnt lgkmcnt(4)
    v_mfma_f32_32x32x16_bf16 v[16:31], a[8:11], v[56:59], v[16:31]
    ds_read_b128 v[52:55], v5 offset:7168
    v_mfma_f32_32x32x16_bf16 v[32:47], v[56:59], a[168:171], v[32:47]
    buffer_load_dwordx4 v1, s[4:7], s53 offen offset:2048 lds
    s_waitcnt lgkmcnt(4)
    v_mfma_f32_32x32x16_bf16 v[16:31], a[12:15], v[60:63], v[16:31]
    ds_read_b128 v[56:59], v5 offset:8192
    v_mfma_f32_32x32x16_bf16 v[32:47], v[60:63], a[172:175], v[32:47]
    buffer_load_dwordx4 v1, s[4:7], s53 offen offset:3072 lds
    s_waitcnt lgkmcnt(4)
    v_mfma_f32_32x32x16_bf16 v[16:31], a[16:19], v[64:67], v[16:31]
    ds_read_b128 v[60:63], v5 offset:9216
    v_mfma_f32_32x32x16_bf16 v[32:47], v[64:67], a[176:179], v[32:47]
    s_add_u32 m0, s38, 4096
    s_add_u32 s53, s34, 4096
    buffer_load_dwordx4 v1, s[4:7], s53 offen offset:0 lds
    s_waitcnt lgkmcnt(4)
    v_mfma_f32_32x32x16_bf16 v[16:31], a[20:23], v[68:71], v[16:31]
    ds_read_b128 v[64:67], v5 offset:10240
    v_mfma_f32_32x32x16_bf16 v[32:47], v[68:71], a[180:183], v[32:47]
    buffer_load_dwordx4 v1, s[4:7], s53 offen offset:1024 lds
    s_waitcnt lgkmcnt(4)
    v_mfma_f32_32x32x16_bf16 v[16:31], a[24:27], v[48:51], v[16:31]
    ds_read_b128 v[68:71], v5 offset:11264
    v_mfma_f32_32x32x16_bf16 v[32:47], v[48:51], a[184:187], v[32:47]
    buffer_load_dwordx4 v1, s[4:7], s53 offen offset:2048 lds
    s_waitcnt lgkmcnt(4)
    v_mfma_f32_32x32x16_bf16 v[16:31], a[28:31], v[52:55], v[16:31]
    ds_read_b128 v[48:51], v5 offset:12288
    v_mfma_f32_32x32x16_bf16 v[32:47], v[52:55], a[188:191], v[32:47]
    buffer_load_dwordx4 v1, s[4:7], s53 offen offset:3072 lds
    s_waitcnt lgkmcnt(4)
    v_mfma_f32_32x32x16_bf16 v[16:31], a[32:35], v[56:59], v[16:31]
    ds_read_b128 v[52:55], v5 offset:13312
    v_mfma_f32_32x32x16_bf16 v[32:47], v[56:59], a[192:195], v[32:47]
    s_add_u32 m0, s38, 8192
    s_add_u32 s53, s34, 8192
    buffer_load_dwordx4 v1, s[4:7], s53 offen offset:0 lds
    s_waitcnt lgkmcnt(4)
    v_mfma_f32_32x32x16_bf16 v[16:31], a[36:39], v[60:63], v[16:31]
    ds_read_b128 v[56:59], v5 offset:14336
    v_mfma_f32_32x32x16_bf16 v[32:47], v[60:63], a[196:199], v[32:47]
    buffer_load_dwordx4 v1, s[4:7], s53 offen offset:1024 lds
    s_waitcnt lgkmcnt(4)
    v_mfma_f32_32x32x16_bf16 v[16:31], a[40:43], v[64:67], v[16:31]
    ds_read_b128 v[60:63], v5 offset:15360
    v_mfma_f32_32x32x16_bf16 v[32:47], v[64:67], a[200:203], v[32:47]
    s_add_u32 s34, s34, 40960
    s_add_u32 s38, s38, 40960
    s_cmp_ge_u32 s38, 122880
    s_cselect_b32 s54, 122880, 0
    s_sub_u32 s38, s38, s54
    s_add_u32 s35, s35, 40960
    s_cmp_ge_u32 s35, 122880
    s_cselect_b32 s54, 122880, 0
    s_sub_u32 s35, s35, s54
    s_waitcnt lgkmcnt(4)
    v_mfma_f32_32x32x16_bf16 v[16:31], a[44:47], v[68:71], v[16:31]
    ds_read_b128 v[64:67], v5 offset:16384
    v_mfma_f32_32x32x16_bf16 v[32:47], v[68:71], a[204:207], v[32:47]
    s_waitcnt lgkmcnt(4)
    v_mfma_f32_32x32x16_bf16 v[16:31], a[48:51], v[48:51], v[16:31]
    ds_read_b128 v[68:71], v5 offset:17408
    v_mfma_f32_32x32x16_bf16 v[32:47], v[48:51], a[208:211], v[32:47]
    s_waitcnt lgkmcnt(4)
    v_mfma_f32_32x32x16_bf16 v[16:31], a[52:55], v[52:55], v[16:31]
    ds_read_b128 v[48:51], v5 offset:18432
    v_mfma_f32_32x32x16_bf16 v[32:47], v[52:55], a[212:215], v[32:47]
    s_waitcnt lgkmcnt(4)
    v_mfma_f32_32x32x16_bf16 v[16:31], a[56:59], v[56:59], v[16:31]
    ds_read_b128 v[52:55], v5 offset:19456
    v_mfma_f32_32x32x16_bf16 v[32:47], v[56:59], a[216:219], v[32:47]
    s_waitcnt vmcnt(10)
    v_mov_b32 v6, s33
    s_mov_b64 exec, 3
    buffer_store_dword v6, v7, s[4:7], s37 offen sc1
    s_mov_b64 exec, -1
    s_waitcnt lgkmcnt(4)
    v_mfma_f32_32x32x16_bf16 v[16:31], a[60:63], v[60:63], v[16:31]
    ds_read_b128 v[56:59], v5 offset:20480
    v_mfma_f32_32x32x16_bf16 v[32:47], v[60:63], a[220:223], v[32:47]
    s_waitcnt lgkmcnt(4)
    v_mfma_f32_32x32x16_bf16 v[16:31], a[64:67], v[64:67], v[16:31]
    ds_read_b128 v[60:63], v5 offset:21504
    v_mfma_f32_32x32x16_bf16 v[32:47], v[64:67], a[224:227], v[32:47]
    s_waitcnt lgkmcnt(4)
    v_mfma_f32_32x32x16_bf16 v[16:31], a[68:71], v[68:71], v[16:31]
    ds_read_b128 v[64:67], v5 offset:22528
    v_mfma_f32_32x32x16_bf16 v[32:47], v[68:71], a[228:231], v[32:47]
    s_waitcnt lgkmcnt(4)
    v_mfma_f32_32x32x16_bf16 v[16:31], a[72:75], v[48:51], v[16:31]
    ds_read_b128 v[68:71], v5 offset:23552
    v_mfma_f32_32x32x16_bf16 v[32:47], v[48:51], a[232:235], v[32:47]
    s_waitcnt lgkmcnt(4)
    v_mfma_f32_32x32x16_bf16 v[16:31], a[76:79], v[52:55], v[16:31]
    ds_read_b128 v[48:51], v5 offset:24576
    v_mfma_f32_32x32x16_bf16 v[32:47], v[52:55], a[236:239], v[32:47]
    s_waitcnt lgkmcnt(4)
    v_mfma_f32_32x32x16_bf16 v[16:31], a[80:83], v[56:59], v[16:31]
    ds_read_b128 v[52:55], v5 offset:25600
    v_mfma_f32_32x32x16_bf16 v[32:47], v[56:59], a[240:243], v[32:47]
    s_waitcnt lgkmcnt(4)
    v_mfma_f32_32x32x16_bf16 v[16:31], a[84:87], v[60:63], v[16:31]
    ds_read_b128 v[56:59], v5 offset:26624
    v_mfma_f32_32x32x16_bf16 v[32:47], v[60:63], a[244:247], v[32:47]
    s_waitcnt lgkmcnt(4)
    v_mfma_f32_32x32x16_bf16 v[16:31], a[88:91], v[64:67], v[16:31]
    ds_read_b128 v[60:63], v5 offset:27648
    v_mfma_f32_32x32x16_bf16 v[32:47], v[64:67], a[248:251], v[32:47]
    s_waitcnt lgkmcnt(4)
    v_mfma_f32_32x32x16_bf16 v[16:31], a[92:95], v[68:71], v[16:31]
    ds_read_b128 v[64:67], v5 offset:28672
    v_mfma_f32_32x32x16_bf16 v[32:47], v[68:71], a[252:255], v[32:47]
    s_waitcnt lgkmcnt(4)
    v_mfma_f32_32x32x16_bf16 v[16:31], a[96:99], v[48:51], v[16:31]
    ds_read_b128 v[68:71], v5 offset:29696
    v_mfma_f32_32x32x16_bf16 v[32:47], v[48:51], v[192:195], v[32:47]
    s_waitcnt lgkmcnt(4)
    v_mfma_f32_32x32x16_bf16 v[16:31], a[100:103], v[52:55], v[16:31]
    ds_read_b128 v[48:51], v5 offset:30720
    v_mfma_f32_32x32x16_bf16 v[32:47], v[52:55], v[196:199], v[32:47]
    s_waitcnt lgkmcnt(4)
    v_mfma_f32_32x32x16_bf16 v[16:31], a[104:107], v[56:59], v[16:31]
    ds_read_b128 v[52:55], v5 offset:31744
    v_mfma_f32_32x32x16_bf16 v[32:47], v[56:59], v[200:203], v[32:47]
    s_waitcnt lgkmcnt(4)
    v_mfma_f32_32x32x16_bf16 v[16:31], a[108:111], v[60:63], v[16:31]
    ds_read_b128 v[56:59], v5 offset:32768
    v_mfma_f32_32x32x16_bf16 v[32:47], v[60:63], v[204:207], v[32:47]
    s_waitcnt lgkmcnt(4)
    v_mfma_f32_32x32x16_bf16 v[16:31], a[112:115], v[64:67], v[16:31]
    ds_read_b128 v[60:63], v5 offset:33792
    v_mfma_f32_32x32x16_bf16 v[32:47], v[64:67], v[208:211], v[32:47]
    s_waitcnt lgkmcnt(4)
    v_mfma_f32_32x32x16_bf16 v[16:31], a[116:119], v[68:71], v[16:31]
    ds_read_b128 v[64:67], v5 offset:34816
    v_mfma_f32_32x32x16_bf16 v[32:47], v[68:71], v[212:215], v[32:47]
    s_waitcnt lgkmcnt(4)
    v_mfma_f32_32x32x16_bf16 v[16:31], a[120:123], v[48:51], v[16:31]
    ds_read_b128 v[68:71], v5 offset:35840
    v_mfma_f32_32x32x16_bf16 v[32:47], v[48:51], v[216:219], v[32:47]
    s_waitcnt lgkmcnt(4)
    v_mfma_f32_32x32x16_bf16 v[16:31], a[124:127], v[52:55], v[16:31]
    ds_read_b128 v[48:51], v5 offset:36864
    v_mfma_f32_32x32x16_bf16 v[32:47], v[52:55], v[220:223], v[32:47]
    s_waitcnt lgkmcnt(4)
    v_mfma_f32_32x32x16_bf16 v[16:31], a[128:131], v[56:59], v[16:31]
    ds_read_b128 v[52:55], v5 offset:37888
    v_mfma_f32_32x32x16_bf16 v[32:47], v[56:59], v[224:227], v[32:47]
    s_waitcnt lgkmcnt(4)
    v_mfma_f32_32x32x16_bf16 v[16:31], a[132:135], v[60:63], v[16:31]
    ds_read_b128 v[56:59], v5 offset:38912
    v_mfma_f32_32x32x16_bf16 v[32:47], v[60:63], v[228:231], v[32:47]
    s_waitcnt lgkmcnt(4)
    v_mfma_f32_32x32x16_bf16 v[16:31], a[136:139], v[64:67], v[16:31]
    ds_read_b128 v[60:63], v5 offset:39936
    v_mfma_f32_32x32x16_bf16 v[32:47], v[64:67], v[232:235], v[32:47]
    s_waitcnt lgkmcnt(4)
    v_mfma_f32_32x32x16_bf16 v[16:31], a[140:143], v[68:71], v[16:31]
    v_mfma_f32_32x32x16_bf16 v[32:47], v[68:71], v[236:239], v[32:47]
    s_waitcnt lgkmcnt(3)
    v_mfma_f32_32x32x16_bf16 v[16:31], a[144:147], v[48:51], v[16:31]
    v_mfma_f32_32x32x16_bf16 v[32:47], v[48:51], v[240:243], v[32:47]
    s_waitcnt lgkmcnt(2)
    v_mfma_f32_32x32x16_bf16 v[16:31], a[148:151], v[52:55], v[16:31]
    v_mfma_f32_32x32x16_bf16 v[32:47], v[52:55], v[244:247], v[32:47]
    s_waitcnt lgkmcnt(1)
    v_mfma_f32_32x32x16_bf16 v[16:31], a[152:155], v[56:59], v[16:31]
    v_mfma_f32_32x32x16_bf16 v[32:47], v[56:59], v[248:251], v[32:47]
    s_waitcnt lgkmcnt(0)
    v_mfma_f32_32x32x16_bf16 v[16:31], a[156:159], v[60:63], v[16:31]
    v_mfma_f32_32x32x16_bf16 v[32:47], v[60:63], v[252:255], v[32:47]
    s_nop 10
    v_cvt_pk_bf16_f32 v72, v16, v17
    v_cvt_pk_bf16_f32 v73, v18, v19
    v_cvt_pk_bf16_f32 v74, v20, v21
    v_cvt_pk_bf16_f32 v75, v22, v23
    v_cvt_pk_bf16_f32 v76, v24, v25
    v_cvt_pk_bf16_f32 v77, v26, v27
    v_cvt_pk_bf16_f32 v78, v28, v29
    v_cvt_pk_bf16_f32 v79, v30, v31
    buffer_store_dwordx4 v[72:75], v3, s[4:7], s36 offen offset:0 sc1
    buffer_store_dwordx4 v[76:79], v3, s[4:7], s36 offen offset:512 sc1
    v_cvt_pk_bf16_f32 v80, v32, v33
    v_cvt_pk_bf16_f32 v81, v34, v35
    v_cvt_pk_bf16_f32 v82, v40, v41
    v_cvt_pk_bf16_f32 v83, v42, v43
    v_cvt_pk_bf16_f32 v84, v36, v37
    v_cvt_pk_bf16_f32 v85, v38, v39
    v_cvt_pk_bf16_f32 v86, v44, v45
    v_cvt_pk_bf16_f32 v87, v46, v47
    buffer_store_dwordx4 v[80:83], v4, s[4:7], s39 offen offset:0 sc1
    buffer_store_dwordx4 v[84:87], v4, s[4:7], s39 offen offset:512 sc1
    s_add_u32 s36, s36, 8192
    s_add_u32 s39, s39, 8192
    s_add_u32 s33, s33, 1
    s_cmp_lt_u32 s33, 64
    s_waitcnt vmcnt(15)
    s_cbranch_scc1 L_KV_loop
    s_waitcnt vmcnt(0)
    v_mov_b32 v6, 64
    s_mov_b64 exec, 3
    buffer_store_dword v6, v7, s[4:7], s37 offen sc1
    s_waitcnt vmcnt(0)
    s_endpgm
L_role_F:
    v_and_b32 v10, 63, v0
    v_lshlrev_b32 v1, 4, v10
    v_mov_b32 v5, 0
    s_cmp_lg_u32 s16, 0
    s_cbranch_scc1 L_ww_34
    s_mov_b32 s62, 0
L_pw_35:
    buffer_load_dword v6, v5, s[12:15], 0 offen sc1
    s_waitcnt vmcnt(0)
    v_cmp_gt_u32 vcc, 64, v6
    s_cbranch_vccz L_pok_36
    s_sleep 48
    s_add_u32 s62, s62, 1
    s_cmp_lt_u32 s62, 2000000
    s_cbranch_scc1 L_pw_35
    v_mov_b32 v1, 532
    v_mov_b32 v2, 192
    buffer_store_dword v1, v2, s[12:15], 0 offen sc1
    s_waitcnt vmcnt(0)
    s_endpgm
L_pok_36:
L_ww_34:
    s_barrier
    v_lshrrev_b32 v11, 4, v10
    v_lshlrev_b32 v12, 2, v11
    v_sub_u32 v12, v10, v12
    v_and_b32 v12, 15, v12
    s_lshl_b32 s50, s16, 2
    v_add_u32 v11, s50, v11
    s_lshl_b32 s32, s16, 10
    v_mul_u32_u24 v11, 3456, v11
    v_and_b32 v5, 7, v12
    v_lshl_add_u32 v11, v5, 4, v11
    s_lshl_b32 s50, s17, 8
    v_add_u32 v11, s50, v11
    v_cmp_gt_u32 vcc, 8, v12
    v_mov_b32 v12, s80
    v_mov_b32 v13, s81
    v_mov_b32 v14, s82
    v_mov_b32 v15, s83
    v_cndmask_b32 v12, v14, v12, vcc
    v_cndmask_b32 v13, v15, v13, vcc
    v_add_co_u32 v12, vcc, v12, v11
    s_nop 1
    v_addc_co_u32 v13, vcc, 0, v13, vcc
    s_cmp_lt_u32 s17, 13
    s_cselect_b32 s50, 128, 0
    v_add_co_u32 v8, vcc, s50, v12
    s_nop 1
    v_addc_co_u32 v9, vcc, 0, v13, vcc
    s_add_u32 m0, s32, 0
    s_nop 0
    global_load_lds_dwordx4 v[12:13], off
    v_add_co_u32 v12, vcc, 55296, v12
    s_nop 1
    v_addc_co_u32 v13, vcc, 0, v13, vcc
    s_add_u32 m0, s32, 4096
    s_nop 0
    global_load_lds_dwordx4 v[12:13], off
    v_add_co_u32 v12, vcc, 55296, v12
    s_nop 1
    v_addc_co_u32 v13, vcc, 0, v13, vcc
    s_add_u32 m0, s32, 8192
    s_nop 0
    global_load_lds_dwordx4 v[12:13], off
    v_add_co_u32 v12, vcc, 55296, v12
    s_nop 1
    v_addc_co_u32 v13, vcc, 0, v13, vcc
    s_add_u32 m0, s32, 12288
    s_nop 0
    global_load_lds_dwordx4 v[12:13], off
    v_add_co_u32 v12, vcc, 55296, v12
    s_nop 1
    v_addc_co_u32 v13, vcc, 0, v13, vcc
    s_add_u32 m0, s32, 16384
    s_nop 0
    global_load_lds_dwordx4 v[12:13], off
    v_add_co_u32 v12, vcc, 55296, v12
    s_nop 1
    v_addc_co_u32 v13, vcc, 0, v13, vcc
    s_add_u32 m0, s32, 20480
    s_nop 0
    global_load_lds_dwordx4 v[12:13], off
    v_add_co_u32 v12, vcc, 55296, v12
    s_nop 1
    v_addc_co_u32 v13, vcc, 0, v13, vcc
    s_add_u32 m0, s32, 24576
    s_nop 0
    global_load_lds_dwordx4 v[12:13], off
    v_add_co_u32 v12, vcc, 55296, v12
    s_nop 1
    v_addc_co_u32 v13, vcc, 0, v13, vcc
    s_add_u32 m0, s32, 28672
    s_nop 0
    global_load_lds_dwordx4 v[12:13], off
    v_add_co_u32 v12, vcc, 55296, v12
    s_nop 1
    v_addc_co_u32 v13, vcc, 0, v13, vcc
    s_add_u32 m0, s32, 32768
    s_nop 0
    global_load_lds_dwordx4 v[8:9], off
    v_add_co_u32 v8, vcc, 55296, v8
    s_nop 1
    v_addc_co_u32 v9, vcc, 0, v9, vcc
    s_add_u32 m0, s32, 36864
    s_nop 0
    global_load_lds_dwordx4 v[8:9], off
    v_add_co_u32 v8, vcc, 55296, v8
    s_nop 1
    v_addc_co_u32 v9, vcc, 0, v9, vcc
    s_add_u32 m0, s32, 40960
    s_nop 0
    global_load_lds_dwordx4 v[8:9], off
    v_add_co_u32 v8, vcc, 55296, v8
    s_nop 1
    v_addc_co_u32 v9, vcc, 0, v9, vcc
    s_add_u32 m0, s32, 45056
    s_nop 0
    global_load_lds_dwordx4 v[8:9], off
    v_add_co_u32 v8, vcc, 55296, v8
    s_nop 1
    v_addc_co_u32 v9, vcc, 0, v9, vcc
    s_add_u32 m0, s32, 49152
    s_nop 0
    global_load_lds_dwordx4 v[8:9], off
    v_add_co_u32 v8, vcc, 55296, v8
    s_nop 1
    v_addc_co_u32 v9, vcc, 0, v9, vcc
    s_add_u32 m0, s32, 53248
    s_nop 0
    global_load_lds_dwordx4 v[8:9], off
    v_add_co_u32 v8, vcc, 55296, v8
    s_nop 1
    v_addc_co_u32 v9, vcc, 0, v9, vcc
    s_add_u32 m0, s32, 57344
    s_nop 0
    global_load_lds_dwordx4 v[8:9], off
    v_add_co_u32 v8, vcc, 55296, v8
    s_nop 1
    v_addc_co_u32 v9, vcc, 0, v9, vcc
    s_add_u32 m0, s32, 61440
    s_nop 0
    global_load_lds_dwordx4 v[8:9], off
    v_add_co_u32 v8, vcc, 55296, v8
    s_nop 1
    v_addc_co_u32 v9, vcc, 0, v9, vcc
    s_add_u32 m0, s32, 65536
    s_nop 0
    global_load_lds_dwordx4 v[12:13], off
    v_add_co_u32 v12, vcc, 55296, v12
    s_nop 1
    v_addc_co_u32 v13, vcc, 0, v13, vcc
    s_add_u32 m0, s32, 69632
    s_nop 0
    global_load_lds_dwordx4 v[12:13], off
    v_add_co_u32 v12, vcc, 55296, v12
    s_nop 1
    v_addc_co_u32 v13, vcc, 0, v13, vcc
    s_add_u32 m0, s32, 73728
    s_nop 0
    global_load_lds_dwordx4 v[12:13], off
    v_add_co_u32 v12, vcc, 55296, v12
    s_nop 1
    v_addc_co_u32 v13, vcc, 0, v13, vcc
    s_add_u32 m0, s32, 77824
    s_nop 0
    global_load_lds_dwordx4 v[12:13], off
    v_add_co_u32 v12, vcc, 55296, v12
    s_nop 1
    v_addc_co_u32 v13, vcc, 0, v13, vcc
    s_add_u32 m0, s32, 81920
    s_nop 0
    global_load_lds_dwordx4 v[12:13], off
    v_add_co_u32 v12, vcc, 55296, v12
    s_nop 1
    v_addc_co_u32 v13, vcc, 0, v13, vcc
    s_add_u32 m0, s32, 86016
    s_nop 0
    global_load_lds_dwordx4 v[12:13], off
    v_add_co_u32 v12, vcc, 55296, v12
    s_nop 1
    v_addc_co_u32 v13, vcc, 0, v13, vcc
    s_add_u32 m0, s32, 90112
    s_nop 0
    global_load_lds_dwordx4 v[12:13], off
    v_add_co_u32 v12, vcc, 55296, v12
    s_nop 1
    v_addc_co_u32 v13, vcc, 0, v13, vcc
    s_add_u32 m0, s32, 94208
    s_nop 0
    global_load_lds_dwordx4 v[12:13], off
    v_add_co_u32 v12, vcc, 55296, v12
    s_nop 1
    v_addc_co_u32 v13, vcc, 0, v13, vcc
    s_add_u32 m0, s32, 98304
    s_nop 0
    global_load_lds_dwordx4 v[8:9], off
    v_add_co_u32 v8, vcc, 55296, v8
    s_nop 1
    v_addc_co_u32 v9, vcc, 0, v9, vcc
    s_add_u32 m0, s32, 102400
    s_nop 0
    global_load_lds_dwordx4 v[8:9], off
    v_add_co_u32 v8, vcc, 55296, v8
    s_nop 1
    v_addc_co_u32 v9, vcc, 0, v9, vcc
    s_add_u32 m0, s32, 106496
    s_nop 0
    global_load_lds_dwordx4 v[8:9], off
    v_add_co_u32 v8, vcc, 55296, v8
    s_nop 1
    v_addc_co_u32 v9, vcc, 0, v9, vcc
    s_add_u32 m0, s32, 110592
    s_nop 0
    global_load_lds_dwordx4 v[8:9], off
    v_add_co_u32 v8, vcc, 55296, v8
    s_nop 1
    v_addc_co_u32 v9, vcc, 0, v9, vcc
    s_add_u32 m0, s32, 114688
    s_nop 0
    global_load_lds_dwordx4 v[8:9], off
    v_add_co_u32 v8, vcc, 55296, v8
    s_nop 1
    v_addc_co_u32 v9, vcc, 0, v9, vcc
    s_add_u32 m0, s32, 118784
    s_nop 0
    global_load_lds_dwordx4 v[8:9], off
    v_add_co_u32 v8, vcc, 55296, v8
    s_nop 1
    v_addc_co_u32 v9, vcc, 0, v9, vcc
    s_add_u32 m0, s32, 122880
    s_nop 0
    global_load_lds_dwordx4 v[8:9], off
    v_add_co_u32 v8, vcc, 55296, v8
    s_nop 1
    v_addc_co_u32 v9, vcc, 0, v9, vcc
    s_add_u32 m0, s32, 126976
    s_nop 0
    global_load_lds_dwordx4 v[8:9], off
    v_add_co_u32 v8, vcc, 55296, v8
    s_nop 1
    v_addc_co_u32 v9, vcc, 0, v9, vcc
    s_add_u32 m0, s32, 131072
    s_nop 0
    global_load_lds_dwordx4 v[12:13], off
    v_add_co_u32 v12, vcc, 55296, v12
    s_nop 1
    v_addc_co_u32 v13, vcc, 0, v13, vcc
    s_add_u32 m0, s32, 135168
    s_nop 0
    global_load_lds_dwordx4 v[12:13], off
    v_add_co_u32 v12, vcc, 55296, v12
    s_nop 1
    v_addc_co_u32 v13, vcc, 0, v13, vcc
    s_add_u32 m0, s32, 139264
    s_nop 0
    global_load_lds_dwordx4 v[12:13], off
    v_add_co_u32 v12, vcc, 55296, v12
    s_nop 1
    v_addc_co_u32 v13, vcc, 0, v13, vcc
    s_add_u32 m0, s32, 143360
    s_nop 0
    global_load_lds_dwordx4 v[12:13], off
    v_add_co_u32 v12, vcc, 55296, v12
    s_nop 1
    v_addc_co_u32 v13, vcc, 0, v13, vcc
    s_add_u32 m0, s32, 147456
    s_nop 0
    global_load_lds_dwordx4 v[12:13], off
    v_add_co_u32 v12, vcc, 55296, v12
    s_nop 1
    v_addc_co_u32 v13, vcc, 0, v13, vcc
    s_add_u32 m0, s32, 151552
    s_nop 0
    global_load_lds_dwordx4 v[12:13], off
    v_add_co_u32 v12, vcc, 55296, v12
    s_nop 1
    v_addc_co_u32 v13, vcc, 0, v13, vcc
    s_add_u32 m0, s32, 155648
    s_nop 0
    global_load_lds_dwordx4 v[12:13], off
    v_add_co_u32 v12, vcc, 55296, v12
    s_nop 1
    v_addc_co_u32 v13, vcc, 0, v13, vcc
    s_add_u32 m0, s32, 159744
    s_nop 0
    global_load_lds_dwordx4 v[12:13], off
    v_add_co_u32 v12, vcc, 55296, v12
    s_nop 1
    v_addc_co_u32 v13, vcc, 0, v13, vcc
    v_bfe_u32 v11, v10, 2, 2
    v_bfe_u32 v88, v10, 4, 1
    v_lshlrev_b32 v88, 3, v88
    v_lshl_add_u32 v88, v11, 2, v88
    v_bfe_u32 v14, v10, 1, 1
    v_add_u32 v88, v88, v14
    s_lshl_b32 s52, s16, 1
    v_add_u32 v88, s52, v88
    v_and_b32 v88, 15, v88
    v_lshlrev_b32 v88, 4, v88
    v_lshl_add_u32 v88, v11, 8, v88
    v_lshrrev_b32 v11, 5, v10
    v_lshl_add_u32 v88, v11, 11, v88
    v_and_b32 v11, 1, v10
    v_lshl_add_u32 v2, v11, 3, v88
    v_add_u32 v15, 65536, v2
    v_add_u32 v14, 131072, v2
    v_mov_b32 v3, v1
    v_mov_b32 v88, 0x7ffffff0
    s_cmp_lt_u32 s17, 13
    s_cselect_b64 vcc, -1, 0
    v_cndmask_b32 v4, v88, v1, vcc
    v_lshlrev_b32 v7, 7, v10
    s_cselect_b32 s52, 2, 1
    v_cmp_gt_u32 vcc, s52, v10
    s_nop 1
    v_cndmask_b32 v7, v88, v7, vcc
    s_lshl_b32 s36, s17, 3
    s_add_u32 s36, s36, s16
    s_lshl_b32 s36, s36, 10
    s_add_u32 s36, s36, 61865984
    s_add_u32 s39, s36, 4096
    s_lshl_b32 s37, s17, 8
    s_lshl_b32 s52, s16, 2
    s_add_u32 s37, s37, s52
    s_add_u32 s37, s37, 6303744
    s_waitcnt vmcnt(32)
    s_barrier
    ds_read_b64_tr_b16 a[0:1], v2 offset:0
    ds_read_b64_tr_b16 a[2:3], v2 offset:1024
    ds_read_b64_tr_b16 a[4:5], v2 offset:4096
    ds_read_b64_tr_b16 a[6:7], v2 offset:5120
    ds_read_b64_tr_b16 a[8:9], v2 offset:8192
    ds_read_b64_tr_b16 a[10:11], v2 offset:9216
    ds_read_b64_tr_b16 a[12:13], v2 offset:12288
    ds_read_b64_tr_b16 a[14:15], v2 offset:13312
    ds_read_b64_tr_b16 a[16:17], v2 offset:16384
    ds_read_b64_tr_b16 a[18:19], v2 offset:17408
    ds_read_b64_tr_b16 a[20:21], v2 offset:20480
    ds_read_b64_tr_b16 a[22:23], v2 offset:21504
    ds_read_b64_tr_b16 a[24:25], v2 offset:24576
    ds_read_b64_tr_b16 a[26:27], v2 offset:25600
    ds_read_b64_tr_b16 a[28:29], v2 offset:28672
    ds_read_b64_tr_b16 a[30:31], v2 offset:29696
    s_waitcnt lgkmcnt(0)
    s_waitcnt vmcnt(24)
    s_barrier
    s_add_u32 m0, s32, 0
    s_nop 0
    global_load_lds_dwordx4 v[8:9], off
    v_add_co_u32 v8, vcc, 55296, v8
    s_nop 1
    v_addc_co_u32 v9, vcc, 0, v9, vcc
    s_add_u32 m0, s32, 4096
    s_nop 0
    global_load_lds_dwordx4 v[8:9], off
    v_add_co_u32 v8, vcc, 55296, v8
    s_nop 1
    v_addc_co_u32 v9, vcc, 0, v9, vcc
    s_add_u32 m0, s32, 8192
    s_nop 0
    global_load_lds_dwordx4 v[8:9], off
    v_add_co_u32 v8, vcc, 55296, v8
    s_nop 1
    v_addc_co_u32 v9, vcc, 0, v9, vcc
    s_add_u32 m0, s32, 12288
    s_nop 0
    global_load_lds_dwordx4 v[8:9], off
    v_add_co_u32 v8, vcc, 55296, v8
    s_nop 1
    v_addc_co_u32 v9, vcc, 0, v9, vcc
    s_add_u32 m0, s32, 16384
    s_nop 0
    global_load_lds_dwordx4 v[8:9], off
    v_add_co_u32 v8, vcc, 55296, v8
    s_nop 1
    v_addc_co_u32 v9, vcc, 0, v9, vcc
    s_add_u32 m0, s32, 20480
    s_nop 0
    global_load_lds_dwordx4 v[8:9], off
    v_add_co_u32 v8, vcc, 55296, v8
    s_nop 1
    v_addc_co_u32 v9, vcc, 0, v9, vcc
    s_add_u32 m0, s32, 24576
    s_nop 0
    global_load_lds_dwordx4 v[8:9], off
    v_add_co_u32 v8, vcc, 55296, v8
    s_nop 1
    v_addc_co_u32 v9, vcc, 0, v9, vcc
    s_add_u32 m0, s32, 28672
    s_nop 0
    global_load_lds_dwordx4 v[8:9], off
    v_add_co_u32 v8, vcc, 55296, v8
    s_nop 1
    v_addc_co_u32 v9, vcc, 0, v9, vcc
    ds_read_b64_tr_b16 a[160:161], v2 offset:32768
    ds_read_b64_tr_b16 a[162:163], v2 offset:33792
    ds_read_b64_tr_b16 a[164:165], v2 offset:36864
    ds_read_b64_tr_b16 a[166:167], v2 offset:37888
    ds_read_b64_tr_b16 a[168:169], v2 offset:40960
    ds_read_b64_tr_b16 a[170:171], v2 offset:41984
    ds_read_b64_tr_b16 a[172:173], v2 offset:45056
    ds_read_b64_tr_b16 a[174:175], v2 offset:46080
    ds_read_b64_tr_b16 a[176:177], v2 offset:49152
    ds_read_b64_tr_b16 a[178:179], v2 offset:50176
    ds_read_b64_tr_b16 a[180:181], v2 offset:53248
    ds_read_b64_tr_b16 a[182:183], v2 offset:54272
    ds_read_b64_tr_b16 a[184:185], v2 offset:57344
    ds_read_b64_tr_b16 a[186:187], v2 offset:58368
    ds_read_b64_tr_b16 a[188:189], v2 offset:61440
    ds_read_b64_tr_b16 a[190:191], v2 offset:62464
    s_waitcnt lgkmcnt(0)
    s_waitcnt vmcnt(24)
    s_barrier
    s_add_u32 m0, s32, 32768
    s_nop 0
    global_load_lds_dwordx4 v[12:13], off
    v_add_co_u32 v12, vcc, 55296, v12
    s_nop 1
    v_addc_co_u32 v13, vcc, 0, v13, vcc
    s_add_u32 m0, s32, 36864
    s_nop 0
    global_load_lds_dwordx4 v[12:13], off
    v_add_co_u32 v12, vcc, 55296, v12
    s_nop 1
    v_addc_co_u32 v13, vcc, 0, v13, vcc
    s_add_u32 m0, s32, 40960
    s_nop 0
    global_load_lds_dwordx4 v[12:13], off
    v_add_co_u32 v12, vcc, 55296, v12
    s_nop 1
    v_addc_co_u32 v13, vcc, 0, v13, vcc
    s_add_u32 m0, s32, 45056
    s_nop 0
    global_load_lds_dwordx4 v[12:13], off
    v_add_co_u32 v12, vcc, 55296, v12
    s_nop 1
    v_addc_co_u32 v13, vcc, 0, v13, vcc
    s_add_u32 m0, s32, 49152
    s_nop 0
    global_load_lds_dwordx4 v[12:13], off
    v_add_co_u32 v12, vcc, 55296, v12
    s_nop 1
    v_addc_co_u32 v13, vcc, 0, v13, vcc
    s_add_u32 m0, s32, 53248
    s_nop 0
    global_load_lds_dwordx4 v[12:13], off
    v_add_co_u32 v12, vcc, 55296, v12
    s_nop 1
    v_addc_co_u32 v13, vcc, 0, v13, vcc
    s_add_u32 m0, s32, 57344
    s_nop 0
    global_load_lds_dwordx4 v[12:13], off
    v_add_co_u32 v12, vcc, 55296, v12
    s_nop 1
    v_addc_co_u32 v13, vcc, 0, v13, vcc
    s_add_u32 m0, s32, 61440
    s_nop 0
    global_load_lds_dwordx4 v[12:13], off
    v_add_co_u32 v12, vcc, 55296, v12
    s_nop 1
    v_addc_co_u32 v13, vcc, 0, v13, vcc
    ds_read_b64_tr_b16 a[32:33], v15 offset:0
    ds_read_b64_tr_b16 a[34:35], v15 offset:1024
    ds_read_b64_tr_b16 a[36:37], v15 offset:4096
    ds_read_b64_tr_b16 a[38:39], v15 offset:5120
    ds_read_b64_tr_b16 a[40:41], v15 offset:8192
    ds_read_b64_tr_b16 a[42:43], v15 offset:9216
    ds_read_b64_tr_b16 a[44:45], v15 offset:12288
    ds_read_b64_tr_b16 a[46:47], v15 offset:13312
    ds_read_b64_tr_b16 a[48:49], v15 offset:16384
    ds_read_b64_tr_b16 a[50:51], v15 offset:17408
    ds_read_b64_tr_b16 a[52:53], v15 offset:20480
    ds_read_b64_tr_b16 a[54:55], v15 offset:21504
    ds_read_b64_tr_b16 a[56:57], v15 offset:24576
    ds_read_b64_tr_b16 a[58:59], v15 offset:25600
    ds_read_b64_tr_b16 a[60:61], v15 offset:28672
    ds_read_b64_tr_b16 a[62:63], v15 offset:29696
    s_waitcnt lgkmcnt(0)
    s_waitcnt vmcnt(24)
    s_barrier
    s_add_u32 m0, s32, 65536
    s_nop 0
    global_load_lds_dwordx4 v[8:9], off
    v_add_co_u32 v8, vcc, 55296, v8
    s_nop 1
    v_addc_co_u32 v9, vcc, 0, v9, vcc
    s_add_u32 m0, s32, 69632
    s_nop 0
    global_load_lds_dwordx4 v[8:9], off
    v_add_co_u32 v8, vcc, 55296, v8
    s_nop 1
    v_addc_co_u32 v9, vcc, 0, v9, vcc
    s_add_u32 m0, s32, 73728
    s_nop 0
    global_load_lds_dwordx4 v[8:9], off
    v_add_co_u32 v8, vcc, 55296, v8
    s_nop 1
    v_addc_co_u32 v9, vcc, 0, v9, vcc
    s_add_u32 m0, s32, 77824
    s_nop 0
    global_load_lds_dwordx4 v[8:9], off
    v_add_co_u32 v8, vcc, 55296, v8
    s_nop 1
    v_addc_co_u32 v9, vcc, 0, v9, vcc
    s_add_u32 m0, s32, 81920
    s_nop 0
    global_load_lds_dwordx4 v[8:9], off
    v_add_co_u32 v8, vcc, 55296, v8
    s_nop 1
    v_addc_co_u32 v9, vcc, 0, v9, vcc
    s_add_u32 m0, s32, 86016
    s_nop 0
    global_load_lds_dwordx4 v[8:9], off
    v_add_co_u32 v8, vcc, 55296, v8
    s_nop 1
    v_addc_co_u32 v9, vcc, 0, v9, vcc
    s_add_u32 m0, s32, 90112
    s_nop 0
    global_load_lds_dwordx4 v[8:9], off
    v_add_co_u32 v8, vcc, 55296, v8
    s_nop 1
    v_addc_co_u32 v9, vcc, 0, v9, vcc
    s_add_u32 m0, s32, 94208
    s_nop 0
    global_load_lds_dwordx4 v[8:9], off
    v_add_co_u32 v8, vcc, 55296, v8
    s_nop 1
    v_addc_co_u32 v9, vcc, 0, v9, vcc
    ds_read_b64_tr_b16 a[192:193], v15 offset:32768
    ds_read_b64_tr_b16 a[194:195], v15 offset:33792
    ds_read_b64_tr_b16 a[196:197], v15 offset:36864
    ds_read_b64_tr_b16 a[198:199], v15 offset:37888
    ds_read_b64_tr_b16 a[200:201], v15 offset:40960
    ds_read_b64_tr_b16 a[202:203], v15 offset:41984
    ds_read_b64_tr_b16 a[204:205], v15 offset:45056
    ds_read_b64_tr_b16 a[206:207], v15 offset:46080
    ds_read_b64_tr_b16 a[208:209], v15 offset:49152
    ds_read_b64_tr_b16 a[210:211], v15 offset:50176
    ds_read_b64_tr_b16 a[212:213], v15 offset:53248
    ds_read_b64_tr_b16 a[214:215], v15 offset:54272
    ds_read_b64_tr_b16 a[216:217], v15 offset:57344
    ds_read_b64_tr_b16 a[218:219], v15 offset:58368
    ds_read_b64_tr_b16 a[220:221], v15 offset:61440
    ds_read_b64_tr_b16 a[222:223], v15 offset:62464
    s_waitcnt lgkmcnt(0)
    s_waitcnt vmcnt(24)
    s_barrier
    s_add_u32 m0, s32, 98304
    s_nop 0
    global_load_lds_dwordx4 v[12:13], off
    v_add_co_u32 v12, vcc, 55296, v12
    s_nop 1
    v_addc_co_u32 v13, vcc, 0, v13, vcc
    s_add_u32 m0, s32, 102400
    s_nop 0
    global_load_lds_dwordx4 v[12:13], off
    v_add_co_u32 v12, vcc, 55296, v12
    s_nop 1
    v_addc_co_u32 v13, vcc, 0, v13, vcc
    s_add_u32 m0, s32, 106496
    s_nop 0
    global_load_lds_dwordx4 v[12:13], off
    v_add_co_u32 v12, vcc, 55296, v12
    s_nop 1
    v_addc_co_u32 v13, vcc, 0, v13, vcc
    s_add_u32 m0, s32, 110592
    s_nop 0
    global_load_lds_dwordx4 v[12:13], off
    v_add_co_u32 v12, vcc, 55296, v12
    s_nop 1
    v_addc_co_u32 v13, vcc, 0, v13, vcc
    s_add_u32 m0, s32, 114688
    s_nop 0
    global_load_lds_dwordx4 v[12:13], off
    v_add_co_u32 v12, vcc, 55296, v12
    s_nop 1
    v_addc_co_u32 v13, vcc, 0, v13, vcc
    s_add_u32 m0, s32, 118784
    s_nop 0
    global_load_lds_dwordx4 v[12:13], off
    v_add_co_u32 v12, vcc, 55296, v12
    s_nop 1
    v_addc_co_u32 v13, vcc, 0, v13, vcc
    s_add_u32 m0, s32, 122880
    s_nop 0
    global_load_lds_dwordx4 v[12:13], off
    v_add_co_u32 v12, vcc, 55296, v12
    s_nop 1
    v_addc_co_u32 v13, vcc, 0, v13, vcc
    s_add_u32 m0, s32, 126976
    s_nop 0
    global_load_lds_dwordx4 v[12:13], off
    v_add_co_u32 v12, vcc, 55296, v12
    s_nop 1
    v_addc_co_u32 v13, vcc, 0, v13, vcc
    ds_read_b64_tr_b16 a[64:65], v14 offset:0
    ds_read_b64_tr_b16 a[66:67], v14 offset:1024
    ds_read_b64_tr_b16 a[68:69], v14 offset:4096
    ds_read_b64_tr_b16 a[70:71], v14 offset:5120
    ds_read_b64_tr_b16 a[72:73], v14 offset:8192
    ds_read_b64_tr_b16 a[74:75], v14 offset:9216
    ds_read_b64_tr_b16 a[76:77], v14 offset:12288
    ds_read_b64_tr_b16 a[78:79], v14 offset:13312
    ds_read_b64_tr_b16 a[80:81], v14 offset:16384
    ds_read_b64_tr_b16 a[82:83], v14 offset:17408
    ds_read_b64_tr_b16 a[84:85], v14 offset:20480
    ds_read_b64_tr_b16 a[86:87], v14 offset:21504
    ds_read_b64_tr_b16 a[88:89], v14 offset:24576
    ds_read_b64_tr_b16 a[90:91], v14 offset:25600
    ds_read_b64_tr_b16 a[92:93], v14 offset:28672
    ds_read_b64_tr_b16 a[94:95], v14 offset:29696
    s_waitcnt lgkmcnt(0)
    s_waitcnt vmcnt(24)
    s_barrier
    s_add_u32 m0, s32, 131072
    s_nop 0
    global_load_lds_dwordx4 v[8:9], off
    v_add_co_u32 v8, vcc, 55296, v8
    s_nop 1
    v_addc_co_u32 v9, vcc, 0, v9, vcc
    s_add_u32 m0, s32, 135168
    s_nop 0
    global_load_lds_dwordx4 v[8:9], off
    v_add_co_u32 v8, vcc, 55296, v8
    s_nop 1
    v_addc_co_u32 v9, vcc, 0, v9, vcc
    s_add_u32 m0, s32, 139264
    s_nop 0
    global_load_lds_dwordx4 v[8:9], off
    v_add_co_u32 v8, vcc, 55296, v8
    s_nop 1
    v_addc_co_u32 v9, vcc, 0, v9, vcc
    s_add_u32 m0, s32, 143360
    s_nop 0
    global_load_lds_dwordx4 v[8:9], off
    v_add_co_u32 v8, vcc, 55296, v8
    s_nop 1
    v_addc_co_u32 v9, vcc, 0, v9, vcc
    s_add_u32 m0, s32, 147456
    s_nop 0
    global_load_lds_dwordx4 v[8:9], off
    v_add_co_u32 v8, vcc, 55296, v8
    s_nop 1
    v_addc_co_u32 v9, vcc, 0, v9, vcc
    s_add_u32 m0, s32, 151552
    s_nop 0
    global_load_lds_dwordx4 v[8:9], off
    v_add_co_u32 v8, vcc, 55296, v8
    s_nop 1
    v_addc_co_u32 v9, vcc, 0, v9, vcc
    s_add_u32 m0, s32, 155648
    s_nop 0
    global_load_lds_dwordx4 v[8:9], off
    v_add_co_u32 v8, vcc, 55296, v8
    s_nop 1
    v_addc_co_u32 v9, vcc, 0, v9, vcc
    s_add_u32 m0, s32, 159744
    s_nop 0
    global_load_lds_dwordx4 v[8:9], off
    v_add_co_u32 v8, vcc, 55296, v8
    s_nop 1
    v_addc_co_u32 v9, vcc, 0, v9, vcc
    ds_read_b64_tr_b16 a[224:225], v2 offset:0
    ds_read_b64_tr_b16 a[226:227], v2 offset:1024
    ds_read_b64_tr_b16 a[228:229], v2 offset:4096
    ds_read_b64_tr_b16 a[230:231], v2 offset:5120
    ds_read_b64_tr_b16 a[232:233], v2 offset:8192
    ds_read_b64_tr_b16 a[234:235], v2 offset:9216
    ds_read_b64_tr_b16 a[236:237], v2 offset:12288
    ds_read_b64_tr_b16 a[238:239], v2 offset:13312
    ds_read_b64_tr_b16 a[240:241], v2 offset:16384
    ds_read_b64_tr_b16 a[242:243], v2 offset:17408
    ds_read_b64_tr_b16 a[244:245], v2 offset:20480
    ds_read_b64_tr_b16 a[246:247], v2 offset:21504
    ds_read_b64_tr_b16 a[248:249], v2 offset:24576
    ds_read_b64_tr_b16 a[250:251], v2 offset:25600
    ds_read_b64_tr_b16 a[252:253], v2 offset:28672
    ds_read_b64_tr_b16 a[254:255], v2 offset:29696
    s_waitcnt lgkmcnt(0)
    s_waitcnt vmcnt(24)
    s_barrier
    ds_read_b64_tr_b16 a[96:97], v2 offset:32768
    ds_read_b64_tr_b16 a[98:99], v2 offset:33792
    ds_read_b64_tr_b16 a[100:101], v2 offset:36864
    ds_read_b64_tr_b16 a[102:103], v2 offset:37888
    ds_read_b64_tr_b16 a[104:105], v2 offset:40960
    ds_read_b64_tr_b16 a[106:107], v2 offset:41984
    ds_read_b64_tr_b16 a[108:109], v2 offset:45056
    ds_read_b64_tr_b16 a[110:111], v2 offset:46080
    ds_read_b64_tr_b16 a[112:113], v2 offset:49152
    ds_read_b64_tr_b16 a[114:115], v2 offset:50176
    ds_read_b64_tr_b16 a[116:117], v2 offset:53248
    ds_read_b64_tr_b16 a[118:119], v2 offset:54272
    ds_read_b64_tr_b16 a[120:121], v2 offset:57344
    ds_read_b64_tr_b16 a[122:123], v2 offset:58368
    ds_read_b64_tr_b16 a[124:125], v2 offset:61440
    ds_read_b64_tr_b16 a[126:127], v2 offset:62464
    s_waitcnt lgkmcnt(0)
    s_waitcnt vmcnt(16)
    s_barrier
    ds_read_b64_tr_b16 v[192:193], v15 offset:0
    ds_read_b64_tr_b16 v[194:195], v15 offset:1024
    ds_read_b64_tr_b16 v[196:197], v15 offset:4096
    ds_read_b64_tr_b16 v[198:199], v15 offset:5120
    ds_read_b64_tr_b16 v[200:201], v15 offset:8192
    ds_read_b64_tr_b16 v[202:203], v15 offset:9216
    ds_read_b64_tr_b16 v[204:205], v15 offset:12288
    ds_read_b64_tr_b16 v[206:207], v15 offset:13312
    ds_read_b64_tr_b16 v[208:209], v15 offset:16384
    ds_read_b64_tr_b16 v[210:211], v15 offset:17408
    ds_read_b64_tr_b16 v[212:213], v15 offset:20480
    ds_read_b64_tr_b16 v[214:215], v15 offset:21504
    ds_read_b64_tr_b16 v[216:217], v15 offset:24576
    ds_read_b64_tr_b16 v[218:219], v15 offset:25600
    ds_read_b64_tr_b16 v[220:221], v15 offset:28672
    ds_read_b64_tr_b16 v[222:223], v15 offset:29696
    s_waitcnt lgkmcnt(0)
    s_waitcnt vmcnt(8)
    s_barrier
    ds_read_b64_tr_b16 a[128:129], v15 offset:32768
    ds_read_b64_tr_b16 a[130:131], v15 offset:33792
    ds_read_b64_tr_b16 a[132:133], v15 offset:36864
    ds_read_b64_tr_b16 a[134:135], v15 offset:37888
    ds_read_b64_tr_b16 a[136:137], v15 offset:40960
    ds_read_b64_tr_b16 a[138:139], v15 offset:41984
    ds_read_b64_tr_b16 a[140:141], v15 offset:45056
    ds_read_b64_tr_b16 a[142:143], v15 offset:46080
    ds_read_b64_tr_b16 a[144:145], v15 offset:49152
    ds_read_b64_tr_b16 a[146:147], v15 offset:50176
    ds_read_b64_tr_b16 a[148:149], v15 offset:53248
    ds_read_b64_tr_b16 a[150:151], v15 offset:54272
    ds_read_b64_tr_b16 a[152:153], v15 offset:57344
    ds_read_b64_tr_b16 a[154:155], v15 offset:58368
    ds_read_b64_tr_b16 a[156:157], v15 offset:61440
    ds_read_b64_tr_b16 a[158:159], v15 offset:62464
    s_waitcnt lgkmcnt(0)
    s_waitcnt vmcnt(0)
    s_barrier
    ds_read_b64_tr_b16 v[224:225], v14 offset:0
    ds_read_b64_tr_b16 v[226:227], v14 offset:1024
    ds_read_b64_tr_b16 v[228:229], v14 offset:4096
    ds_read_b64_tr_b16 v[230:231], v14 offset:5120
    ds_read_b64_tr_b16 v[232:233], v14 offset:8192
    ds_read_b64_tr_b16 v[234:235], v14 offset:9216
    ds_read_b64_tr_b16 v[236:237], v14 offset:12288
    ds_read_b64_tr_b16 v[238:239], v14 offset:13312
    ds_read_b64_tr_b16 v[240:241], v14 offset:16384
    ds_read_b64_tr_b16 v[242:243], v14 offset:17408
    ds_read_b64_tr_b16 v[244:245], v14 offset:20480
    ds_read_b64_tr_b16 v[246:247], v14 offset:21504
    ds_read_b64_tr_b16 v[248:249], v14 offset:24576
    ds_read_b64_tr_b16 v[250:251], v14 offset:25600
    ds_read_b64_tr_b16 v[252:253], v14 offset:28672
    ds_read_b64_tr_b16 v[254:255], v14 offset:29696
    s_waitcnt lgkmcnt(0)
    s_barrier
    s_mul_i32 s34, s16, 10240
    s_add_u32 s34, s34, 8388608
    s_mul_i32 s38, s16, 10240
    s_mov_b32 s35, 0
    s_mov_b32 s33, 0
    s_add_u32 m0, s38, 0
    s_add_u32 s53, s34, 0
    buffer_load_dwordx4 v1, s[4:7], s53 offen offset:0 lds
    buffer_load_dwordx4 v1, s[4:7], s53 offen offset:1024 lds
    buffer_load_dwordx4 v1, s[4:7], s53 offen offset:2048 lds
    buffer_load_dwordx4 v1, s[4:7], s53 offen offset:3072 lds
    s_add_u32 m0, s38, 4096
    s_add_u32 s53, s34, 4096
    buffer_load_dwordx4 v1, s[4:7], s53 offen offset:0 lds
    buffer_load_dwordx4 v1, s[4:7], s53 offen offset:1024 lds
    buffer_load_dwordx4 v1, s[4:7], s53 offen offset:2048 lds
    buffer_load_dwordx4 v1, s[4:7], s53 offen offset:3072 lds
    s_add_u32 m0, s38, 8192
    s_add_u32 s53, s34, 8192
    buffer_load_dwordx4 v1, s[4:7], s53 offen offset:0 lds
    buffer_load_dwordx4 v1, s[4:7], s53 offen offset:1024 lds
    s_add_u32 s34, s34, 40960
    s_add_u32 s38, s38, 40960
    s_cmp_ge_u32 s38, 122880
    s_cselect_b32 s54, 122880, 0
    s_sub_u32 s38, s38, s54
    s_add_u32 m0, s38, 0
    s_add_u32 s53, s34, 0
    buffer_load_dwordx4 v1, s[4:7], s53 offen offset:0 lds
    buffer_load_dwordx4 v1, s[4:7], s53 offen offset:1024 lds
    buffer_load_dwordx4 v1, s[4:7], s53 offen offset:2048 lds
    buffer_load_dwordx4 v1, s[4:7], s53 offen offset:3072 lds
    s_add_u32 m0, s38, 4096
    s_add_u32 s53, s34, 4096
    buffer_load_dwordx4 v1, s[4:7], s53 offen offset:0 lds
    buffer_load_dwordx4 v1, s[4:7], s53 offen offset:1024 lds
    buffer_load_dwordx4 v1, s[4:7], s53 offen offset:2048 lds
    buffer_load_dwordx4 v1, s[4:7], s53 offen offset:3072 lds
    s_add_u32 m0, s38, 8192
    s_add_u32 s53, s34, 8192
    buffer_load_dwordx4 v1, s[4:7], s53 offen offset:0 lds
    buffer_load_dwordx4 v1, s[4:7], s53 offen offset:1024 lds
    s_add_u32 s34, s34, 40960
    s_add_u32 s38, s38, 40960
    s_cmp_ge_u32 s38, 122880
    s_cselect_b32 s54, 122880, 0
    s_sub_u32 s38, s38, s54
    s_waitcnt vmcnt(10)
L_F2_loop:
    s_barrier
    v_add_u32 v5, s35, v1
    ds_read_b128 v[48:51], v5 offset:0
    ds_read_b128 v[52:55], v5 offset:1024
    ds_read_b128 v[56:59], v5 offset:2048
    ds_read_b128 v[60:63], v5 offset:3072
    ds_read_b128 v[64:67], v5 offset:4096
    s_waitcnt lgkmcnt(4)
    v_mfma_f32_32x32x16_bf16 v[16:31], a[0:3], v[48:51], 0
    ds_read_b128 v[68:71], v5 offset:5120
    v_mfma_f32_32x32x16_bf16 v[32:47], a[160:163], v[48:51], 0
    s_add_u32 m0, s38, 0
    s_add_u32 s53, s34, 0
    buffer_load_dwordx4 v1, s[4:7], s53 offen offset:0 lds
    s_waitcnt lgkmcnt(4)
    v_mfma_f32_32x32x16_bf16 v[16:31], a[4:7], v[52:55], v[16:31]
    ds_read_b128 v[48:51], v5 offset:6144
    v_mfma_f32_32x32x16_bf16 v[32:47], a[164:167], v[52:55], v[32:47]
    buffer_load_dwordx4 v1, s[4:7], s53 offen offset:1024 lds
    s_waitcnt lgkmcnt(4)
    v_mfma_f32_32x32x16_bf16 v[16:31], a[8:11], v[56:59], v[16:31]
    ds_read_b128 v[52:55], v5 offset:7168
    v_mfma_f32_32x32x16_bf16 v[32:47], a[168:171], v[56:59], v[32:47]
    buffer_load_dwordx4 v1, s[4:7], s53 offen offset:2048 lds
    s_waitcnt lgkmcnt(4)
    v_mfma_f32_32x32x16_bf16 v[16:31], a[12:15], v[60:63], v[16:31]
    ds_read_b128 v[56:59], v5 offset:8192
    v_mfma_f32_32x32x16_bf16 v[32:47], a[172:175], v[60:63], v[32:47]
    buffer_load_dwordx4 v1, s[4:7], s53 offen offset:3072 lds
    s_waitcnt lgkmcnt(4)
    v_mfma_f32_32x32x16_bf16 v[16:31], a[16:19], v[64:67], v[16:31]
    ds_read_b128 v[60:63], v5 offset:9216
    v_mfma_f32_32x32x16_bf16 v[32:47], a[176:179], v[64:67], v[32:47]
    s_add_u32 m0, s38, 4096
    s_add_u32 s53, s34, 4096
    buffer_load_dwordx4 v1, s[4:7], s53 offen offset:0 lds
    s_waitcnt lgkmcnt(4)
    v_mfma_f32_32x32x16_bf16 v[16:31], a[20:23], v[68:71], v[16:31]
    ds_read_b128 v[64:67], v5 offset:10240
    v_mfma_f32_32x32x16_bf16 v[32:47], a[180:183], v[68:71], v[32:47]
    buffer_load_dwordx4 v1, s[4:7], s53 offen offset:1024 lds
    s_waitcnt lgkmcnt(4)
    v_mfma_f32_32x32x16_bf16 v[16:31], a[24:27], v[48:51], v[16:31]
    ds_read_b128 v[68:71], v5 offset:11264
    v_mfma_f32_32x32x16_bf16 v[32:47], a[184:187], v[48:51], v[32:47]
    buffer_load_dwordx4 v1, s[4:7], s53 offen offset:2048 lds
    s_waitcnt lgkmcnt(4)
    v_mfma_f32_32x32x16_bf16 v[16:31], a[28:31], v[52:55], v[16:31]
    ds_read_b128 v[48:51], v5 offset:12288
    v_mfma_f32_32x32x16_bf16 v[32:47], a[188:191], v[52:55], v[32:47]
    buffer_load_dwordx4 v1, s[4:7], s53 offen offset:3072 lds
    s_waitcnt lgkmcnt(4)
    v_mfma_f32_32x32x16_bf16 v[16:31], a[32:35], v[56:59], v[16:31]
    ds_read_b128 v[52:55], v5 offset:13312
    v_mfma_f32_32x32x16_bf16 v[32:47], a[192:195], v[56:59], v[32:47]
    s_add_u32 m0, s38, 8192
    s_add_u32 s53, s34, 8192
    buffer_load_dwordx4 v1, s[4:7], s53 offen offset:0 lds
    s_waitcnt lgkmcnt(4)
    v_mfma_f32_32x32x16_bf16 v[16:31], a[36:39], v[60:63], v[16:31]
    ds_read_b128 v[56:59], v5 offset:14336
    v_mfma_f32_32x32x16_bf16 v[32:47], a[196:199], v[60:63], v[32:47]
    buffer_load_dwordx4 v1, s[4:7], s53 offen offset:1024 lds
    s_waitcnt lgkmcnt(4)
    v_mfma_f32_32x32x16_bf16 v[16:31], a[40:43], v[64:67], v[16:31]
    ds_read_b128 v[60:63], v5 offset:15360
    v_mfma_f32_32x32x16_bf16 v[32:47], a[200:203], v[64:67], v[32:47]
    s_add_u32 s34, s34, 40960
    s_add_u32 s38, s38, 40960
    s_cmp_ge_u32 s38, 122880
    s_cselect_b32 s54, 122880, 0
    s_sub_u32 s38, s38, s54
    s_add_u32 s35, s35, 40960
    s_cmp_ge_u32 s35, 122880
    s_cselect_b32 s54, 122880, 0
    s_sub_u32 s35, s35, s54
    s_waitcnt lgkmcnt(4)
    v_mfma_f32_32x32x16_bf16 v[16:31], a[44:47], v[68:71], v[16:31]
    ds_read_b128 v[64:67], v5 offset:16384
    v_mfma_f32_32x32x16_bf16 v[32:47], a[204:207], v[68:71], v[32:47]
    s_waitcnt lgkmcnt(4)
    v_mfma_f32_32x32x16_bf16 v[16:31], a[48:51], v[48:51], v[16:31]
    ds_read_b128 v[68:71], v5 offset:17408
    v_mfma_f32_32x32x16_bf16 v[32:47], a[208:211], v[48:51], v[32:47]
    s_waitcnt lgkmcnt(4)
    v_mfma_f32_32x32x16_bf16 v[16:31], a[52:55], v[52:55], v[16:31]
    ds_read_b128 v[48:51], v5 offset:18432
    v_mfma_f32_32x32x16_bf16 v[32:47], a[212:215], v[52:55], v[32:47]
    s_waitcnt lgkmcnt(4)
    v_mfma_f32_32x32x16_bf16 v[16:31], a[56:59], v[56:59], v[16:31]
    ds_read_b128 v[52:55], v5 offset:19456
    v_mfma_f32_32x32x16_bf16 v[32:47], a[216:219], v[56:59], v[32:47]
    s_waitcnt vmcnt(10)
    v_mov_b32 v6, s33
    s_mov_b64 exec, 3
    buffer_store_dword v6, v7, s[4:7], s37 offen sc1
    s_mov_b64 exec, -1
    s_waitcnt lgkmcnt(4)
    v_mfma_f32_32x32x16_bf16 v[16:31], a[60:63], v[60:63], v[16:31]
    ds_read_b128 v[56:59], v5 offset:20480
    v_mfma_f32_32x32x16_bf16 v[32:47], a[220:223], v[60:63], v[32:47]
    s_waitcnt lgkmcnt(4)
    v_mfma_f32_32x32x16_bf16 v[16:31], a[64:67], v[64:67], v[16:31]
    ds_read_b128 v[60:63], v5 offset:21504
    v_mfma_f32_32x32x16_bf16 v[32:47], a[224:227], v[64:67], v[32:47]
    s_waitcnt lgkmcnt(4)
    v_mfma_f32_32x32x16_bf16 v[16:31], a[68:71], v[68:71], v[16:31]
    ds_read_b128 v[64:67], v5 offset:22528
    v_mfma_f32_32x32x16_bf16 v[32:47], a[228:231], v[68:71], v[32:47]
    s_waitcnt lgkmcnt(4)
    v_mfma_f32_32x32x16_bf16 v[16:31], a[72:75], v[48:51], v[16:31]
    ds_read_b128 v[68:71], v5 offset:23552
    v_mfma_f32_32x32x16_bf16 v[32:47], a[232:235], v[48:51], v[32:47]
    s_waitcnt lgkmcnt(4)
    v_mfma_f32_32x32x16_bf16 v[16:31], a[76:79], v[52:55], v[16:31]
    ds_read_b128 v[48:51], v5 offset:24576
    v_mfma_f32_32x32x16_bf16 v[32:47], a[236:239], v[52:55], v[32:47]
    s_waitcnt lgkmcnt(4)
    v_mfma_f32_32x32x16_bf16 v[16:31], a[80:83], v[56:59], v[16:31]
    ds_read_b128 v[52:55], v5 offset:25600
    v_mfma_f32_32x32x16_bf16 v[32:47], a[240:243], v[56:59], v[32:47]
    s_waitcnt lgkmcnt(4)
    v_mfma_f32_32x32x16_bf16 v[16:31], a[84:87], v[60:63], v[16:31]
    ds_read_b128 v[56:59], v5 offset:26624
    v_mfma_f32_32x32x16_bf16 v[32:47], a[244:247], v[60:63], v[32:47]
    s_waitcnt lgkmcnt(4)
    v_mfma_f32_32x32x16_bf16 v[16:31], a[88:91], v[64:67], v[16:31]
    ds_read_b128 v[60:63], v5 offset:27648
    v_mfma_f32_32x32x16_bf16 v[32:47], a[248:251], v[64:67], v[32:47]
    s_waitcnt lgkmcnt(4)
    v_mfma_f32_32x32x16_bf16 v[16:31], a[92:95], v[68:71], v[16:31]
    ds_read_b128 v[64:67], v5 offset:28672
    v_mfma_f32_32x32x16_bf16 v[32:47], a[252:255], v[68:71], v[32:47]
    s_waitcnt lgkmcnt(4)
    v_mfma_f32_32x32x16_bf16 v[16:31], a[96:99], v[48:51], v[16:31]
    ds_read_b128 v[68:71], v5 offset:29696
    v_mfma_f32_32x32x16_bf16 v[32:47], v[192:195], v[48:51], v[32:47]
    s_waitcnt lgkmcnt(4)
    v_mfma_f32_32x32x16_bf16 v[16:31], a[100:103], v[52:55], v[16:31]
    ds_read_b128 v[48:51], v5 offset:30720
    v_mfma_f32_32x32x16_bf16 v[32:47], v[196:199], v[52:55], v[32:47]
    s_waitcnt lgkmcnt(4)
    v_mfma_f32_32x32x16_bf16 v[16:31], a[104:107], v[56:59], v[16:31]
    ds_read_b128 v[52:55], v5 offset:31744
    v_mfma_f32_32x32x16_bf16 v[32:47], v[200:203], v[56:59], v[32:47]
    s_waitcnt lgkmcnt(4)
    v_mfma_f32_32x32x16_bf16 v[16:31], a[108:111], v[60:63], v[16:31]
    ds_read_b128 v[56:59], v5 offset:32768
    v_mfma_f32_32x32x16_bf16 v[32:47], v[204:207], v[60:63], v[32:47]
    s_waitcnt lgkmcnt(4)
    v_mfma_f32_32x32x16_bf16 v[16:31], a[112:115], v[64:67], v[16:31]
    ds_read_b128 v[60:63], v5 offset:33792
    v_mfma_f32_32x32x16_bf16 v[32:47], v[208:211], v[64:67], v[32:47]
    s_waitcnt lgkmcnt(4)
    v_mfma_f32_32x32x16_bf16 v[16:31], a[116:119], v[68:71], v[16:31]
    ds_read_b128 v[64:67], v5 offset:34816
    v_mfma_f32_32x32x16_bf16 v[32:47], v[212:215], v[68:71], v[32:47]
    s_waitcnt lgkmcnt(4)
    v_mfma_f32_32x32x16_bf16 v[16:31], a[120:123], v[48:51], v[16:31]
    ds_read_b128 v[68:71], v5 offset:35840
    v_mfma_f32_32x32x16_bf16 v[32:47], v[216:219], v[48:51], v[32:47]
    s_waitcnt lgkmcnt(4)
    v_mfma_f32_32x32x16_bf16 v[16:31], a[124:127], v[52:55], v[16:31]
    ds_read_b128 v[48:51], v5 offset:36864
    v_mfma_f32_32x32x16_bf16 v[32:47], v[220:223], v[52:55], v[32:47]
    s_waitcnt lgkmcnt(4)
    v_mfma_f32_32x32x16_bf16 v[16:31], a[128:131], v[56:59], v[16:31]
    ds_read_b128 v[52:55], v5 offset:37888
    v_mfma_f32_32x32x16_bf16 v[32:47], v[224:227], v[56:59], v[32:47]
    s_waitcnt lgkmcnt(4)
    v_mfma_f32_32x32x16_bf16 v[16:31], a[132:135], v[60:63], v[16:31]
    ds_read_b128 v[56:59], v5 offset:38912
    v_mfma_f32_32x32x16_bf16 v[32:47], v[228:231], v[60:63], v[32:47]
    s_waitcnt lgkmcnt(4)
    v_mfma_f32_32x32x16_bf16 v[16:31], a[136:139], v[64:67], v[16:31]
    ds_read_b128 v[60:63], v5 offset:39936
    v_mfma_f32_32x32x16_bf16 v[32:47], v[232:235], v[64:67], v[32:47]
    s_waitcnt lgkmcnt(4)
    v_mfma_f32_32x32x16_bf16 v[16:31], a[140:143], v[68:71], v[16:31]
    v_mfma_f32_32x32x16_bf16 v[32:47], v[236:239], v[68:71], v[32:47]
    s_waitcnt lgkmcnt(3)
    v_mfma_f32_32x32x16_bf16 v[16:31], a[144:147], v[48:51], v[16:31]
    v_mfma_f32_32x32x16_bf16 v[32:47], v[240:243], v[48:51], v[32:47]
    s_waitcnt lgkmcnt(2)
    v_mfma_f32_32x32x16_bf16 v[16:31], a[148:151], v[52:55], v[16:31]
    v_mfma_f32_32x32x16_bf16 v[32:47], v[244:247], v[52:55], v[32:47]
    s_waitcnt lgkmcnt(1)
    v_mfma_f32_32x32x16_bf16 v[16:31], a[152:155], v[56:59], v[16:31]
    v_mfma_f32_32x32x16_bf16 v[32:47], v[248:251], v[56:59], v[32:47]
    s_waitcnt lgkmcnt(0)
    v_mfma_f32_32x32x16_bf16 v[16:31], a[156:159], v[60:63], v[16:31]
    v_mfma_f32_32x32x16_bf16 v[32:47], v[252:255], v[60:63], v[32:47]
    s_nop 10
    v_mul_f32 v72, 0xbfb8aa3b, v16
    v_mul_f32 v73, 0xbfb8aa3b, v17
    v_mul_f32 v74, 0xbfb8aa3b, v18
    v_mul_f32 v75, 0xbfb8aa3b, v19
    v_mul_f32 v76, 0xbfb8aa3b, v20
    v_mul_f32 v77, 0xbfb8aa3b, v21
    v_mul_f32 v78, 0xbfb8aa3b, v22
    v_mul_f32 v79, 0xbfb8aa3b, v23
    v_exp_f32 v72, v72
    v_exp_f32 v73, v73
    v_exp_f32 v74, v74
    v_exp_f32 v75, v75
    v_exp_f32 v76, v76
    v_exp_f32 v77, v77
    v_exp_f32 v78, v78
    v_exp_f32 v79, v79
    v_add_f32 v72, 1.0, v72
    v_add_f32 v73, 1.0, v73
    v_add_f32 v74, 1.0, v74
    v_add_f32 v75, 1.0, v75
    v_add_f32 v76, 1.0, v76
    v_add_f32 v77, 1.0, v77
    v_add_f32 v78, 1.0, v78
    v_add_f32 v79, 1.0, v79
    v_rcp_f32 v72, v72
    v_rcp_f32 v73, v73
    v_rcp_f32 v74, v74
    v_rcp_f32 v75, v75
    v_rcp_f32 v76, v76
    v_rcp_f32 v77, v77
    v_rcp_f32 v78, v78
    v_rcp_f32 v79, v79
    v_mul_f32 v16, v16, v24
    v_mul_f32 v17, v17, v25
    v_mul_f32 v18, v18, v26
    v_mul_f32 v19, v19, v27
    v_mul_f32 v20, v20, v28
    v_mul_f32 v21, v21, v29
    v_mul_f32 v22, v22, v30
    v_mul_f32 v23, v23, v31
    v_mul_f32 v16, v16, v72
    v_mul_f32 v17, v17, v73
    v_mul_f32 v18, v18, v74
    v_mul_f32 v19, v19, v75
    v_mul_f32 v20, v20, v76
    v_mul_f32 v21, v21, v77
    v_mul_f32 v22, v22, v78
    v_mul_f32 v23, v23, v79
    v_cvt_pk_bf16_f32 v80, v16, v17
    v_cvt_pk_bf16_f32 v81, v18, v19
    v_cvt_pk_bf16_f32 v82, v20, v21
    v_cvt_pk_bf16_f32 v83, v22, v23
    buffer_store_dwordx4 v[80:83], v3, s[4:7], s36 offen sc1
    v_mul_f32 v72, 0xbfb8aa3b, v32
    v_mul_f32 v73, 0xbfb8aa3b, v33
    v_mul_f32 v74, 0xbfb8aa3b, v34
    v_mul_f32 v75, 0xbfb8aa3b, v35
    v_mul_f32 v76, 0xbfb8aa3b, v36
    v_mul_f32 v77, 0xbfb8aa3b, v37
    v_mul_f32 v78, 0xbfb8aa3b, v38
    v_mul_f32 v79, 0xbfb8aa3b, v39
    v_exp_f32 v72, v72
    v_exp_f32 v73, v73
    v_exp_f32 v74, v74
    v_exp_f32 v75, v75
    v_exp_f32 v76, v76
    v_exp_f32 v77, v77
    v_exp_f32 v78, v78
    v_exp_f32 v79, v79
    v_add_f32 v72, 1.0, v72
    v_add_f32 v73, 1.0, v73
    v_add_f32 v74, 1.0, v74
    v_add_f32 v75, 1.0, v75
    v_add_f32 v76, 1.0, v76
    v_add_f32 v77, 1.0, v77
    v_add_f32 v78, 1.0, v78
    v_add_f32 v79, 1.0, v79
    v_rcp_f32 v72, v72
    v_rcp_f32 v73, v73
    v_rcp_f32 v74, v74
    v_rcp_f32 v75, v75
    v_rcp_f32 v76, v76
    v_rcp_f32 v77, v77
    v_rcp_f32 v78, v78
    v_rcp_f32 v79, v79
    v_mul_f32 v32, v32, v40
    v_mul_f32 v33, v33, v41
    v_mul_f32 v34, v34, v42
    v_mul_f32 v35, v35, v43
    v_mul_f32 v36, v36, v44
    v_mul_f32 v37, v37, v45
    v_mul_f32 v38, v38, v46
    v_mul_f32 v39, v39, v47
    v_mul_f32 v32, v32, v72
    v_mul_f32 v33, v33, v73
    v_mul_f32 v34, v34, v74
    v_mul_f32 v35, v35, v75
    v_mul_f32 v36, v36, v76
    v_mul_f32 v37, v37, v77
    v_mul_f32 v38, v38, v78
    v_mul_f32 v39, v39, v79
    v_cvt_pk_bf16_f32 v84, v32, v33
    v_cvt_pk_bf16_f32 v85, v34, v35
    v_cvt_pk_bf16_f32 v86, v36, v37
    v_cvt_pk_bf16_f32 v87, v38, v39
    buffer_store_dwordx4 v[84:87], v4, s[4:7], s39 offen sc1
    s_add_u32 s36, s36, 110592
    s_add_u32 s39, s39, 110592
    s_add_u32 s33, s33, 1
    s_cmp_lt_u32 s33, 64
    s_waitcnt vmcnt(13)
    s_cbranch_scc1 L_F2_loop
    s_waitcnt vmcnt(0)
    v_mov_b32 v6, 64
    s_mov_b64 exec, 3
    buffer_store_dword v6, v7, s[4:7], s37 offen sc1
    s_waitcnt vmcnt(0)
    s_endpgm
L_exit:
    s_endpgm
L_code_end:
.section .rodata,"a"
.p2align 6
.amdhsa_kernel parallel_sum__memory_aug_recurrent_mem_tr__swiglu_ffn__prompt_kernel
.amdhsa_next_free_vgpr 512
.amdhsa_next_free_sgpr 102
.amdhsa_accum_offset 256
.amdhsa_group_segment_fixed_size 0
.amdhsa_kernarg_size 112
.amdhsa_user_sgpr_count 2
.amdhsa_user_sgpr_kernarg_segment_ptr 1
.amdhsa_system_sgpr_workgroup_id_x 1
.amdhsa_float_denorm_mode_32 3
.end_amdhsa_kernel
```
